```python
import torch

def _softmax(x, axis=-1):
    return torch.softmax(x, dim=axis)
def _gelu(x):
    return torch.nn.functional.gelu(x, approximate="tanh")
def _silu(x):
    return torch.nn.functional.silu(x)
def _sigmoid(x):
    return torch.sigmoid(x)
def _layernorm(x, axis=-1, eps=1e-5):
    m = x.mean(dim=axis, keepdim=True)
    v = x.var(dim=axis, keepdim=True, unbiased=False)
    return (x - m) / torch.sqrt(v + eps)
def _scatter_add(tgt, idx, src, axis=0):
    return tgt.clone().index_add_(axis, idx, src)
def _segment_sum(src, seg, n):
    out = torch.zeros((n,) + src.shape[1:], dtype=src.dtype)
    return out.index_add_(0, seg, src)
def _pad(x, pw):
    flat = tuple(v for pair in reversed(pw) for v in pair)
    return torch.nn.functional.pad(x, flat)

kernel_name = 'gated_mix__linear_kernel_hedgehog__compressed_kv_cla__prompt'

def setup_inputs():

    _w = (lambda a: (lambda t: t.to(torch.bfloat16) if t.is_floating_point() else t)(torch.as_tensor(a)))
    def _A_setup():
        B, S, D, H = 1, 2048, 512, 32
        Dh = D // H
        return {
            "x": _w((lambda *s: torch.randn(*s, dtype=torch.bfloat16) * 0.05)(B, S, D)),
            "wqkv": _w((lambda *s: torch.randn(*s, dtype=torch.bfloat16) * 1.6)(D, 3 * D)),
            "w_phi": _w((lambda *s: torch.randn(*s, dtype=torch.bfloat16) * 1.6)(H, Dh, Dh) * (Dh ** -0.5)),
            "wo": _w((lambda *s: torch.randn(*s, dtype=torch.bfloat16) * 0.05)(D, D)),
        }
    _A_in = _A_setup()

    def _B_setup():
        B, H, Sq, Sk, D, M = 1, 32, 2048, 2048, 128, 512
        Dc = 4 * D
        return {
            "x": _w((lambda *s: torch.randn(*s, dtype=torch.bfloat16) * 0.05)(B, Sq, M)),
            "c_kv": _w((lambda *s: torch.randn(*s, dtype=torch.bfloat16) * 0.8)(B, Sk, Dc)),
            "w_q": _w((lambda *s: torch.randn(*s, dtype=torch.bfloat16) * 6.4)(M, H, D) * (M ** -0.5)),
            "w_uk": _w((lambda *s: torch.randn(*s, dtype=torch.bfloat16) * 6.4)(Dc, H, D) * (Dc ** -0.5)),
            "w_uv": _w((lambda *s: torch.randn(*s, dtype=torch.bfloat16) * 0.8)(Dc, H, D) * (Dc ** -0.5)),
            "w_o": _w((lambda *s: torch.randn(*s, dtype=torch.bfloat16) * 0.8)(H, D, M) * ((H * D) ** -0.5)),
        }
    _B_in = _B_setup()

    return {
        "A_x": _A_in["x"],
        "A_wqkv": _A_in["wqkv"],
        "A_w_phi": _A_in["w_phi"],
        "A_wo": _A_in["wo"],
        "B_x": _B_in["x"],
        "B_c_kv": _B_in["c_kv"],
        "B_w_q": _B_in["w_q"],
        "B_w_uk": _B_in["w_uk"],
        "B_w_uv": _B_in["w_uv"],
        "B_w_o": _B_in["w_o"],
        "gate_w": _w((lambda *s: torch.randn(*s, dtype=torch.bfloat16) * 0.05)(512) * 16.0),
    }

def reference(A_x, A_wqkv, A_w_phi, A_wo, B_x, B_c_kv, B_w_q, B_w_uk, B_w_uv, B_w_o, gate_w):
    def _A_ref(x, wqkv, w_phi, wo):
        B, S, D = x.shape
        H = 32; Dh = D // H
        qkv = (lambda x, *d: x.permute(*d))((x @ wqkv).reshape(B, S, 3, H, Dh), 2, 0, 3, 1, 4)
        q, k, v = qkv[0], qkv[1], qkv[2]
        pq = torch.einsum("bhsd,hdf->bhsf", q, w_phi)
        pk = torch.einsum("bhsd,hdf->bhsf", k, w_phi)
        phi_q = torch.concatenate([_softmax(pq, axis=-1), _softmax(-pq, axis=-1)], axis=-1)
        phi_k = torch.concatenate([_softmax(pk, axis=-1), _softmax(-pk, axis=-1)], axis=-1)
        kv = torch.einsum("bhsf,bhsd->bhfd", phi_k, v)
        z  = torch.einsum("bhsf->bhf", phi_k)
        num = torch.einsum("bhqf,bhfd->bhqd", phi_q, kv)
        den = torch.einsum("bhqf,bhf->bhq", phi_q, z)[..., None] + 1e-6
        o = num / den
        return (lambda x, *d: x.permute(*d))(o, 0, 2, 1, 3).reshape(B, S, D) @ wo

    def _B_ref(x, c_kv, w_q, w_uk, w_uv, w_o):
        B, Sq, M = x.shape[0], x.shape[1], x.shape[2]
        Sk = c_kv.shape[1]
        H, D = w_q.shape[1], w_q.shape[2]
        q = torch.einsum("bqm,mhd->bhqd", x, w_q)
        k = torch.einsum("bkc,chd->bhkd", c_kv, w_uk)
        v = torch.einsum("bkc,chd->bhkd", c_kv, w_uv)
        scores = torch.einsum("bhqd,bhkd->bhqk", q, k) * (D ** -0.5)
        off = Sk - Sq
        qi = torch.arange(Sq)[:, None]
        kj = torch.arange(Sk)[None, :]
        cmask = kj <= (qi + off)
        scores = torch.where(cmask[None, None], scores, -1e9)
        p = _softmax(scores, axis=-1)
        ctx = torch.einsum("bhqk,bhkd->bhqd", p, v)
        return torch.einsum("bhqd,hdm->bqm", ctx, w_o)

    x = A_x
    g = _sigmoid((x * gate_w).sum(-1, keepdims=True))
    a = _A_ref(x, A_wqkv, A_w_phi, A_wo)
    b = _B_ref(x, B_c_kv, B_w_q, B_w_uk, B_w_uv, B_w_o)
    return g * a + (1 - g) * b
```

```asm
; @launch kernel=k12_kernel grid=(256,1,1) block=(256,1,1) lds=133120
; @launch kernel=k3b_kernel grid=(256,1,1) block=(320,1,1) lds=131072
.amdgcn_target "amdgcn-amd-amdhsa--gfx950"
.text
.globl k12_kernel
.p2align 8
.type k12_kernel,@function
k12_kernel:
    s_cmp_ge_u32 s2, 256
    s_cbranch_scc1 K1_end
    s_load_dwordx4 s[64:67], s[0:1], 0
    s_load_dwordx2 s[68:69], s[0:1], 16
    s_load_dwordx4 s[72:75], s[0:1], 40
    s_load_dwordx4 s[76:79], s[0:1], 56
    s_load_dwordx2 s[80:81], s[0:1], 80
    s_load_dwordx2 s[82:83], s[0:1], 104
    v_lshrrev_b32 v1, 6, v0
    v_and_b32 v0, 63, v0
    s_nop 0
    v_readfirstlane_b32 s46, v1
    s_and_b32 s44, s2, 7
    s_lshl_b32 s44, s44, 2
    s_bfe_u32 s45, s2, 0x20003
    s_add_u32 s44, s44, s45
    s_lshr_b32 s45, s2, 5
    s_sub_u32 s62, 15, s45
    s_mov_b32 s61, s45
    s_waitcnt lgkmcnt(0)
    s_mov_b32 s8, s64
    s_and_b32 s9, s65, 0xffff
    s_mov_b32 s10, 0x200000
    s_mov_b32 s11, 0x20000
    s_mov_b32 s12, s72
    s_and_b32 s13, s73, 0xffff
    s_mov_b32 s14, 0x200000
    s_mov_b32 s15, 0x20000
    s_cmp_lt_u32 s46, 2
    s_cselect_b32 s84, s76, s78
    s_cselect_b32 s85, s77, s79
    s_mov_b32 s16, s84
    s_and_b32 s17, s85, 0xffff
    s_mov_b32 s18, 0x400000
    s_mov_b32 s19, 0x20000
    s_mov_b32 s24, s74
    s_and_b32 s25, s75, 0xffff
    s_mov_b32 s26, 0x400000
    s_mov_b32 s27, 0x20000
    s_mov_b32 s28, s66
    s_and_b32 s29, s67, 0xffff
    s_mov_b32 s30, 0x180000
    s_mov_b32 s31, 0x20000
    s_mov_b32 s32, s82
    s_and_b32 s33, s83, 0xffff
    s_mov_b32 s34, 0x10000000
    s_mov_b32 s35, 0x20000
    s_mov_b32 s36, s68
    s_and_b32 s37, s69, 0xffff
    s_mov_b32 s38, 0x4000
    s_mov_b32 s39, 0x20000
    s_mov_b32 s40, s80
    s_and_b32 s41, s81, 0xffff
    s_mov_b32 s42, 0x400
    s_mov_b32 s43, 0x20000
    s_load_dwordx2 s[64:65], s[0:1], 24
    s_load_dwordx2 s[66:67], s[0:1], 72
    s_load_dwordx2 s[100:101], s[0:1], 96
    s_lshl_b32 s58, s44, 3
    s_add_u32 s58, s58, s45
    s_lshl_b32 s58, s58, 7
    s_add_u32 s58, s58, 101711872
    v_and_b32 v3, 31, v0
    v_lshlrev_b32 v3, 2, v3
    v_mov_b32 v2, 0
    buffer_store_dword v2, v3, s[32:35], s58 offen sc1
    s_cmp_lt_u32 s46, 2
    s_cselect_b32 s47, s61, s62
    s_lshl_b32 s58, s47, 17
    s_and_b32 s59, s46, 1
    s_lshl_b32 s60, s59, 16
    s_add_u32 s52, s58, s60
    s_mov_b32 s54, s52
    s_lshl_b32 s58, s44, 8
    s_lshl_b32 s60, s59, 18
    s_add_u32 s53, s58, s60
    s_lshl_b32 s60, s46, 17
    s_add_u32 s55, s58, s60
    s_lshl_b32 s58, s44, 5
    s_mul_i32 s60, s46, 49152
    s_add_u32 s56, s58, s60
    s_lshl_b32 s48, s46, 13
    s_add_u32 s49, s48, 32768
    s_lshl_b32 s58, s46, 12
    s_add_u32 s50, s58, 32768
    s_lshl_b32 s58, s46, 11
    s_add_u32 s51, s58, 49152
    s_mov_b32 s63, 0x3fb8aa3b
    v_lshrrev_b32 v1, 3, v0
    v_lshlrev_b32 v1, 10, v1
    v_and_b32 v2, 7, v0
    v_lshrrev_b32 v3, 4, v0
    v_xor_b32 v4, v2, v3
    v_lshlrev_b32 v4, 4, v4
    v_add_u32 v4, v4, v1
    v_add_u32 v3, 4, v3
    v_xor_b32 v5, v2, v3
    v_lshlrev_b32 v5, 4, v5
    v_add_u32 v5, v5, v1
    v_add_u32 v8, 0, v4
    v_add_u32 v9, 7168, v5
    v_add_u32 v10, 14336, v4
    v_add_u32 v11, 21504, v5
    v_add_u32 v12, 32768, v4
    v_add_u32 v13, 39936, v5
    v_add_u32 v14, 47104, v4
    v_add_u32 v15, 54272, v5
    v_lshrrev_b32 v1, 4, v0
    v_lshlrev_b32 v2, 2, v1
    v_and_b32 v3, 15, v0
    v_xor_b32 v2, v2, v3
    v_lshlrev_b32 v2, 4, v2
    v_lshlrev_b32 v1, 13, v1
    v_add_u32 v4, v1, v2
    v_add_u32 v16, 0, v4
    v_add_u32 v17, 31744, v4
    v_add_u32 v18, 63488, v4
    v_add_u32 v19, 95232, v4
    v_add_u32 v20, 131072, v4
    v_add_u32 v21, 162816, v4
    v_add_u32 v22, 194560, v4
    v_add_u32 v23, 226304, v4
    v_bfe_u32 v1, v0, 4, 1
    v_lshlrev_b32 v1, 2, v1
    v_and_b32 v2, 7, v0
    v_xor_b32 v1, v1, v2
    v_lshrrev_b32 v2, 1, v1
    v_min_u32 v2, 2, v2
    v_lshlrev_b32 v2, 10, v2
    v_and_b32 v1, 1, v1
    v_lshlrev_b32 v1, 4, v1
    v_add_u32 v1, v1, v2
    v_lshrrev_b32 v2, 3, v0
    v_mul_u32_u24 v2, 3072, v2
    v_add_u32 v24, v1, v2
    v_add_u32 v25, 23552, v24
    s_cmp_lt_u32 s44, 16
    s_cselect_b32 s58, s61, s62
    s_lshl_b32 s58, s58, 7
    s_and_b32 s59, s44, 15
    s_lshl_b32 s59, s59, 3
    s_add_u32 s58, s58, s59
    s_lshl_b32 s59, s46, 1
    s_add_u32 s58, s58, s59
    s_lshl_b32 s59, s58, 10
    v_lshlrev_b32 v1, 4, v0
    buffer_load_dwordx4 v[128:131], v1, s[40:43], 0 offen
    buffer_load_dwordx4 v[132:135], v1, s[8:11], s59 offen
    buffer_load_dwordx4 v[136:139], v1, s[8:11], s59 offen offset:1024
    s_mov_b32 s71, s58
    v_and_b32 v2, 15, v0
    v_lshrrev_b32 v3, 5, v0
    v_lshlrev_b32 v3, 7, v3
    v_lshl_add_u32 v2, v2, 1, v3
    s_lshl_b32 s59, s44, 9
    buffer_load_ushort v44, v2, s[36:39], s59 offen offset:0
    buffer_load_ushort v45, v2, s[36:39], s59 offen offset:32
    buffer_load_ushort v46, v2, s[36:39], s59 offen offset:64
    buffer_load_ushort v47, v2, s[36:39], s59 offen offset:96
    buffer_load_ushort v48, v2, s[36:39], s59 offen offset:256
    buffer_load_ushort v49, v2, s[36:39], s59 offen offset:288
    buffer_load_ushort v50, v2, s[36:39], s59 offen offset:320
    buffer_load_ushort v51, v2, s[36:39], s59 offen offset:352
    s_add_u32 m0, s49, 0
    s_nop 0
    buffer_load_dwordx4 v16, s[16:19], s53 offen lds
    buffer_load_dwordx4 v17, s[16:19], s53 offen offset:1024 lds
    buffer_load_dwordx4 v18, s[16:19], s53 offen offset:2048 lds
    buffer_load_dwordx4 v19, s[16:19], s53 offen offset:3072 lds
    s_add_u32 m0, s49, 4096
    s_nop 0
    buffer_load_dwordx4 v20, s[16:19], s53 offen lds
    buffer_load_dwordx4 v21, s[16:19], s53 offen offset:1024 lds
    buffer_load_dwordx4 v22, s[16:19], s53 offen offset:2048 lds
    buffer_load_dwordx4 v23, s[16:19], s53 offen offset:3072 lds
    s_add_u32 m0, s48, 0
    s_nop 0
    buffer_load_dwordx4 v8, s[12:15], s52 offen lds
    buffer_load_dwordx4 v9, s[12:15], s52 offen offset:1024 lds
    buffer_load_dwordx4 v10, s[12:15], s52 offen offset:2048 lds
    buffer_load_dwordx4 v11, s[12:15], s52 offen offset:3072 lds
    s_add_u32 m0, s48, 4096
    s_nop 0
    buffer_load_dwordx4 v12, s[12:15], s52 offen lds
    buffer_load_dwordx4 v13, s[12:15], s52 offen offset:1024 lds
    buffer_load_dwordx4 v14, s[12:15], s52 offen offset:2048 lds
    buffer_load_dwordx4 v15, s[12:15], s52 offen offset:3072 lds
    s_add_u32 s52, s52, 128
    s_add_u32 s53, s53, 524288
    s_xor_b32 s48, s48, 0x10000
    s_xor_b32 s49, s49, 0x10000
    s_xor_b32 s50, s50, 0x10000
    s_xor_b32 s51, s51, 0x10000
    s_add_u32 m0, s49, 0
    s_nop 0
    buffer_load_dwordx4 v16, s[16:19], s53 offen lds
    buffer_load_dwordx4 v17, s[16:19], s53 offen offset:1024 lds
    buffer_load_dwordx4 v18, s[16:19], s53 offen offset:2048 lds
    buffer_load_dwordx4 v19, s[16:19], s53 offen offset:3072 lds
    s_add_u32 m0, s49, 4096
    s_nop 0
    buffer_load_dwordx4 v20, s[16:19], s53 offen lds
    buffer_load_dwordx4 v21, s[16:19], s53 offen offset:1024 lds
    buffer_load_dwordx4 v22, s[16:19], s53 offen offset:2048 lds
    buffer_load_dwordx4 v23, s[16:19], s53 offen offset:3072 lds
    s_add_u32 m0, s48, 0
    s_nop 0
    buffer_load_dwordx4 v8, s[12:15], s52 offen lds
    buffer_load_dwordx4 v9, s[12:15], s52 offen offset:1024 lds
    buffer_load_dwordx4 v10, s[12:15], s52 offen offset:2048 lds
    buffer_load_dwordx4 v11, s[12:15], s52 offen offset:3072 lds
    s_add_u32 m0, s48, 4096
    s_nop 0
    buffer_load_dwordx4 v12, s[12:15], s52 offen lds
    buffer_load_dwordx4 v13, s[12:15], s52 offen offset:1024 lds
    buffer_load_dwordx4 v14, s[12:15], s52 offen offset:2048 lds
    buffer_load_dwordx4 v15, s[12:15], s52 offen offset:3072 lds
    s_add_u32 s52, s52, 128
    s_add_u32 s53, s53, 524288
    s_xor_b32 s48, s48, 0x10000
    s_xor_b32 s49, s49, 0x10000
    s_xor_b32 s50, s50, 0x10000
    s_xor_b32 s51, s51, 0x10000
    v_and_b32 v1, 31, v0
    v_lshlrev_b32 v1, 7, v1
    v_lshrrev_b32 v2, 5, v0
    v_bfe_u32 v3, v0, 1, 3
    s_and_b32 s58, s46, 1
    s_lshl_b32 s58, s58, 14
    v_add_u32 v1, s58, v1
    v_add_u32 v4, 0, v2
    v_xor_b32 v4, v4, v3
    v_lshlrev_b32 v4, 4, v4
    v_add_u32 v26, v4, v1
    v_add_u32 v4, 2, v2
    v_xor_b32 v4, v4, v3
    v_lshlrev_b32 v4, 4, v4
    v_add_u32 v27, v4, v1
    v_add_u32 v4, 4, v2
    v_xor_b32 v4, v4, v3
    v_lshlrev_b32 v4, 4, v4
    v_add_u32 v28, v4, v1
    v_add_u32 v4, 6, v2
    v_xor_b32 v4, v4, v3
    v_lshlrev_b32 v4, 4, v4
    v_add_u32 v29, v4, v1
    v_bfe_u32 v1, v0, 2, 2
    v_lshrrev_b32 v2, 5, v0
    v_lshlrev_b32 v2, 3, v2
    v_add_u32 v2, v2, v1
    v_lshlrev_b32 v3, 8, v2
    v_bfe_u32 v4, v0, 4, 1
    v_lshlrev_b32 v4, 1, v4
    v_bfe_u32 v5, v0, 1, 1
    v_add_u32 v4, v4, v5
    v_lshlrev_b32 v4, 4, v4
    v_and_b32 v5, 1, v0
    v_lshlrev_b32 v5, 3, v5
    v_add_u32 v4, v4, v5
    v_add_u32 v3, v3, v4
    s_lshr_b32 s58, s46, 1
    s_lshl_b32 s58, s58, 14
    s_add_u32 s58, s58, 32768
    v_add_u32 v3, s58, v3
    v_xor_b32 v5, 0, v1
    v_lshlrev_b32 v5, 6, v5
    v_add_u32 v30, v5, v3
    v_xor_b32 v5, 1, v1
    v_lshlrev_b32 v5, 6, v5
    v_add_u32 v31, v5, v3
    v_xor_b32 v5, 2, v1
    v_lshlrev_b32 v5, 6, v5
    v_add_u32 v32, v5, v3
    v_xor_b32 v5, 3, v1
    v_lshlrev_b32 v5, 6, v5
    v_add_u32 v33, v5, v3
    v_lshlrev_b32 v3, 7, v2
    v_add_u32 v3, v3, v4
    v_add_u32 v3, 49152, v3
    v_bfe_u32 v1, v0, 3, 1
    v_xor_b32 v5, 0, v1
    v_lshlrev_b32 v5, 6, v5
    v_add_u32 v34, v5, v3
    v_xor_b32 v5, 1, v1
    v_lshlrev_b32 v5, 6, v5
    v_add_u32 v35, v5, v3
    s_lshr_b32 s58, s2, 3
    s_lshl_b32 s58, s58, 2
    s_add_u32 s58, s58, s46
    s_and_b32 s59, s2, 7
    v_and_b32 v1, 15, v0
    s_lshl_b32 s60, s58, 4
    v_add_u32 v1, s60, v1
    v_lshlrev_b32 v1, 10, v1
    v_add_u32 v56, 256, v1
    v_and_b32 v2, 7, v0
    v_lshlrev_b32 v1, 7, v2
    s_and_b32 s60, s58, 63
    s_add_u32 s60, s60, 128
    s_lshl_b32 s60, s60, 13
    s_lshl_b32 s70, s59, 10
    s_add_u32 s60, s60, s70
    v_add_u32 v57, s60, v1
    v_and_b32 v1, 3, v0
    v_lshlrev_b32 v1, 7, v1
    s_lshr_b32 s60, s58, 1
    s_lshl_b32 s60, s60, 13
    s_add_u32 s60, s60, s70
    s_and_b32 s70, s58, 1
    s_lshl_b32 s70, s70, 9
    s_add_u32 s60, s60, s70
    v_add_u32 v58, s60, v1
    v_bfe_u32 v1, v0, 2, 2
    v_mul_u32_u24 v1, 3072, v1
    v_and_b32 v2, 3, v0
    v_min_u32 v2, 2, v2
    v_lshl_add_u32 v1, v2, 10, v1
    s_mul_i32 s60, s58, 12288
    s_lshl_b32 s70, s59, 7
    s_add_u32 s60, s60, s70
    v_add_u32 v59, s60, v1
    s_cmp_lt_u32 s58, 64
    s_cselect_b32 s4, s76, s78
    s_cselect_b32 s5, s77, s79
    s_and_b32 s5, s5, 0xffff
    s_mov_b32 s6, 0x400000
    s_mov_b32 s7, 0x20000
    s_mov_b32 s96, s12
    s_mov_b32 s97, s13
    s_mov_b32 s98, s14
    s_mov_b32 s99, s15
    buffer_load_dword v62, v59, s[28:31], 0 offen
    buffer_load_dword v60, v56, s[96:99], 0 offen
    buffer_load_dword v61, v57, s[4:7], 0 offen
    v_add_u32 v56, 128, v56
    v_add_u32 v57, 524288, v57
    buffer_load_dword v60, v56, s[96:99], 0 offen
    buffer_load_dword v61, v57, s[4:7], 0 offen
    v_add_u32 v56, 128, v56
    v_add_u32 v57, 524288, v57
    v_accvgpr_write_b32 a0, 0
    v_accvgpr_write_b32 a1, 0
    v_accvgpr_write_b32 a2, 0
    v_accvgpr_write_b32 a3, 0
    v_accvgpr_write_b32 a4, 0
    v_accvgpr_write_b32 a5, 0
    v_accvgpr_write_b32 a6, 0
    v_accvgpr_write_b32 a7, 0
    v_accvgpr_write_b32 a8, 0
    v_accvgpr_write_b32 a9, 0
    v_accvgpr_write_b32 a10, 0
    v_accvgpr_write_b32 a11, 0
    v_accvgpr_write_b32 a12, 0
    v_accvgpr_write_b32 a13, 0
    v_accvgpr_write_b32 a14, 0
    v_accvgpr_write_b32 a15, 0
    v_accvgpr_write_b32 a16, 0
    v_accvgpr_write_b32 a17, 0
    v_accvgpr_write_b32 a18, 0
    v_accvgpr_write_b32 a19, 0
    v_accvgpr_write_b32 a20, 0
    v_accvgpr_write_b32 a21, 0
    v_accvgpr_write_b32 a22, 0
    v_accvgpr_write_b32 a23, 0
    v_accvgpr_write_b32 a24, 0
    v_accvgpr_write_b32 a25, 0
    v_accvgpr_write_b32 a26, 0
    v_accvgpr_write_b32 a27, 0
    v_accvgpr_write_b32 a28, 0
    v_accvgpr_write_b32 a29, 0
    v_accvgpr_write_b32 a30, 0
    v_accvgpr_write_b32 a31, 0
    v_accvgpr_write_b32 a32, 0
    v_accvgpr_write_b32 a33, 0
    v_accvgpr_write_b32 a34, 0
    v_accvgpr_write_b32 a35, 0
    v_accvgpr_write_b32 a36, 0
    v_accvgpr_write_b32 a37, 0
    v_accvgpr_write_b32 a38, 0
    v_accvgpr_write_b32 a39, 0
    v_accvgpr_write_b32 a40, 0
    v_accvgpr_write_b32 a41, 0
    v_accvgpr_write_b32 a42, 0
    v_accvgpr_write_b32 a43, 0
    v_accvgpr_write_b32 a44, 0
    v_accvgpr_write_b32 a45, 0
    v_accvgpr_write_b32 a46, 0
    v_accvgpr_write_b32 a47, 0
    v_accvgpr_write_b32 a48, 0
    v_accvgpr_write_b32 a49, 0
    v_accvgpr_write_b32 a50, 0
    v_accvgpr_write_b32 a51, 0
    v_accvgpr_write_b32 a52, 0
    v_accvgpr_write_b32 a53, 0
    v_accvgpr_write_b32 a54, 0
    v_accvgpr_write_b32 a55, 0
    v_accvgpr_write_b32 a56, 0
    v_accvgpr_write_b32 a57, 0
    v_accvgpr_write_b32 a58, 0
    v_accvgpr_write_b32 a59, 0
    v_accvgpr_write_b32 a60, 0
    v_accvgpr_write_b32 a61, 0
    v_accvgpr_write_b32 a62, 0
    v_accvgpr_write_b32 a63, 0
    v_accvgpr_write_b32 a64, 0
    v_accvgpr_write_b32 a65, 0
    v_accvgpr_write_b32 a66, 0
    v_accvgpr_write_b32 a67, 0
    v_accvgpr_write_b32 a68, 0
    v_accvgpr_write_b32 a69, 0
    v_accvgpr_write_b32 a70, 0
    v_accvgpr_write_b32 a71, 0
    v_accvgpr_write_b32 a72, 0
    v_accvgpr_write_b32 a73, 0
    v_accvgpr_write_b32 a74, 0
    v_accvgpr_write_b32 a75, 0
    v_accvgpr_write_b32 a76, 0
    v_accvgpr_write_b32 a77, 0
    v_accvgpr_write_b32 a78, 0
    v_accvgpr_write_b32 a79, 0
    v_accvgpr_write_b32 a80, 0
    v_accvgpr_write_b32 a81, 0
    v_accvgpr_write_b32 a82, 0
    v_accvgpr_write_b32 a83, 0
    v_accvgpr_write_b32 a84, 0
    v_accvgpr_write_b32 a85, 0
    v_accvgpr_write_b32 a86, 0
    v_accvgpr_write_b32 a87, 0
    v_accvgpr_write_b32 a88, 0
    v_accvgpr_write_b32 a89, 0
    v_accvgpr_write_b32 a90, 0
    v_accvgpr_write_b32 a91, 0
    v_accvgpr_write_b32 a92, 0
    v_accvgpr_write_b32 a93, 0
    v_accvgpr_write_b32 a94, 0
    v_accvgpr_write_b32 a95, 0
    v_accvgpr_write_b32 a96, 0
    v_accvgpr_write_b32 a97, 0
    v_accvgpr_write_b32 a98, 0
    v_accvgpr_write_b32 a99, 0
    v_accvgpr_write_b32 a100, 0
    v_accvgpr_write_b32 a101, 0
    v_accvgpr_write_b32 a102, 0
    v_accvgpr_write_b32 a103, 0
    v_accvgpr_write_b32 a104, 0
    v_accvgpr_write_b32 a105, 0
    v_accvgpr_write_b32 a106, 0
    v_accvgpr_write_b32 a107, 0
    v_accvgpr_write_b32 a108, 0
    v_accvgpr_write_b32 a109, 0
    v_accvgpr_write_b32 a110, 0
    v_accvgpr_write_b32 a111, 0
    v_accvgpr_write_b32 a112, 0
    v_accvgpr_write_b32 a113, 0
    v_accvgpr_write_b32 a114, 0
    v_accvgpr_write_b32 a115, 0
    v_accvgpr_write_b32 a116, 0
    v_accvgpr_write_b32 a117, 0
    v_accvgpr_write_b32 a118, 0
    v_accvgpr_write_b32 a119, 0
    v_accvgpr_write_b32 a120, 0
    v_accvgpr_write_b32 a121, 0
    v_accvgpr_write_b32 a122, 0
    v_accvgpr_write_b32 a123, 0
    v_accvgpr_write_b32 a124, 0
    v_accvgpr_write_b32 a125, 0
    v_accvgpr_write_b32 a126, 0
    v_accvgpr_write_b32 a127, 0
    v_accvgpr_write_b32 a128, 0
    v_accvgpr_write_b32 a129, 0
    v_accvgpr_write_b32 a130, 0
    v_accvgpr_write_b32 a131, 0
    v_accvgpr_write_b32 a132, 0
    v_accvgpr_write_b32 a133, 0
    v_accvgpr_write_b32 a134, 0
    v_accvgpr_write_b32 a135, 0
    v_accvgpr_write_b32 a136, 0
    v_accvgpr_write_b32 a137, 0
    v_accvgpr_write_b32 a138, 0
    v_accvgpr_write_b32 a139, 0
    v_accvgpr_write_b32 a140, 0
    v_accvgpr_write_b32 a141, 0
    v_accvgpr_write_b32 a142, 0
    v_accvgpr_write_b32 a143, 0
    v_accvgpr_write_b32 a144, 0
    v_accvgpr_write_b32 a145, 0
    v_accvgpr_write_b32 a146, 0
    v_accvgpr_write_b32 a147, 0
    v_accvgpr_write_b32 a148, 0
    v_accvgpr_write_b32 a149, 0
    v_accvgpr_write_b32 a150, 0
    v_accvgpr_write_b32 a151, 0
    v_accvgpr_write_b32 a152, 0
    v_accvgpr_write_b32 a153, 0
    v_accvgpr_write_b32 a154, 0
    v_accvgpr_write_b32 a155, 0
    v_accvgpr_write_b32 a156, 0
    v_accvgpr_write_b32 a157, 0
    v_accvgpr_write_b32 a158, 0
    v_accvgpr_write_b32 a159, 0
    v_accvgpr_write_b32 a160, 0
    v_accvgpr_write_b32 a161, 0
    v_accvgpr_write_b32 a162, 0
    v_accvgpr_write_b32 a163, 0
    v_accvgpr_write_b32 a164, 0
    v_accvgpr_write_b32 a165, 0
    v_accvgpr_write_b32 a166, 0
    v_accvgpr_write_b32 a167, 0
    v_accvgpr_write_b32 a168, 0
    v_accvgpr_write_b32 a169, 0
    v_accvgpr_write_b32 a170, 0
    v_accvgpr_write_b32 a171, 0
    v_accvgpr_write_b32 a172, 0
    v_accvgpr_write_b32 a173, 0
    v_accvgpr_write_b32 a174, 0
    v_accvgpr_write_b32 a175, 0
    v_accvgpr_write_b32 a176, 0
    v_accvgpr_write_b32 a177, 0
    v_accvgpr_write_b32 a178, 0
    v_accvgpr_write_b32 a179, 0
    v_accvgpr_write_b32 a180, 0
    v_accvgpr_write_b32 a181, 0
    v_accvgpr_write_b32 a182, 0
    v_accvgpr_write_b32 a183, 0
    v_accvgpr_write_b32 a184, 0
    v_accvgpr_write_b32 a185, 0
    v_accvgpr_write_b32 a186, 0
    v_accvgpr_write_b32 a187, 0
    v_accvgpr_write_b32 a188, 0
    v_accvgpr_write_b32 a189, 0
    v_accvgpr_write_b32 a190, 0
    v_accvgpr_write_b32 a191, 0
    v_accvgpr_write_b32 a192, 0
    v_accvgpr_write_b32 a193, 0
    v_accvgpr_write_b32 a194, 0
    v_accvgpr_write_b32 a195, 0
    v_accvgpr_write_b32 a196, 0
    v_accvgpr_write_b32 a197, 0
    v_accvgpr_write_b32 a198, 0
    v_accvgpr_write_b32 a199, 0
    s_waitcnt vmcnt(37)
    v_bfe_u32 v3, v0, 4, 1
    v_mul_u32_u24 v3, 0x8000, v3
    v_lshl_or_b32 v3, v3, 16, v3
    v_lshl_or_b32 v36, v45, 16, v44
    v_xor_b32 v36, v36, v3
    v_lshl_or_b32 v37, v47, 16, v46
    v_xor_b32 v37, v37, v3
    v_lshl_or_b32 v38, v49, 16, v48
    v_xor_b32 v38, v38, v3
    v_lshl_or_b32 v39, v51, 16, v50
    v_xor_b32 v39, v39, v3
    v_lshlrev_b32 v140, 16, v128
    v_and_b32 v141, 0xffff0000, v128
    v_lshlrev_b32 v142, 16, v129
    v_and_b32 v143, 0xffff0000, v129
    v_lshlrev_b32 v144, 16, v130
    v_and_b32 v145, 0xffff0000, v130
    v_lshlrev_b32 v146, 16, v131
    v_and_b32 v147, 0xffff0000, v131
    v_lshlrev_b32 v152, 16, v132
    v_and_b32 v153, 0xffff0000, v132
    v_mul_f32 v150, v152, v140
    v_fmac_f32 v150, v153, v141
    v_lshlrev_b32 v152, 16, v133
    v_and_b32 v153, 0xffff0000, v133
    v_fmac_f32 v150, v152, v142
    v_fmac_f32 v150, v153, v143
    v_lshlrev_b32 v152, 16, v134
    v_and_b32 v153, 0xffff0000, v134
    v_fmac_f32 v150, v152, v144
    v_fmac_f32 v150, v153, v145
    v_lshlrev_b32 v152, 16, v135
    v_and_b32 v153, 0xffff0000, v135
    v_fmac_f32 v150, v152, v146
    v_fmac_f32 v150, v153, v147
    v_lshlrev_b32 v152, 16, v136
    v_and_b32 v153, 0xffff0000, v136
    v_mul_f32 v151, v152, v140
    v_fmac_f32 v151, v153, v141
    v_lshlrev_b32 v152, 16, v137
    v_and_b32 v153, 0xffff0000, v137
    v_fmac_f32 v151, v152, v142
    v_fmac_f32 v151, v153, v143
    v_lshlrev_b32 v152, 16, v138
    v_and_b32 v153, 0xffff0000, v138
    v_fmac_f32 v151, v152, v144
    v_fmac_f32 v151, v153, v145
    v_lshlrev_b32 v152, 16, v139
    v_and_b32 v153, 0xffff0000, v139
    v_fmac_f32 v151, v152, v146
    v_fmac_f32 v151, v153, v147
    s_nop 1
    v_add_f32_dpp v150, v150, v150 row_ror:8 row_mask:0xf bank_mask:0xf
    v_add_f32_dpp v151, v151, v151 row_ror:8 row_mask:0xf bank_mask:0xf
    s_nop 1
    v_add_f32_dpp v150, v150, v150 row_ror:4 row_mask:0xf bank_mask:0xf
    v_add_f32_dpp v151, v151, v151 row_ror:4 row_mask:0xf bank_mask:0xf
    s_nop 1
    v_add_f32_dpp v150, v150, v150 row_ror:2 row_mask:0xf bank_mask:0xf
    v_add_f32_dpp v151, v151, v151 row_ror:2 row_mask:0xf bank_mask:0xf
    s_nop 1
    v_add_f32_dpp v150, v150, v150 row_ror:1 row_mask:0xf bank_mask:0xf
    v_add_f32_dpp v151, v151, v151 row_ror:1 row_mask:0xf bank_mask:0xf
    v_mov_b32 v152, v150
    v_mov_b32 v153, v151
    s_nop 1
    v_permlane16_swap_b32 v150, v152
    v_permlane16_swap_b32 v151, v153
    v_add_f32 v150, v150, v152
    v_add_f32 v151, v151, v153
    v_mov_b32 v152, v150
    v_mov_b32 v153, v151
    s_nop 1
    v_permlane32_swap_b32 v150, v152
    v_permlane32_swap_b32 v151, v153
    v_add_f32 v150, v150, v152
    v_add_f32 v151, v151, v153
    v_cmp_eq_u32 vcc, 1, v0
    s_nop 1
    v_cndmask_b32 v150, v150, v151, vcc
    v_mul_f32 v150, s63, v150
    v_exp_f32 v150, -v150
    s_nop 0
    v_add_f32 v150, 1.0, v150
    v_rcp_f32 v150, v150
    v_lshlrev_b32 v152, 2, v0
    s_lshl_b32 s71, s71, 2
    s_add_u32 s71, s71, 55574528
    v_cmp_gt_u32 vcc, 2, v0
    s_and_saveexec_b64 s[74:75], vcc
    buffer_store_dword v150, v152, s[32:35], s71 offen sc1
    s_mov_b64 exec, s[74:75]
    v_accvgpr_write_b32 a200, 0
    v_accvgpr_write_b32 a201, 0
    v_accvgpr_write_b32 a202, 0
    v_accvgpr_write_b32 a203, 0
    v_accvgpr_write_b32 a204, 0
    v_accvgpr_write_b32 a205, 0
    v_accvgpr_write_b32 a206, 0
    v_accvgpr_write_b32 a207, 0
    v_accvgpr_write_b32 a208, 0
    v_accvgpr_write_b32 a209, 0
    v_accvgpr_write_b32 a210, 0
    v_accvgpr_write_b32 a211, 0
    v_accvgpr_write_b32 a212, 0
    v_accvgpr_write_b32 a213, 0
    v_accvgpr_write_b32 a214, 0
    v_accvgpr_write_b32 a215, 0
    v_accvgpr_write_b32 a216, 0
    v_accvgpr_write_b32 a217, 0
    v_accvgpr_write_b32 a218, 0
    v_accvgpr_write_b32 a219, 0
    v_accvgpr_write_b32 a220, 0
    v_accvgpr_write_b32 a221, 0
    v_accvgpr_write_b32 a222, 0
    v_accvgpr_write_b32 a223, 0
    v_accvgpr_write_b32 a224, 0
    v_accvgpr_write_b32 a225, 0
    v_accvgpr_write_b32 a226, 0
    v_accvgpr_write_b32 a227, 0
    v_accvgpr_write_b32 a228, 0
    v_accvgpr_write_b32 a229, 0
    v_accvgpr_write_b32 a230, 0
    v_accvgpr_write_b32 a231, 0
    v_accvgpr_write_b32 a232, 0
    v_accvgpr_write_b32 a233, 0
    v_accvgpr_write_b32 a234, 0
    v_accvgpr_write_b32 a235, 0
    v_accvgpr_write_b32 a236, 0
    v_accvgpr_write_b32 a237, 0
    v_accvgpr_write_b32 a238, 0
    v_accvgpr_write_b32 a239, 0
    v_accvgpr_write_b32 a240, 0
    v_accvgpr_write_b32 a241, 0
    v_accvgpr_write_b32 a242, 0
    v_accvgpr_write_b32 a243, 0
    v_accvgpr_write_b32 a244, 0
    v_accvgpr_write_b32 a245, 0
    v_accvgpr_write_b32 a246, 0
    v_accvgpr_write_b32 a247, 0
    v_accvgpr_write_b32 a248, 0
    v_accvgpr_write_b32 a249, 0
    v_accvgpr_write_b32 a250, 0
    v_accvgpr_write_b32 a251, 0
    v_accvgpr_write_b32 a252, 0
    v_accvgpr_write_b32 a253, 0
    v_accvgpr_write_b32 a254, 0
    v_accvgpr_write_b32 a255, 0
    s_waitcnt vmcnt(22)
    s_barrier
    ds_read_b128 v[64:67], v26 offset:0
    ds_read_b64_tr_b16 v[80:81], v30 offset:0
    ds_read_b64_tr_b16 v[82:83], v30 offset:1024
    ds_read_b128 v[68:71], v26 offset:4096
    ds_read_b64_tr_b16 v[84:85], v31 offset:0
    ds_read_b64_tr_b16 v[86:87], v31 offset:1024
    ds_read_b128 v[72:75], v26 offset:8192
    ds_read_b64_tr_b16 v[88:89], v32 offset:0
    ds_read_b64_tr_b16 v[90:91], v32 offset:1024
    ds_read_b128 v[76:79], v26 offset:12288
    ds_read_b64_tr_b16 v[92:93], v33 offset:0
    ds_read_b64_tr_b16 v[94:95], v33 offset:1024
    s_cmp_lt_u32 s46, 2
    s_cbranch_scc0 K1_roleV
    s_waitcnt lgkmcnt(0)
    v_mfma_f32_32x32x16_bf16 a[0:15], v[80:83], v[64:67], a[0:15]
    ds_read_b128 v[96:99], v27 offset:0
    v_mfma_f32_32x32x16_bf16 a[16:31], v[84:87], v[64:67], a[16:31]
    ds_read_b64_tr_b16 v[112:113], v30 offset:4096
    v_mfma_f32_32x32x16_bf16 a[32:47], v[88:91], v[64:67], a[32:47]
    ds_read_b64_tr_b16 v[114:115], v30 offset:5120
    v_mfma_f32_32x32x16_bf16 a[48:63], v[92:95], v[64:67], a[48:63]
    ds_read_b128 v[100:103], v27 offset:4096
    v_mfma_f32_32x32x16_bf16 a[64:79], v[80:83], v[68:71], a[64:79]
    ds_read_b64_tr_b16 v[116:117], v31 offset:4096
    v_mfma_f32_32x32x16_bf16 a[80:95], v[84:87], v[68:71], a[80:95]
    ds_read_b64_tr_b16 v[118:119], v31 offset:5120
    v_mfma_f32_32x32x16_bf16 a[96:111], v[88:91], v[68:71], a[96:111]
    ds_read_b128 v[104:107], v27 offset:8192
    v_mfma_f32_32x32x16_bf16 a[112:127], v[92:95], v[68:71], a[112:127]
    ds_read_b64_tr_b16 v[120:121], v32 offset:4096
    v_mfma_f32_32x32x16_bf16 a[128:143], v[80:83], v[72:75], a[128:143]
    ds_read_b64_tr_b16 v[122:123], v32 offset:5120
    v_mfma_f32_32x32x16_bf16 a[144:159], v[84:87], v[72:75], a[144:159]
    ds_read_b128 v[108:111], v27 offset:12288
    v_mfma_f32_32x32x16_bf16 a[160:175], v[88:91], v[72:75], a[160:175]
    ds_read_b64_tr_b16 v[124:125], v33 offset:4096
    v_mfma_f32_32x32x16_bf16 a[176:191], v[92:95], v[72:75], a[176:191]
    ds_read_b64_tr_b16 v[126:127], v33 offset:5120
    v_mfma_f32_32x32x16_bf16 a[192:207], v[80:83], v[76:79], a[192:207]
    v_mfma_f32_32x32x16_bf16 a[208:223], v[84:87], v[76:79], a[208:223]
    v_mfma_f32_32x32x16_bf16 a[224:239], v[88:91], v[76:79], a[224:239]
    v_mfma_f32_32x32x16_bf16 a[240:255], v[92:95], v[76:79], a[240:255]
    s_waitcnt lgkmcnt(0)
    v_mfma_f32_32x32x16_bf16 a[0:15], v[112:115], v[96:99], a[0:15]
    ds_read_b128 v[64:67], v28 offset:0
    v_mfma_f32_32x32x16_bf16 a[16:31], v[116:119], v[96:99], a[16:31]
    ds_read_b64_tr_b16 v[80:81], v30 offset:8192
    v_mfma_f32_32x32x16_bf16 a[32:47], v[120:123], v[96:99], a[32:47]
    ds_read_b64_tr_b16 v[82:83], v30 offset:9216
    v_mfma_f32_32x32x16_bf16 a[48:63], v[124:127], v[96:99], a[48:63]
    ds_read_b128 v[68:71], v28 offset:4096
    v_mfma_f32_32x32x16_bf16 a[64:79], v[112:115], v[100:103], a[64:79]
    ds_read_b64_tr_b16 v[84:85], v31 offset:8192
    v_mfma_f32_32x32x16_bf16 a[80:95], v[116:119], v[100:103], a[80:95]
    ds_read_b64_tr_b16 v[86:87], v31 offset:9216
    v_mfma_f32_32x32x16_bf16 a[96:111], v[120:123], v[100:103], a[96:111]
    ds_read_b128 v[72:75], v28 offset:8192
    v_mfma_f32_32x32x16_bf16 a[112:127], v[124:127], v[100:103], a[112:127]
    ds_read_b64_tr_b16 v[88:89], v32 offset:8192
    v_mfma_f32_32x32x16_bf16 a[128:143], v[112:115], v[104:107], a[128:143]
    ds_read_b64_tr_b16 v[90:91], v32 offset:9216
    v_mfma_f32_32x32x16_bf16 a[144:159], v[116:119], v[104:107], a[144:159]
    ds_read_b128 v[76:79], v28 offset:12288
    v_mfma_f32_32x32x16_bf16 a[160:175], v[120:123], v[104:107], a[160:175]
    ds_read_b64_tr_b16 v[92:93], v33 offset:8192
    v_mfma_f32_32x32x16_bf16 a[176:191], v[124:127], v[104:107], a[176:191]
    ds_read_b64_tr_b16 v[94:95], v33 offset:9216
    v_mfma_f32_32x32x16_bf16 a[192:207], v[112:115], v[108:111], a[192:207]
    v_mfma_f32_32x32x16_bf16 a[208:223], v[116:119], v[108:111], a[208:223]
    v_mfma_f32_32x32x16_bf16 a[224:239], v[120:123], v[108:111], a[224:239]
    v_mfma_f32_32x32x16_bf16 a[240:255], v[124:127], v[108:111], a[240:255]
    s_waitcnt lgkmcnt(0)
    v_mfma_f32_32x32x16_bf16 a[0:15], v[80:83], v[64:67], a[0:15]
    ds_read_b128 v[96:99], v29 offset:0
    buffer_load_dword v60, v56, s[96:99], 0 offen
    buffer_load_dword v61, v57, s[4:7], 0 offen
    v_add_u32 v56, 128, v56
    v_add_u32 v57, 524288, v57
    v_mfma_f32_32x32x16_bf16 a[16:31], v[84:87], v[64:67], a[16:31]
    ds_read_b64_tr_b16 v[112:113], v30 offset:12288
    v_mfma_f32_32x32x16_bf16 a[32:47], v[88:91], v[64:67], a[32:47]
    ds_read_b64_tr_b16 v[114:115], v30 offset:13312
    v_mfma_f32_32x32x16_bf16 a[48:63], v[92:95], v[64:67], a[48:63]
    ds_read_b128 v[100:103], v29 offset:4096
    v_mfma_f32_32x32x16_bf16 a[64:79], v[80:83], v[68:71], a[64:79]
    ds_read_b64_tr_b16 v[116:117], v31 offset:12288
    buffer_load_dword v60, v56, s[96:99], 0 offen
    buffer_load_dword v61, v57, s[4:7], 0 offen
    v_add_u32 v56, 128, v56
    v_add_u32 v57, 524288, v57
    v_mfma_f32_32x32x16_bf16 a[80:95], v[84:87], v[68:71], a[80:95]
    ds_read_b64_tr_b16 v[118:119], v31 offset:13312
    v_mfma_f32_32x32x16_bf16 a[96:111], v[88:91], v[68:71], a[96:111]
    ds_read_b128 v[104:107], v29 offset:8192
    v_mfma_f32_32x32x16_bf16 a[112:127], v[92:95], v[68:71], a[112:127]
    ds_read_b64_tr_b16 v[120:121], v32 offset:12288
    v_mfma_f32_32x32x16_bf16 a[128:143], v[80:83], v[72:75], a[128:143]
    ds_read_b64_tr_b16 v[122:123], v32 offset:13312
    v_mfma_f32_32x32x16_bf16 a[144:159], v[84:87], v[72:75], a[144:159]
    ds_read_b128 v[108:111], v29 offset:12288
    v_mfma_f32_32x32x16_bf16 a[160:175], v[88:91], v[72:75], a[160:175]
    ds_read_b64_tr_b16 v[124:125], v33 offset:12288
    v_mfma_f32_32x32x16_bf16 a[176:191], v[92:95], v[72:75], a[176:191]
    ds_read_b64_tr_b16 v[126:127], v33 offset:13312
    v_mfma_f32_32x32x16_bf16 a[192:207], v[80:83], v[76:79], a[192:207]
    v_mfma_f32_32x32x16_bf16 a[208:223], v[84:87], v[76:79], a[208:223]
    v_mfma_f32_32x32x16_bf16 a[224:239], v[88:91], v[76:79], a[224:239]
    v_mfma_f32_32x32x16_bf16 a[240:255], v[92:95], v[76:79], a[240:255]
    s_waitcnt lgkmcnt(0)
    v_mfma_f32_32x32x16_bf16 a[0:15], v[112:115], v[96:99], a[0:15]
    v_mfma_f32_32x32x16_bf16 a[16:31], v[116:119], v[96:99], a[16:31]
    s_waitcnt vmcnt(10)
    s_barrier
    v_mfma_f32_32x32x16_bf16 a[32:47], v[120:123], v[96:99], a[32:47]
    v_xor_b32 v26, 0x10000, v26
    v_xor_b32 v27, 0x10000, v27
    v_xor_b32 v28, 0x10000, v28
    v_xor_b32 v29, 0x10000, v29
    v_xor_b32 v30, 0x10000, v30
    v_xor_b32 v31, 0x10000, v31
    v_xor_b32 v32, 0x10000, v32
    v_xor_b32 v33, 0x10000, v33
    v_mfma_f32_32x32x16_bf16 a[48:63], v[124:127], v[96:99], a[48:63]
    ds_read_b128 v[64:67], v26 offset:0
    ds_read_b64_tr_b16 v[80:81], v30 offset:0
    s_add_u32 m0, s49, 0
    s_nop 0
    buffer_load_dwordx4 v16, s[16:19], s53 offen lds
    v_mfma_f32_32x32x16_bf16 a[64:79], v[112:115], v[100:103], a[64:79]
    ds_read_b64_tr_b16 v[82:83], v30 offset:1024
    v_mfma_f32_32x32x16_bf16 a[80:95], v[116:119], v[100:103], a[80:95]
    ds_read_b128 v[68:71], v26 offset:4096
    buffer_load_dwordx4 v17, s[16:19], s53 offen offset:1024 lds
    v_mfma_f32_32x32x16_bf16 a[96:111], v[120:123], v[100:103], a[96:111]
    ds_read_b64_tr_b16 v[84:85], v31 offset:0
    v_mfma_f32_32x32x16_bf16 a[112:127], v[124:127], v[100:103], a[112:127]
    ds_read_b64_tr_b16 v[86:87], v31 offset:1024
    v_mfma_f32_32x32x16_bf16 a[128:143], v[112:115], v[104:107], a[128:143]
    ds_read_b128 v[72:75], v26 offset:8192
    buffer_load_dwordx4 v18, s[16:19], s53 offen offset:2048 lds
    v_mfma_f32_32x32x16_bf16 a[144:159], v[116:119], v[104:107], a[144:159]
    ds_read_b64_tr_b16 v[88:89], v32 offset:0
    v_mfma_f32_32x32x16_bf16 a[160:175], v[120:123], v[104:107], a[160:175]
    ds_read_b64_tr_b16 v[90:91], v32 offset:1024
    buffer_load_dwordx4 v19, s[16:19], s53 offen offset:3072 lds
    v_mfma_f32_32x32x16_bf16 a[176:191], v[124:127], v[104:107], a[176:191]
    ds_read_b128 v[76:79], v26 offset:12288
    v_mfma_f32_32x32x16_bf16 a[192:207], v[112:115], v[108:111], a[192:207]
    ds_read_b64_tr_b16 v[92:93], v33 offset:0
    v_mfma_f32_32x32x16_bf16 a[208:223], v[116:119], v[108:111], a[208:223]
    ds_read_b64_tr_b16 v[94:95], v33 offset:1024
    s_add_u32 m0, s49, 4096
    s_nop 0
    buffer_load_dwordx4 v20, s[16:19], s53 offen lds
    v_mfma_f32_32x32x16_bf16 a[224:239], v[120:123], v[108:111], a[224:239]
    v_mfma_f32_32x32x16_bf16 a[240:255], v[124:127], v[108:111], a[240:255]
    s_mov_b32 s57, 5
.p2align 6
K1_p1loop_K:
    s_waitcnt lgkmcnt(0)
    v_mfma_f32_32x32x16_bf16 a[0:15], v[80:83], v[64:67], a[0:15]
    ds_read_b128 v[96:99], v27 offset:0
    buffer_load_dwordx4 v21, s[16:19], s53 offen offset:1024 lds
    v_mfma_f32_32x32x16_bf16 a[16:31], v[84:87], v[64:67], a[16:31]
    ds_read_b64_tr_b16 v[112:113], v30 offset:4096
    v_mfma_f32_32x32x16_bf16 a[32:47], v[88:91], v[64:67], a[32:47]
    ds_read_b64_tr_b16 v[114:115], v30 offset:5120
    buffer_load_dwordx4 v22, s[16:19], s53 offen offset:2048 lds
    v_mfma_f32_32x32x16_bf16 a[48:63], v[92:95], v[64:67], a[48:63]
    ds_read_b128 v[100:103], v27 offset:4096
    v_mfma_f32_32x32x16_bf16 a[64:79], v[80:83], v[68:71], a[64:79]
    ds_read_b64_tr_b16 v[116:117], v31 offset:4096
    buffer_load_dwordx4 v23, s[16:19], s53 offen offset:3072 lds
    v_mfma_f32_32x32x16_bf16 a[80:95], v[84:87], v[68:71], a[80:95]
    ds_read_b64_tr_b16 v[118:119], v31 offset:5120
    v_mfma_f32_32x32x16_bf16 a[96:111], v[88:91], v[68:71], a[96:111]
    ds_read_b128 v[104:107], v27 offset:8192
    s_add_u32 m0, s48, 0
    s_nop 0
    buffer_load_dwordx4 v8, s[12:15], s52 offen lds
    v_mfma_f32_32x32x16_bf16 a[112:127], v[92:95], v[68:71], a[112:127]
    ds_read_b64_tr_b16 v[120:121], v32 offset:4096
    v_mfma_f32_32x32x16_bf16 a[128:143], v[80:83], v[72:75], a[128:143]
    ds_read_b64_tr_b16 v[122:123], v32 offset:5120
    v_mfma_f32_32x32x16_bf16 a[144:159], v[84:87], v[72:75], a[144:159]
    ds_read_b128 v[108:111], v27 offset:12288
    buffer_load_dwordx4 v9, s[12:15], s52 offen offset:1024 lds
    v_mfma_f32_32x32x16_bf16 a[160:175], v[88:91], v[72:75], a[160:175]
    ds_read_b64_tr_b16 v[124:125], v33 offset:4096
    v_mfma_f32_32x32x16_bf16 a[176:191], v[92:95], v[72:75], a[176:191]
    ds_read_b64_tr_b16 v[126:127], v33 offset:5120
    buffer_load_dwordx4 v10, s[12:15], s52 offen offset:2048 lds
    v_mfma_f32_32x32x16_bf16 a[192:207], v[80:83], v[76:79], a[192:207]
    v_mfma_f32_32x32x16_bf16 a[208:223], v[84:87], v[76:79], a[208:223]
    buffer_load_dwordx4 v11, s[12:15], s52 offen offset:3072 lds
    v_mfma_f32_32x32x16_bf16 a[224:239], v[88:91], v[76:79], a[224:239]
    v_mfma_f32_32x32x16_bf16 a[240:255], v[92:95], v[76:79], a[240:255]
    s_waitcnt lgkmcnt(0)
    v_mfma_f32_32x32x16_bf16 a[0:15], v[112:115], v[96:99], a[0:15]
    ds_read_b128 v[64:67], v28 offset:0
    s_add_u32 m0, s48, 4096
    s_nop 0
    buffer_load_dwordx4 v12, s[12:15], s52 offen lds
    v_mfma_f32_32x32x16_bf16 a[16:31], v[116:119], v[96:99], a[16:31]
    ds_read_b64_tr_b16 v[80:81], v30 offset:8192
    v_mfma_f32_32x32x16_bf16 a[32:47], v[120:123], v[96:99], a[32:47]
    ds_read_b64_tr_b16 v[82:83], v30 offset:9216
    buffer_load_dwordx4 v13, s[12:15], s52 offen offset:1024 lds
    v_mfma_f32_32x32x16_bf16 a[48:63], v[124:127], v[96:99], a[48:63]
    ds_read_b128 v[68:71], v28 offset:4096
    v_mfma_f32_32x32x16_bf16 a[64:79], v[112:115], v[100:103], a[64:79]
    ds_read_b64_tr_b16 v[84:85], v31 offset:8192
    v_mfma_f32_32x32x16_bf16 a[80:95], v[116:119], v[100:103], a[80:95]
    ds_read_b64_tr_b16 v[86:87], v31 offset:9216
    buffer_load_dwordx4 v14, s[12:15], s52 offen offset:2048 lds
    v_mfma_f32_32x32x16_bf16 a[96:111], v[120:123], v[100:103], a[96:111]
    ds_read_b128 v[72:75], v28 offset:8192
    v_mfma_f32_32x32x16_bf16 a[112:127], v[124:127], v[100:103], a[112:127]
    ds_read_b64_tr_b16 v[88:89], v32 offset:8192
    v_mfma_f32_32x32x16_bf16 a[128:143], v[112:115], v[104:107], a[128:143]
    ds_read_b64_tr_b16 v[90:91], v32 offset:9216
    buffer_load_dwordx4 v15, s[12:15], s52 offen offset:3072 lds
    v_mfma_f32_32x32x16_bf16 a[144:159], v[116:119], v[104:107], a[144:159]
    ds_read_b128 v[76:79], v28 offset:12288
    v_mfma_f32_32x32x16_bf16 a[160:175], v[120:123], v[104:107], a[160:175]
    ds_read_b64_tr_b16 v[92:93], v33 offset:8192
    s_add_u32 s52, s52, 128
    s_add_u32 s53, s53, 524288
    v_mfma_f32_32x32x16_bf16 a[176:191], v[124:127], v[104:107], a[176:191]
    ds_read_b64_tr_b16 v[94:95], v33 offset:9216
    v_mfma_f32_32x32x16_bf16 a[192:207], v[112:115], v[108:111], a[192:207]
    v_mfma_f32_32x32x16_bf16 a[208:223], v[116:119], v[108:111], a[208:223]
    s_xor_b32 s48, s48, 0x10000
    s_xor_b32 s49, s49, 0x10000
    s_xor_b32 s50, s50, 0x10000
    s_xor_b32 s51, s51, 0x10000
    v_mfma_f32_32x32x16_bf16 a[224:239], v[120:123], v[108:111], a[224:239]
    v_mfma_f32_32x32x16_bf16 a[240:255], v[124:127], v[108:111], a[240:255]
    s_waitcnt lgkmcnt(0)
    s_cmp_eq_u32 s57, 4
    s_cbranch_scc0 K1_nosw_K
    s_mov_b32 s96, s8
    s_mov_b32 s4, s24
    s_mov_b32 s97, s9
    s_mov_b32 s5, s25
    s_mov_b32 s98, s10
    s_mov_b32 s6, s26
    s_mov_b32 s99, s11
    s_mov_b32 s7, s27
    v_add_u32 v56, 0xfffffc00, v56
    v_mov_b32 v57, v58
K1_nosw_K:
    v_mfma_f32_32x32x16_bf16 a[0:15], v[80:83], v[64:67], a[0:15]
    ds_read_b128 v[96:99], v29 offset:0
    buffer_load_dword v60, v56, s[96:99], 0 offen
    buffer_load_dword v61, v57, s[4:7], 0 offen
    v_add_u32 v56, 128, v56
    v_add_u32 v57, 524288, v57
    v_mfma_f32_32x32x16_bf16 a[16:31], v[84:87], v[64:67], a[16:31]
    ds_read_b64_tr_b16 v[112:113], v30 offset:12288
    v_mfma_f32_32x32x16_bf16 a[32:47], v[88:91], v[64:67], a[32:47]
    ds_read_b64_tr_b16 v[114:115], v30 offset:13312
    v_mfma_f32_32x32x16_bf16 a[48:63], v[92:95], v[64:67], a[48:63]
    ds_read_b128 v[100:103], v29 offset:4096
    v_mfma_f32_32x32x16_bf16 a[64:79], v[80:83], v[68:71], a[64:79]
    ds_read_b64_tr_b16 v[116:117], v31 offset:12288
    buffer_load_dword v60, v56, s[96:99], 0 offen
    buffer_load_dword v61, v57, s[4:7], 0 offen
    v_add_u32 v56, 128, v56
    v_add_u32 v57, 524288, v57
    v_mfma_f32_32x32x16_bf16 a[80:95], v[84:87], v[68:71], a[80:95]
    ds_read_b64_tr_b16 v[118:119], v31 offset:13312
    v_mfma_f32_32x32x16_bf16 a[96:111], v[88:91], v[68:71], a[96:111]
    ds_read_b128 v[104:107], v29 offset:8192
    v_mfma_f32_32x32x16_bf16 a[112:127], v[92:95], v[68:71], a[112:127]
    ds_read_b64_tr_b16 v[120:121], v32 offset:12288
    v_mfma_f32_32x32x16_bf16 a[128:143], v[80:83], v[72:75], a[128:143]
    ds_read_b64_tr_b16 v[122:123], v32 offset:13312
    v_mfma_f32_32x32x16_bf16 a[144:159], v[84:87], v[72:75], a[144:159]
    ds_read_b128 v[108:111], v29 offset:12288
    v_mfma_f32_32x32x16_bf16 a[160:175], v[88:91], v[72:75], a[160:175]
    ds_read_b64_tr_b16 v[124:125], v33 offset:12288
    v_mfma_f32_32x32x16_bf16 a[176:191], v[92:95], v[72:75], a[176:191]
    ds_read_b64_tr_b16 v[126:127], v33 offset:13312
    v_mfma_f32_32x32x16_bf16 a[192:207], v[80:83], v[76:79], a[192:207]
    v_mfma_f32_32x32x16_bf16 a[208:223], v[84:87], v[76:79], a[208:223]
    v_mfma_f32_32x32x16_bf16 a[224:239], v[88:91], v[76:79], a[224:239]
    v_mfma_f32_32x32x16_bf16 a[240:255], v[92:95], v[76:79], a[240:255]
    s_waitcnt lgkmcnt(0)
    v_mfma_f32_32x32x16_bf16 a[0:15], v[112:115], v[96:99], a[0:15]
    v_mfma_f32_32x32x16_bf16 a[16:31], v[116:119], v[96:99], a[16:31]
    s_waitcnt vmcnt(4)
    s_barrier
    v_mfma_f32_32x32x16_bf16 a[32:47], v[120:123], v[96:99], a[32:47]
    v_xor_b32 v26, 0x10000, v26
    v_xor_b32 v27, 0x10000, v27
    v_xor_b32 v28, 0x10000, v28
    v_xor_b32 v29, 0x10000, v29
    v_xor_b32 v30, 0x10000, v30
    v_xor_b32 v31, 0x10000, v31
    v_xor_b32 v32, 0x10000, v32
    v_xor_b32 v33, 0x10000, v33
    v_mfma_f32_32x32x16_bf16 a[48:63], v[124:127], v[96:99], a[48:63]
    ds_read_b128 v[64:67], v26 offset:0
    ds_read_b64_tr_b16 v[80:81], v30 offset:0
    s_add_u32 m0, s49, 0
    s_nop 0
    buffer_load_dwordx4 v16, s[16:19], s53 offen lds
    v_mfma_f32_32x32x16_bf16 a[64:79], v[112:115], v[100:103], a[64:79]
    ds_read_b64_tr_b16 v[82:83], v30 offset:1024
    v_mfma_f32_32x32x16_bf16 a[80:95], v[116:119], v[100:103], a[80:95]
    ds_read_b128 v[68:71], v26 offset:4096
    buffer_load_dwordx4 v17, s[16:19], s53 offen offset:1024 lds
    v_mfma_f32_32x32x16_bf16 a[96:111], v[120:123], v[100:103], a[96:111]
    ds_read_b64_tr_b16 v[84:85], v31 offset:0
    v_mfma_f32_32x32x16_bf16 a[112:127], v[124:127], v[100:103], a[112:127]
    ds_read_b64_tr_b16 v[86:87], v31 offset:1024
    v_mfma_f32_32x32x16_bf16 a[128:143], v[112:115], v[104:107], a[128:143]
    ds_read_b128 v[72:75], v26 offset:8192
    buffer_load_dwordx4 v18, s[16:19], s53 offen offset:2048 lds
    v_mfma_f32_32x32x16_bf16 a[144:159], v[116:119], v[104:107], a[144:159]
    ds_read_b64_tr_b16 v[88:89], v32 offset:0
    v_mfma_f32_32x32x16_bf16 a[160:175], v[120:123], v[104:107], a[160:175]
    ds_read_b64_tr_b16 v[90:91], v32 offset:1024
    buffer_load_dwordx4 v19, s[16:19], s53 offen offset:3072 lds
    v_mfma_f32_32x32x16_bf16 a[176:191], v[124:127], v[104:107], a[176:191]
    ds_read_b128 v[76:79], v26 offset:12288
    v_mfma_f32_32x32x16_bf16 a[192:207], v[112:115], v[108:111], a[192:207]
    ds_read_b64_tr_b16 v[92:93], v33 offset:0
    v_mfma_f32_32x32x16_bf16 a[208:223], v[116:119], v[108:111], a[208:223]
    ds_read_b64_tr_b16 v[94:95], v33 offset:1024
    s_add_u32 m0, s49, 4096
    s_nop 0
    buffer_load_dwordx4 v20, s[16:19], s53 offen lds
    v_mfma_f32_32x32x16_bf16 a[224:239], v[120:123], v[108:111], a[224:239]
    v_mfma_f32_32x32x16_bf16 a[240:255], v[124:127], v[108:111], a[240:255]
    s_sub_u32 s57, s57, 1
    s_cmp_lg_u32 s57, 0
    s_cbranch_scc1 K1_p1loop_K
    s_waitcnt lgkmcnt(0)
    v_mfma_f32_32x32x16_bf16 a[0:15], v[80:83], v[64:67], a[0:15]
    ds_read_b128 v[96:99], v27 offset:0
    buffer_load_dwordx4 v21, s[16:19], s53 offen offset:1024 lds
    v_mfma_f32_32x32x16_bf16 a[16:31], v[84:87], v[64:67], a[16:31]
    ds_read_b64_tr_b16 v[112:113], v30 offset:4096
    v_mfma_f32_32x32x16_bf16 a[32:47], v[88:91], v[64:67], a[32:47]
    ds_read_b64_tr_b16 v[114:115], v30 offset:5120
    buffer_load_dwordx4 v22, s[16:19], s53 offen offset:2048 lds
    v_mfma_f32_32x32x16_bf16 a[48:63], v[92:95], v[64:67], a[48:63]
    ds_read_b128 v[100:103], v27 offset:4096
    v_mfma_f32_32x32x16_bf16 a[64:79], v[80:83], v[68:71], a[64:79]
    ds_read_b64_tr_b16 v[116:117], v31 offset:4096
    buffer_load_dwordx4 v23, s[16:19], s53 offen offset:3072 lds
    v_mfma_f32_32x32x16_bf16 a[80:95], v[84:87], v[68:71], a[80:95]
    ds_read_b64_tr_b16 v[118:119], v31 offset:5120
    v_mfma_f32_32x32x16_bf16 a[96:111], v[88:91], v[68:71], a[96:111]
    ds_read_b128 v[104:107], v27 offset:8192
    s_add_u32 m0, s48, 0
    s_nop 0
    buffer_load_dwordx4 v8, s[12:15], s52 offen lds
    v_mfma_f32_32x32x16_bf16 a[112:127], v[92:95], v[68:71], a[112:127]
    ds_read_b64_tr_b16 v[120:121], v32 offset:4096
    v_mfma_f32_32x32x16_bf16 a[128:143], v[80:83], v[72:75], a[128:143]
    ds_read_b64_tr_b16 v[122:123], v32 offset:5120
    v_mfma_f32_32x32x16_bf16 a[144:159], v[84:87], v[72:75], a[144:159]
    ds_read_b128 v[108:111], v27 offset:12288
    buffer_load_dwordx4 v9, s[12:15], s52 offen offset:1024 lds
    v_mfma_f32_32x32x16_bf16 a[160:175], v[88:91], v[72:75], a[160:175]
    ds_read_b64_tr_b16 v[124:125], v33 offset:4096
    v_mfma_f32_32x32x16_bf16 a[176:191], v[92:95], v[72:75], a[176:191]
    ds_read_b64_tr_b16 v[126:127], v33 offset:5120
    buffer_load_dwordx4 v10, s[12:15], s52 offen offset:2048 lds
    v_mfma_f32_32x32x16_bf16 a[192:207], v[80:83], v[76:79], a[192:207]
    v_mfma_f32_32x32x16_bf16 a[208:223], v[84:87], v[76:79], a[208:223]
    buffer_load_dwordx4 v11, s[12:15], s52 offen offset:3072 lds
    v_mfma_f32_32x32x16_bf16 a[224:239], v[88:91], v[76:79], a[224:239]
    v_mfma_f32_32x32x16_bf16 a[240:255], v[92:95], v[76:79], a[240:255]
    s_waitcnt lgkmcnt(0)
    v_mfma_f32_32x32x16_bf16 a[0:15], v[112:115], v[96:99], a[0:15]
    ds_read_b128 v[64:67], v28 offset:0
    s_add_u32 m0, s48, 4096
    s_nop 0
    buffer_load_dwordx4 v12, s[12:15], s52 offen lds
    v_mfma_f32_32x32x16_bf16 a[16:31], v[116:119], v[96:99], a[16:31]
    ds_read_b64_tr_b16 v[80:81], v30 offset:8192
    v_mfma_f32_32x32x16_bf16 a[32:47], v[120:123], v[96:99], a[32:47]
    ds_read_b64_tr_b16 v[82:83], v30 offset:9216
    buffer_load_dwordx4 v13, s[12:15], s52 offen offset:1024 lds
    v_mfma_f32_32x32x16_bf16 a[48:63], v[124:127], v[96:99], a[48:63]
    ds_read_b128 v[68:71], v28 offset:4096
    v_mfma_f32_32x32x16_bf16 a[64:79], v[112:115], v[100:103], a[64:79]
    ds_read_b64_tr_b16 v[84:85], v31 offset:8192
    v_mfma_f32_32x32x16_bf16 a[80:95], v[116:119], v[100:103], a[80:95]
    ds_read_b64_tr_b16 v[86:87], v31 offset:9216
    buffer_load_dwordx4 v14, s[12:15], s52 offen offset:2048 lds
    v_mfma_f32_32x32x16_bf16 a[96:111], v[120:123], v[100:103], a[96:111]
    ds_read_b128 v[72:75], v28 offset:8192
    v_mfma_f32_32x32x16_bf16 a[112:127], v[124:127], v[100:103], a[112:127]
    ds_read_b64_tr_b16 v[88:89], v32 offset:8192
    v_mfma_f32_32x32x16_bf16 a[128:143], v[112:115], v[104:107], a[128:143]
    ds_read_b64_tr_b16 v[90:91], v32 offset:9216
    buffer_load_dwordx4 v15, s[12:15], s52 offen offset:3072 lds
    v_mfma_f32_32x32x16_bf16 a[144:159], v[116:119], v[104:107], a[144:159]
    ds_read_b128 v[76:79], v28 offset:12288
    v_mfma_f32_32x32x16_bf16 a[160:175], v[120:123], v[104:107], a[160:175]
    ds_read_b64_tr_b16 v[92:93], v33 offset:8192
    s_add_u32 s52, s52, 128
    s_add_u32 s53, s53, 524288
    v_mfma_f32_32x32x16_bf16 a[176:191], v[124:127], v[104:107], a[176:191]
    ds_read_b64_tr_b16 v[94:95], v33 offset:9216
    v_mfma_f32_32x32x16_bf16 a[192:207], v[112:115], v[108:111], a[192:207]
    v_mfma_f32_32x32x16_bf16 a[208:223], v[116:119], v[108:111], a[208:223]
    s_xor_b32 s48, s48, 0x10000
    s_xor_b32 s49, s49, 0x10000
    s_xor_b32 s50, s50, 0x10000
    s_xor_b32 s51, s51, 0x10000
    v_mfma_f32_32x32x16_bf16 a[224:239], v[120:123], v[108:111], a[224:239]
    v_mfma_f32_32x32x16_bf16 a[240:255], v[124:127], v[108:111], a[240:255]
    s_waitcnt lgkmcnt(0)
    v_mfma_f32_32x32x16_bf16 a[0:15], v[80:83], v[64:67], a[0:15]
    ds_read_b128 v[96:99], v29 offset:0
    v_mfma_f32_32x32x16_bf16 a[16:31], v[84:87], v[64:67], a[16:31]
    ds_read_b64_tr_b16 v[112:113], v30 offset:12288
    v_mfma_f32_32x32x16_bf16 a[32:47], v[88:91], v[64:67], a[32:47]
    ds_read_b64_tr_b16 v[114:115], v30 offset:13312
    v_mfma_f32_32x32x16_bf16 a[48:63], v[92:95], v[64:67], a[48:63]
    ds_read_b128 v[100:103], v29 offset:4096
    v_mfma_f32_32x32x16_bf16 a[64:79], v[80:83], v[68:71], a[64:79]
    ds_read_b64_tr_b16 v[116:117], v31 offset:12288
    v_mfma_f32_32x32x16_bf16 a[80:95], v[84:87], v[68:71], a[80:95]
    ds_read_b64_tr_b16 v[118:119], v31 offset:13312
    v_mfma_f32_32x32x16_bf16 a[96:111], v[88:91], v[68:71], a[96:111]
    ds_read_b128 v[104:107], v29 offset:8192
    v_mfma_f32_32x32x16_bf16 a[112:127], v[92:95], v[68:71], a[112:127]
    ds_read_b64_tr_b16 v[120:121], v32 offset:12288
    v_mfma_f32_32x32x16_bf16 a[128:143], v[80:83], v[72:75], a[128:143]
    ds_read_b64_tr_b16 v[122:123], v32 offset:13312
    v_mfma_f32_32x32x16_bf16 a[144:159], v[84:87], v[72:75], a[144:159]
    ds_read_b128 v[108:111], v29 offset:12288
    v_mfma_f32_32x32x16_bf16 a[160:175], v[88:91], v[72:75], a[160:175]
    ds_read_b64_tr_b16 v[124:125], v33 offset:12288
    v_mfma_f32_32x32x16_bf16 a[176:191], v[92:95], v[72:75], a[176:191]
    ds_read_b64_tr_b16 v[126:127], v33 offset:13312
    v_mfma_f32_32x32x16_bf16 a[192:207], v[80:83], v[76:79], a[192:207]
    v_mfma_f32_32x32x16_bf16 a[208:223], v[84:87], v[76:79], a[208:223]
    v_mfma_f32_32x32x16_bf16 a[224:239], v[88:91], v[76:79], a[224:239]
    v_mfma_f32_32x32x16_bf16 a[240:255], v[92:95], v[76:79], a[240:255]
    s_waitcnt lgkmcnt(0)
    v_mfma_f32_32x32x16_bf16 a[0:15], v[112:115], v[96:99], a[0:15]
    v_mfma_f32_32x32x16_bf16 a[16:31], v[116:119], v[96:99], a[16:31]
    s_waitcnt vmcnt(0)
    s_barrier
    v_mfma_f32_32x32x16_bf16 a[32:47], v[120:123], v[96:99], a[32:47]
    v_xor_b32 v26, 0x10000, v26
    v_xor_b32 v27, 0x10000, v27
    v_xor_b32 v28, 0x10000, v28
    v_xor_b32 v29, 0x10000, v29
    v_xor_b32 v30, 0x10000, v30
    v_xor_b32 v31, 0x10000, v31
    v_xor_b32 v32, 0x10000, v32
    v_xor_b32 v33, 0x10000, v33
    v_mfma_f32_32x32x16_bf16 a[48:63], v[124:127], v[96:99], a[48:63]
    ds_read_b128 v[64:67], v26 offset:0
    ds_read_b64_tr_b16 v[80:81], v30 offset:0
    s_mov_b32 m0, s50
    s_nop 0
    buffer_load_dwordx4 v16, s[24:27], s55 offen lds
    v_mfma_f32_32x32x16_bf16 a[64:79], v[112:115], v[100:103], a[64:79]
    ds_read_b64_tr_b16 v[82:83], v30 offset:1024
    v_mfma_f32_32x32x16_bf16 a[80:95], v[116:119], v[100:103], a[80:95]
    ds_read_b128 v[68:71], v26 offset:4096
    v_mfma_f32_32x32x16_bf16 a[96:111], v[120:123], v[100:103], a[96:111]
    ds_read_b64_tr_b16 v[84:85], v31 offset:0
    buffer_load_dwordx4 v17, s[24:27], s55 offen offset:1024 lds
    v_mfma_f32_32x32x16_bf16 a[112:127], v[124:127], v[100:103], a[112:127]
    ds_read_b64_tr_b16 v[86:87], v31 offset:1024
    v_mfma_f32_32x32x16_bf16 a[128:143], v[112:115], v[104:107], a[128:143]
    ds_read_b128 v[72:75], v26 offset:8192
    v_mfma_f32_32x32x16_bf16 a[144:159], v[116:119], v[104:107], a[144:159]
    ds_read_b64_tr_b16 v[88:89], v32 offset:0
    buffer_load_dwordx4 v18, s[24:27], s55 offen offset:2048 lds
    v_mfma_f32_32x32x16_bf16 a[160:175], v[120:123], v[104:107], a[160:175]
    ds_read_b64_tr_b16 v[90:91], v32 offset:1024
    v_mfma_f32_32x32x16_bf16 a[176:191], v[124:127], v[104:107], a[176:191]
    ds_read_b128 v[76:79], v26 offset:12288
    v_mfma_f32_32x32x16_bf16 a[192:207], v[112:115], v[108:111], a[192:207]
    ds_read_b64_tr_b16 v[92:93], v33 offset:0
    buffer_load_dwordx4 v19, s[24:27], s55 offen offset:3072 lds
    v_mfma_f32_32x32x16_bf16 a[208:223], v[116:119], v[108:111], a[208:223]
    ds_read_b64_tr_b16 v[94:95], v33 offset:1024
    v_mfma_f32_32x32x16_bf16 a[224:239], v[120:123], v[108:111], a[224:239]
    v_mfma_f32_32x32x16_bf16 a[240:255], v[124:127], v[108:111], a[240:255]
    s_waitcnt lgkmcnt(0)
    v_mfma_f32_32x32x16_bf16 a[0:15], v[80:83], v[64:67], a[0:15]
    ds_read_b128 v[96:99], v27 offset:0
    s_mov_b32 m0, s51
    s_nop 0
    buffer_load_dwordx4 v24, s[28:31], s56 offen lds
    v_mfma_f32_32x32x16_bf16 a[16:31], v[84:87], v[64:67], a[16:31]
    ds_read_b64_tr_b16 v[112:113], v30 offset:4096
    v_mfma_f32_32x32x16_bf16 a[32:47], v[88:91], v[64:67], a[32:47]
    ds_read_b64_tr_b16 v[114:115], v30 offset:5120
    buffer_load_dwordx4 v25, s[28:31], s56 offen offset:1024 lds
    v_mfma_f32_32x32x16_bf16 a[48:63], v[92:95], v[64:67], a[48:63]
    ds_read_b128 v[100:103], v27 offset:4096
    v_mfma_f32_32x32x16_bf16 a[64:79], v[80:83], v[68:71], a[64:79]
    ds_read_b64_tr_b16 v[116:117], v31 offset:4096
    v_mfma_f32_32x32x16_bf16 a[80:95], v[84:87], v[68:71], a[80:95]
    ds_read_b64_tr_b16 v[118:119], v31 offset:5120
    s_add_u32 m0, s48, 0
    s_nop 0
    buffer_load_dwordx4 v8, s[8:11], s54 offen lds
    v_mfma_f32_32x32x16_bf16 a[96:111], v[88:91], v[68:71], a[96:111]
    ds_read_b128 v[104:107], v27 offset:8192
    v_mfma_f32_32x32x16_bf16 a[112:127], v[92:95], v[68:71], a[112:127]
    ds_read_b64_tr_b16 v[120:121], v32 offset:4096
    v_mfma_f32_32x32x16_bf16 a[128:143], v[80:83], v[72:75], a[128:143]
    ds_read_b64_tr_b16 v[122:123], v32 offset:5120
    buffer_load_dwordx4 v9, s[8:11], s54 offen offset:1024 lds
    v_mfma_f32_32x32x16_bf16 a[144:159], v[84:87], v[72:75], a[144:159]
    ds_read_b128 v[108:111], v27 offset:12288
    v_mfma_f32_32x32x16_bf16 a[160:175], v[88:91], v[72:75], a[160:175]
    ds_read_b64_tr_b16 v[124:125], v33 offset:4096
    buffer_load_dwordx4 v10, s[8:11], s54 offen offset:2048 lds
    v_mfma_f32_32x32x16_bf16 a[176:191], v[92:95], v[72:75], a[176:191]
    ds_read_b64_tr_b16 v[126:127], v33 offset:5120
    v_mfma_f32_32x32x16_bf16 a[192:207], v[80:83], v[76:79], a[192:207]
    v_mfma_f32_32x32x16_bf16 a[208:223], v[84:87], v[76:79], a[208:223]
    buffer_load_dwordx4 v11, s[8:11], s54 offen offset:3072 lds
    v_mfma_f32_32x32x16_bf16 a[224:239], v[88:91], v[76:79], a[224:239]
    v_mfma_f32_32x32x16_bf16 a[240:255], v[92:95], v[76:79], a[240:255]
    s_waitcnt lgkmcnt(0)
    v_mfma_f32_32x32x16_bf16 a[0:15], v[112:115], v[96:99], a[0:15]
    ds_read_b128 v[64:67], v28 offset:0
    s_add_u32 m0, s48, 4096
    s_nop 0
    buffer_load_dwordx4 v12, s[8:11], s54 offen lds
    v_mfma_f32_32x32x16_bf16 a[16:31], v[116:119], v[96:99], a[16:31]
    ds_read_b64_tr_b16 v[80:81], v30 offset:8192
    v_mfma_f32_32x32x16_bf16 a[32:47], v[120:123], v[96:99], a[32:47]
    ds_read_b64_tr_b16 v[82:83], v30 offset:9216
    buffer_load_dwordx4 v13, s[8:11], s54 offen offset:1024 lds
    v_mfma_f32_32x32x16_bf16 a[48:63], v[124:127], v[96:99], a[48:63]
    ds_read_b128 v[68:71], v28 offset:4096
    v_mfma_f32_32x32x16_bf16 a[64:79], v[112:115], v[100:103], a[64:79]
    ds_read_b64_tr_b16 v[84:85], v31 offset:8192
    v_mfma_f32_32x32x16_bf16 a[80:95], v[116:119], v[100:103], a[80:95]
    ds_read_b64_tr_b16 v[86:87], v31 offset:9216
    buffer_load_dwordx4 v14, s[8:11], s54 offen offset:2048 lds
    v_mfma_f32_32x32x16_bf16 a[96:111], v[120:123], v[100:103], a[96:111]
    ds_read_b128 v[72:75], v28 offset:8192
    v_mfma_f32_32x32x16_bf16 a[112:127], v[124:127], v[100:103], a[112:127]
    ds_read_b64_tr_b16 v[88:89], v32 offset:8192
    v_mfma_f32_32x32x16_bf16 a[128:143], v[112:115], v[104:107], a[128:143]
    ds_read_b64_tr_b16 v[90:91], v32 offset:9216
    buffer_load_dwordx4 v15, s[8:11], s54 offen offset:3072 lds
    v_mfma_f32_32x32x16_bf16 a[144:159], v[116:119], v[104:107], a[144:159]
    ds_read_b128 v[76:79], v28 offset:12288
    v_mfma_f32_32x32x16_bf16 a[160:175], v[120:123], v[104:107], a[160:175]
    ds_read_b64_tr_b16 v[92:93], v33 offset:8192
    s_add_u32 s54, s54, 128
    s_add_u32 s55, s55, 524288
    s_add_u32 s56, s56, 196608
    v_mfma_f32_32x32x16_bf16 a[176:191], v[124:127], v[104:107], a[176:191]
    ds_read_b64_tr_b16 v[94:95], v33 offset:9216
    v_mfma_f32_32x32x16_bf16 a[192:207], v[112:115], v[108:111], a[192:207]
    v_mfma_f32_32x32x16_bf16 a[208:223], v[116:119], v[108:111], a[208:223]
    s_xor_b32 s48, s48, 0x10000
    s_xor_b32 s49, s49, 0x10000
    s_xor_b32 s50, s50, 0x10000
    s_xor_b32 s51, s51, 0x10000
    v_mfma_f32_32x32x16_bf16 a[224:239], v[120:123], v[108:111], a[224:239]
    v_mfma_f32_32x32x16_bf16 a[240:255], v[124:127], v[108:111], a[240:255]
    s_waitcnt lgkmcnt(0)
    v_mfma_f32_32x32x16_bf16 a[0:15], v[80:83], v[64:67], a[0:15]
    ds_read_b128 v[96:99], v29 offset:0
    v_mfma_f32_32x32x16_bf16 a[16:31], v[84:87], v[64:67], a[16:31]
    ds_read_b64_tr_b16 v[112:113], v30 offset:12288
    v_mfma_f32_32x32x16_bf16 a[32:47], v[88:91], v[64:67], a[32:47]
    ds_read_b64_tr_b16 v[114:115], v30 offset:13312
    v_mfma_f32_32x32x16_bf16 a[48:63], v[92:95], v[64:67], a[48:63]
    ds_read_b128 v[100:103], v29 offset:4096
    v_mfma_f32_32x32x16_bf16 a[64:79], v[80:83], v[68:71], a[64:79]
    ds_read_b64_tr_b16 v[116:117], v31 offset:12288
    v_mfma_f32_32x32x16_bf16 a[80:95], v[84:87], v[68:71], a[80:95]
    ds_read_b64_tr_b16 v[118:119], v31 offset:13312
    v_mfma_f32_32x32x16_bf16 a[96:111], v[88:91], v[68:71], a[96:111]
    ds_read_b128 v[104:107], v29 offset:8192
    v_mfma_f32_32x32x16_bf16 a[112:127], v[92:95], v[68:71], a[112:127]
    ds_read_b64_tr_b16 v[120:121], v32 offset:12288
    v_mfma_f32_32x32x16_bf16 a[128:143], v[80:83], v[72:75], a[128:143]
    ds_read_b64_tr_b16 v[122:123], v32 offset:13312
    v_mfma_f32_32x32x16_bf16 a[144:159], v[84:87], v[72:75], a[144:159]
    ds_read_b128 v[108:111], v29 offset:12288
    v_mfma_f32_32x32x16_bf16 a[160:175], v[88:91], v[72:75], a[160:175]
    ds_read_b64_tr_b16 v[124:125], v33 offset:12288
    v_mfma_f32_32x32x16_bf16 a[176:191], v[92:95], v[72:75], a[176:191]
    ds_read_b64_tr_b16 v[126:127], v33 offset:13312
    v_mfma_f32_32x32x16_bf16 a[192:207], v[80:83], v[76:79], a[192:207]
    v_mfma_f32_32x32x16_bf16 a[208:223], v[84:87], v[76:79], a[208:223]
    v_mfma_f32_32x32x16_bf16 a[224:239], v[88:91], v[76:79], a[224:239]
    v_mfma_f32_32x32x16_bf16 a[240:255], v[92:95], v[76:79], a[240:255]
    s_waitcnt lgkmcnt(0)
    v_mfma_f32_32x32x16_bf16 a[0:15], v[112:115], v[96:99], a[0:15]
    v_mfma_f32_32x32x16_bf16 a[16:31], v[116:119], v[96:99], a[16:31]
    s_waitcnt vmcnt(0)
    s_barrier
    v_mfma_f32_32x32x16_bf16 a[32:47], v[120:123], v[96:99], a[32:47]
    s_mov_b32 m0, s50
    s_nop 0
    buffer_load_dwordx4 v16, s[24:27], s55 offen lds
    buffer_load_dwordx4 v17, s[24:27], s55 offen offset:1024 lds
    v_mfma_f32_32x32x16_bf16 a[48:63], v[124:127], v[96:99], a[48:63]
    buffer_load_dwordx4 v18, s[24:27], s55 offen offset:2048 lds
    v_mfma_f32_32x32x16_bf16 a[64:79], v[112:115], v[100:103], a[64:79]
    buffer_load_dwordx4 v19, s[24:27], s55 offen offset:3072 lds
    v_mfma_f32_32x32x16_bf16 a[80:95], v[116:119], v[100:103], a[80:95]
    s_mov_b32 m0, s51
    s_nop 0
    buffer_load_dwordx4 v24, s[28:31], s56 offen lds
    v_mfma_f32_32x32x16_bf16 a[96:111], v[120:123], v[100:103], a[96:111]
    buffer_load_dwordx4 v25, s[28:31], s56 offen offset:1024 lds
    v_mfma_f32_32x32x16_bf16 a[112:127], v[124:127], v[100:103], a[112:127]
    s_add_u32 m0, s48, 0
    s_nop 0
    buffer_load_dwordx4 v8, s[8:11], s54 offen lds
    v_mfma_f32_32x32x16_bf16 a[128:143], v[112:115], v[104:107], a[128:143]
    buffer_load_dwordx4 v9, s[8:11], s54 offen offset:1024 lds
    v_mfma_f32_32x32x16_bf16 a[144:159], v[116:119], v[104:107], a[144:159]
    buffer_load_dwordx4 v10, s[8:11], s54 offen offset:2048 lds
    buffer_load_dwordx4 v11, s[8:11], s54 offen offset:3072 lds
    v_mfma_f32_32x32x16_bf16 a[160:175], v[120:123], v[104:107], a[160:175]
    s_add_u32 m0, s48, 4096
    s_nop 0
    buffer_load_dwordx4 v12, s[8:11], s54 offen lds
    v_mfma_f32_32x32x16_bf16 a[176:191], v[124:127], v[104:107], a[176:191]
    buffer_load_dwordx4 v13, s[8:11], s54 offen offset:1024 lds
    v_mfma_f32_32x32x16_bf16 a[192:207], v[112:115], v[108:111], a[192:207]
    buffer_load_dwordx4 v14, s[8:11], s54 offen offset:2048 lds
    v_mfma_f32_32x32x16_bf16 a[208:223], v[116:119], v[108:111], a[208:223]
    buffer_load_dwordx4 v15, s[8:11], s54 offen offset:3072 lds
    v_mfma_f32_32x32x16_bf16 a[224:239], v[120:123], v[108:111], a[224:239]
    s_add_u32 s54, s54, 128
    s_add_u32 s55, s55, 524288
    s_add_u32 s56, s56, 196608
    v_mfma_f32_32x32x16_bf16 a[240:255], v[124:127], v[108:111], a[240:255]
    s_xor_b32 s48, s48, 0x10000
    s_xor_b32 s49, s49, 0x10000
    s_xor_b32 s50, s50, 0x10000
    s_xor_b32 s51, s51, 0x10000
    s_and_b32 s58, s46, 1
    s_cmp_eq_u32 s58, 0
    s_cselect_b32 s58, s61, s62
    s_lshl_b32 s58, s58, 16
    s_lshl_b32 s59, s44, 20
    s_add_u32 s58, s58, s59
    v_lshlrev_b32 v7, 4, v0
    s_add_u32 s76, s58, 0
    s_add_u32 s77, s58, 1024
    s_add_u32 s78, s58, 2048
    s_add_u32 s79, s58, 3072
    s_add_u32 s80, s58, 4096
    s_add_u32 s81, s58, 5120
    s_add_u32 s82, s58, 6144
    s_add_u32 s83, s58, 7168
    s_branch K1_pass2
K1_roleV:
    s_waitcnt lgkmcnt(0)
    v_mfma_f32_32x32x16_bf16 a[0:15], v[64:67], v[80:83], a[0:15]
    ds_read_b128 v[96:99], v27 offset:0
    v_mfma_f32_32x32x16_bf16 a[16:31], v[64:67], v[84:87], a[16:31]
    ds_read_b64_tr_b16 v[112:113], v30 offset:4096
    v_mfma_f32_32x32x16_bf16 a[32:47], v[64:67], v[88:91], a[32:47]
    ds_read_b64_tr_b16 v[114:115], v30 offset:5120
    v_mfma_f32_32x32x16_bf16 a[48:63], v[64:67], v[92:95], a[48:63]
    ds_read_b128 v[100:103], v27 offset:4096
    v_mfma_f32_32x32x16_bf16 a[64:79], v[68:71], v[80:83], a[64:79]
    ds_read_b64_tr_b16 v[116:117], v31 offset:4096
    v_mfma_f32_32x32x16_bf16 a[80:95], v[68:71], v[84:87], a[80:95]
    ds_read_b64_tr_b16 v[118:119], v31 offset:5120
    v_mfma_f32_32x32x16_bf16 a[96:111], v[68:71], v[88:91], a[96:111]
    ds_read_b128 v[104:107], v27 offset:8192
    v_mfma_f32_32x32x16_bf16 a[112:127], v[68:71], v[92:95], a[112:127]
    ds_read_b64_tr_b16 v[120:121], v32 offset:4096
    v_mfma_f32_32x32x16_bf16 a[128:143], v[72:75], v[80:83], a[128:143]
    ds_read_b64_tr_b16 v[122:123], v32 offset:5120
    v_mfma_f32_32x32x16_bf16 a[144:159], v[72:75], v[84:87], a[144:159]
    ds_read_b128 v[108:111], v27 offset:12288
    v_mfma_f32_32x32x16_bf16 a[160:175], v[72:75], v[88:91], a[160:175]
    ds_read_b64_tr_b16 v[124:125], v33 offset:4096
    v_mfma_f32_32x32x16_bf16 a[176:191], v[72:75], v[92:95], a[176:191]
    ds_read_b64_tr_b16 v[126:127], v33 offset:5120
    v_mfma_f32_32x32x16_bf16 a[192:207], v[76:79], v[80:83], a[192:207]
    v_mfma_f32_32x32x16_bf16 a[208:223], v[76:79], v[84:87], a[208:223]
    v_mfma_f32_32x32x16_bf16 a[224:239], v[76:79], v[88:91], a[224:239]
    v_mfma_f32_32x32x16_bf16 a[240:255], v[76:79], v[92:95], a[240:255]
    s_waitcnt lgkmcnt(0)
    v_mfma_f32_32x32x16_bf16 a[0:15], v[96:99], v[112:115], a[0:15]
    ds_read_b128 v[64:67], v28 offset:0
    v_mfma_f32_32x32x16_bf16 a[16:31], v[96:99], v[116:119], a[16:31]
    ds_read_b64_tr_b16 v[80:81], v30 offset:8192
    v_mfma_f32_32x32x16_bf16 a[32:47], v[96:99], v[120:123], a[32:47]
    ds_read_b64_tr_b16 v[82:83], v30 offset:9216
    v_mfma_f32_32x32x16_bf16 a[48:63], v[96:99], v[124:127], a[48:63]
    ds_read_b128 v[68:71], v28 offset:4096
    v_mfma_f32_32x32x16_bf16 a[64:79], v[100:103], v[112:115], a[64:79]
    ds_read_b64_tr_b16 v[84:85], v31 offset:8192
    v_mfma_f32_32x32x16_bf16 a[80:95], v[100:103], v[116:119], a[80:95]
    ds_read_b64_tr_b16 v[86:87], v31 offset:9216
    v_mfma_f32_32x32x16_bf16 a[96:111], v[100:103], v[120:123], a[96:111]
    ds_read_b128 v[72:75], v28 offset:8192
    v_mfma_f32_32x32x16_bf16 a[112:127], v[100:103], v[124:127], a[112:127]
    ds_read_b64_tr_b16 v[88:89], v32 offset:8192
    v_mfma_f32_32x32x16_bf16 a[128:143], v[104:107], v[112:115], a[128:143]
    ds_read_b64_tr_b16 v[90:91], v32 offset:9216
    v_mfma_f32_32x32x16_bf16 a[144:159], v[104:107], v[116:119], a[144:159]
    ds_read_b128 v[76:79], v28 offset:12288
    v_mfma_f32_32x32x16_bf16 a[160:175], v[104:107], v[120:123], a[160:175]
    ds_read_b64_tr_b16 v[92:93], v33 offset:8192
    v_mfma_f32_32x32x16_bf16 a[176:191], v[104:107], v[124:127], a[176:191]
    ds_read_b64_tr_b16 v[94:95], v33 offset:9216
    v_mfma_f32_32x32x16_bf16 a[192:207], v[108:111], v[112:115], a[192:207]
    v_mfma_f32_32x32x16_bf16 a[208:223], v[108:111], v[116:119], a[208:223]
    v_mfma_f32_32x32x16_bf16 a[224:239], v[108:111], v[120:123], a[224:239]
    v_mfma_f32_32x32x16_bf16 a[240:255], v[108:111], v[124:127], a[240:255]
    s_waitcnt lgkmcnt(0)
    v_mfma_f32_32x32x16_bf16 a[0:15], v[64:67], v[80:83], a[0:15]
    ds_read_b128 v[96:99], v29 offset:0
    buffer_load_dword v60, v56, s[96:99], 0 offen
    buffer_load_dword v61, v57, s[4:7], 0 offen
    v_add_u32 v56, 128, v56
    v_add_u32 v57, 524288, v57
    v_mfma_f32_32x32x16_bf16 a[16:31], v[64:67], v[84:87], a[16:31]
    ds_read_b64_tr_b16 v[112:113], v30 offset:12288
    v_mfma_f32_32x32x16_bf16 a[32:47], v[64:67], v[88:91], a[32:47]
    ds_read_b64_tr_b16 v[114:115], v30 offset:13312
    v_mfma_f32_32x32x16_bf16 a[48:63], v[64:67], v[92:95], a[48:63]
    ds_read_b128 v[100:103], v29 offset:4096
    v_mfma_f32_32x32x16_bf16 a[64:79], v[68:71], v[80:83], a[64:79]
    ds_read_b64_tr_b16 v[116:117], v31 offset:12288
    buffer_load_dword v60, v56, s[96:99], 0 offen
    buffer_load_dword v61, v57, s[4:7], 0 offen
    v_add_u32 v56, 128, v56
    v_add_u32 v57, 524288, v57
    v_mfma_f32_32x32x16_bf16 a[80:95], v[68:71], v[84:87], a[80:95]
    ds_read_b64_tr_b16 v[118:119], v31 offset:13312
    v_mfma_f32_32x32x16_bf16 a[96:111], v[68:71], v[88:91], a[96:111]
    ds_read_b128 v[104:107], v29 offset:8192
    v_mfma_f32_32x32x16_bf16 a[112:127], v[68:71], v[92:95], a[112:127]
    ds_read_b64_tr_b16 v[120:121], v32 offset:12288
    v_mfma_f32_32x32x16_bf16 a[128:143], v[72:75], v[80:83], a[128:143]
    ds_read_b64_tr_b16 v[122:123], v32 offset:13312
    v_mfma_f32_32x32x16_bf16 a[144:159], v[72:75], v[84:87], a[144:159]
    ds_read_b128 v[108:111], v29 offset:12288
    v_mfma_f32_32x32x16_bf16 a[160:175], v[72:75], v[88:91], a[160:175]
    ds_read_b64_tr_b16 v[124:125], v33 offset:12288
    v_mfma_f32_32x32x16_bf16 a[176:191], v[72:75], v[92:95], a[176:191]
    ds_read_b64_tr_b16 v[126:127], v33 offset:13312
    v_mfma_f32_32x32x16_bf16 a[192:207], v[76:79], v[80:83], a[192:207]
    v_mfma_f32_32x32x16_bf16 a[208:223], v[76:79], v[84:87], a[208:223]
    v_mfma_f32_32x32x16_bf16 a[224:239], v[76:79], v[88:91], a[224:239]
    v_mfma_f32_32x32x16_bf16 a[240:255], v[76:79], v[92:95], a[240:255]
    s_waitcnt lgkmcnt(0)
    v_mfma_f32_32x32x16_bf16 a[0:15], v[96:99], v[112:115], a[0:15]
    v_mfma_f32_32x32x16_bf16 a[16:31], v[96:99], v[116:119], a[16:31]
    s_waitcnt vmcnt(10)
    s_barrier
    v_mfma_f32_32x32x16_bf16 a[32:47], v[96:99], v[120:123], a[32:47]
    v_xor_b32 v26, 0x10000, v26
    v_xor_b32 v27, 0x10000, v27
    v_xor_b32 v28, 0x10000, v28
    v_xor_b32 v29, 0x10000, v29
    v_xor_b32 v30, 0x10000, v30
    v_xor_b32 v31, 0x10000, v31
    v_xor_b32 v32, 0x10000, v32
    v_xor_b32 v33, 0x10000, v33
    v_mfma_f32_32x32x16_bf16 a[48:63], v[96:99], v[124:127], a[48:63]
    ds_read_b128 v[64:67], v26 offset:0
    ds_read_b64_tr_b16 v[80:81], v30 offset:0
    s_add_u32 m0, s49, 0
    s_nop 0
    buffer_load_dwordx4 v16, s[16:19], s53 offen lds
    v_mfma_f32_32x32x16_bf16 a[64:79], v[100:103], v[112:115], a[64:79]
    ds_read_b64_tr_b16 v[82:83], v30 offset:1024
    v_mfma_f32_32x32x16_bf16 a[80:95], v[100:103], v[116:119], a[80:95]
    ds_read_b128 v[68:71], v26 offset:4096
    buffer_load_dwordx4 v17, s[16:19], s53 offen offset:1024 lds
    v_mfma_f32_32x32x16_bf16 a[96:111], v[100:103], v[120:123], a[96:111]
    ds_read_b64_tr_b16 v[84:85], v31 offset:0
    v_mfma_f32_32x32x16_bf16 a[112:127], v[100:103], v[124:127], a[112:127]
    ds_read_b64_tr_b16 v[86:87], v31 offset:1024
    v_mfma_f32_32x32x16_bf16 a[128:143], v[104:107], v[112:115], a[128:143]
    ds_read_b128 v[72:75], v26 offset:8192
    buffer_load_dwordx4 v18, s[16:19], s53 offen offset:2048 lds
    v_mfma_f32_32x32x16_bf16 a[144:159], v[104:107], v[116:119], a[144:159]
    ds_read_b64_tr_b16 v[88:89], v32 offset:0
    v_mfma_f32_32x32x16_bf16 a[160:175], v[104:107], v[120:123], a[160:175]
    ds_read_b64_tr_b16 v[90:91], v32 offset:1024
    buffer_load_dwordx4 v19, s[16:19], s53 offen offset:3072 lds
    v_mfma_f32_32x32x16_bf16 a[176:191], v[104:107], v[124:127], a[176:191]
    ds_read_b128 v[76:79], v26 offset:12288
    v_mfma_f32_32x32x16_bf16 a[192:207], v[108:111], v[112:115], a[192:207]
    ds_read_b64_tr_b16 v[92:93], v33 offset:0
    v_mfma_f32_32x32x16_bf16 a[208:223], v[108:111], v[116:119], a[208:223]
    ds_read_b64_tr_b16 v[94:95], v33 offset:1024
    s_add_u32 m0, s49, 4096
    s_nop 0
    buffer_load_dwordx4 v20, s[16:19], s53 offen lds
    v_mfma_f32_32x32x16_bf16 a[224:239], v[108:111], v[120:123], a[224:239]
    v_mfma_f32_32x32x16_bf16 a[240:255], v[108:111], v[124:127], a[240:255]
    s_mov_b32 s57, 5
.p2align 6
K1_p1loop_V:
    s_waitcnt lgkmcnt(0)
    v_mfma_f32_32x32x16_bf16 a[0:15], v[64:67], v[80:83], a[0:15]
    ds_read_b128 v[96:99], v27 offset:0
    buffer_load_dwordx4 v21, s[16:19], s53 offen offset:1024 lds
    v_mfma_f32_32x32x16_bf16 a[16:31], v[64:67], v[84:87], a[16:31]
    ds_read_b64_tr_b16 v[112:113], v30 offset:4096
    v_mfma_f32_32x32x16_bf16 a[32:47], v[64:67], v[88:91], a[32:47]
    ds_read_b64_tr_b16 v[114:115], v30 offset:5120
    buffer_load_dwordx4 v22, s[16:19], s53 offen offset:2048 lds
    v_mfma_f32_32x32x16_bf16 a[48:63], v[64:67], v[92:95], a[48:63]
    ds_read_b128 v[100:103], v27 offset:4096
    v_mfma_f32_32x32x16_bf16 a[64:79], v[68:71], v[80:83], a[64:79]
    ds_read_b64_tr_b16 v[116:117], v31 offset:4096
    buffer_load_dwordx4 v23, s[16:19], s53 offen offset:3072 lds
    v_mfma_f32_32x32x16_bf16 a[80:95], v[68:71], v[84:87], a[80:95]
    ds_read_b64_tr_b16 v[118:119], v31 offset:5120
    v_mfma_f32_32x32x16_bf16 a[96:111], v[68:71], v[88:91], a[96:111]
    ds_read_b128 v[104:107], v27 offset:8192
    s_add_u32 m0, s48, 0
    s_nop 0
    buffer_load_dwordx4 v8, s[12:15], s52 offen lds
    v_mfma_f32_32x32x16_bf16 a[112:127], v[68:71], v[92:95], a[112:127]
    ds_read_b64_tr_b16 v[120:121], v32 offset:4096
    v_mfma_f32_32x32x16_bf16 a[128:143], v[72:75], v[80:83], a[128:143]
    ds_read_b64_tr_b16 v[122:123], v32 offset:5120
    v_mfma_f32_32x32x16_bf16 a[144:159], v[72:75], v[84:87], a[144:159]
    ds_read_b128 v[108:111], v27 offset:12288
    buffer_load_dwordx4 v9, s[12:15], s52 offen offset:1024 lds
    v_mfma_f32_32x32x16_bf16 a[160:175], v[72:75], v[88:91], a[160:175]
    ds_read_b64_tr_b16 v[124:125], v33 offset:4096
    v_mfma_f32_32x32x16_bf16 a[176:191], v[72:75], v[92:95], a[176:191]
    ds_read_b64_tr_b16 v[126:127], v33 offset:5120
    buffer_load_dwordx4 v10, s[12:15], s52 offen offset:2048 lds
    v_mfma_f32_32x32x16_bf16 a[192:207], v[76:79], v[80:83], a[192:207]
    v_mfma_f32_32x32x16_bf16 a[208:223], v[76:79], v[84:87], a[208:223]
    buffer_load_dwordx4 v11, s[12:15], s52 offen offset:3072 lds
    v_mfma_f32_32x32x16_bf16 a[224:239], v[76:79], v[88:91], a[224:239]
    v_mfma_f32_32x32x16_bf16 a[240:255], v[76:79], v[92:95], a[240:255]
    s_waitcnt lgkmcnt(0)
    v_mfma_f32_32x32x16_bf16 a[0:15], v[96:99], v[112:115], a[0:15]
    ds_read_b128 v[64:67], v28 offset:0
    s_add_u32 m0, s48, 4096
    s_nop 0
    buffer_load_dwordx4 v12, s[12:15], s52 offen lds
    v_mfma_f32_32x32x16_bf16 a[16:31], v[96:99], v[116:119], a[16:31]
    ds_read_b64_tr_b16 v[80:81], v30 offset:8192
    v_mfma_f32_32x32x16_bf16 a[32:47], v[96:99], v[120:123], a[32:47]
    ds_read_b64_tr_b16 v[82:83], v30 offset:9216
    buffer_load_dwordx4 v13, s[12:15], s52 offen offset:1024 lds
    v_mfma_f32_32x32x16_bf16 a[48:63], v[96:99], v[124:127], a[48:63]
    ds_read_b128 v[68:71], v28 offset:4096
    v_mfma_f32_32x32x16_bf16 a[64:79], v[100:103], v[112:115], a[64:79]
    ds_read_b64_tr_b16 v[84:85], v31 offset:8192
    v_mfma_f32_32x32x16_bf16 a[80:95], v[100:103], v[116:119], a[80:95]
    ds_read_b64_tr_b16 v[86:87], v31 offset:9216
    buffer_load_dwordx4 v14, s[12:15], s52 offen offset:2048 lds
    v_mfma_f32_32x32x16_bf16 a[96:111], v[100:103], v[120:123], a[96:111]
    ds_read_b128 v[72:75], v28 offset:8192
    v_mfma_f32_32x32x16_bf16 a[112:127], v[100:103], v[124:127], a[112:127]
    ds_read_b64_tr_b16 v[88:89], v32 offset:8192
    v_mfma_f32_32x32x16_bf16 a[128:143], v[104:107], v[112:115], a[128:143]
    ds_read_b64_tr_b16 v[90:91], v32 offset:9216
    buffer_load_dwordx4 v15, s[12:15], s52 offen offset:3072 lds
    v_mfma_f32_32x32x16_bf16 a[144:159], v[104:107], v[116:119], a[144:159]
    ds_read_b128 v[76:79], v28 offset:12288
    v_mfma_f32_32x32x16_bf16 a[160:175], v[104:107], v[120:123], a[160:175]
    ds_read_b64_tr_b16 v[92:93], v33 offset:8192
    s_add_u32 s52, s52, 128
    s_add_u32 s53, s53, 524288
    v_mfma_f32_32x32x16_bf16 a[176:191], v[104:107], v[124:127], a[176:191]
    ds_read_b64_tr_b16 v[94:95], v33 offset:9216
    v_mfma_f32_32x32x16_bf16 a[192:207], v[108:111], v[112:115], a[192:207]
    v_mfma_f32_32x32x16_bf16 a[208:223], v[108:111], v[116:119], a[208:223]
    s_xor_b32 s48, s48, 0x10000
    s_xor_b32 s49, s49, 0x10000
    s_xor_b32 s50, s50, 0x10000
    s_xor_b32 s51, s51, 0x10000
    v_mfma_f32_32x32x16_bf16 a[224:239], v[108:111], v[120:123], a[224:239]
    v_mfma_f32_32x32x16_bf16 a[240:255], v[108:111], v[124:127], a[240:255]
    s_waitcnt lgkmcnt(0)
    s_cmp_eq_u32 s57, 4
    s_cbranch_scc0 K1_nosw_V
    s_mov_b32 s96, s8
    s_mov_b32 s4, s24
    s_mov_b32 s97, s9
    s_mov_b32 s5, s25
    s_mov_b32 s98, s10
    s_mov_b32 s6, s26
    s_mov_b32 s99, s11
    s_mov_b32 s7, s27
    v_add_u32 v56, 0xfffffc00, v56
    v_mov_b32 v57, v58
K1_nosw_V:
    v_mfma_f32_32x32x16_bf16 a[0:15], v[64:67], v[80:83], a[0:15]
    ds_read_b128 v[96:99], v29 offset:0
    buffer_load_dword v60, v56, s[96:99], 0 offen
    buffer_load_dword v61, v57, s[4:7], 0 offen
    v_add_u32 v56, 128, v56
    v_add_u32 v57, 524288, v57
    v_mfma_f32_32x32x16_bf16 a[16:31], v[64:67], v[84:87], a[16:31]
    ds_read_b64_tr_b16 v[112:113], v30 offset:12288
    v_mfma_f32_32x32x16_bf16 a[32:47], v[64:67], v[88:91], a[32:47]
    ds_read_b64_tr_b16 v[114:115], v30 offset:13312
    v_mfma_f32_32x32x16_bf16 a[48:63], v[64:67], v[92:95], a[48:63]
    ds_read_b128 v[100:103], v29 offset:4096
    v_mfma_f32_32x32x16_bf16 a[64:79], v[68:71], v[80:83], a[64:79]
    ds_read_b64_tr_b16 v[116:117], v31 offset:12288
    buffer_load_dword v60, v56, s[96:99], 0 offen
    buffer_load_dword v61, v57, s[4:7], 0 offen
    v_add_u32 v56, 128, v56
    v_add_u32 v57, 524288, v57
    v_mfma_f32_32x32x16_bf16 a[80:95], v[68:71], v[84:87], a[80:95]
    ds_read_b64_tr_b16 v[118:119], v31 offset:13312
    v_mfma_f32_32x32x16_bf16 a[96:111], v[68:71], v[88:91], a[96:111]
    ds_read_b128 v[104:107], v29 offset:8192
    v_mfma_f32_32x32x16_bf16 a[112:127], v[68:71], v[92:95], a[112:127]
    ds_read_b64_tr_b16 v[120:121], v32 offset:12288
    v_mfma_f32_32x32x16_bf16 a[128:143], v[72:75], v[80:83], a[128:143]
    ds_read_b64_tr_b16 v[122:123], v32 offset:13312
    v_mfma_f32_32x32x16_bf16 a[144:159], v[72:75], v[84:87], a[144:159]
    ds_read_b128 v[108:111], v29 offset:12288
    v_mfma_f32_32x32x16_bf16 a[160:175], v[72:75], v[88:91], a[160:175]
    ds_read_b64_tr_b16 v[124:125], v33 offset:12288
    v_mfma_f32_32x32x16_bf16 a[176:191], v[72:75], v[92:95], a[176:191]
    ds_read_b64_tr_b16 v[126:127], v33 offset:13312
    v_mfma_f32_32x32x16_bf16 a[192:207], v[76:79], v[80:83], a[192:207]
    v_mfma_f32_32x32x16_bf16 a[208:223], v[76:79], v[84:87], a[208:223]
    v_mfma_f32_32x32x16_bf16 a[224:239], v[76:79], v[88:91], a[224:239]
    v_mfma_f32_32x32x16_bf16 a[240:255], v[76:79], v[92:95], a[240:255]
    s_waitcnt lgkmcnt(0)
    v_mfma_f32_32x32x16_bf16 a[0:15], v[96:99], v[112:115], a[0:15]
    v_mfma_f32_32x32x16_bf16 a[16:31], v[96:99], v[116:119], a[16:31]
    s_waitcnt vmcnt(4)
    s_barrier
    v_mfma_f32_32x32x16_bf16 a[32:47], v[96:99], v[120:123], a[32:47]
    v_xor_b32 v26, 0x10000, v26
    v_xor_b32 v27, 0x10000, v27
    v_xor_b32 v28, 0x10000, v28
    v_xor_b32 v29, 0x10000, v29
    v_xor_b32 v30, 0x10000, v30
    v_xor_b32 v31, 0x10000, v31
    v_xor_b32 v32, 0x10000, v32
    v_xor_b32 v33, 0x10000, v33
    v_mfma_f32_32x32x16_bf16 a[48:63], v[96:99], v[124:127], a[48:63]
    ds_read_b128 v[64:67], v26 offset:0
    ds_read_b64_tr_b16 v[80:81], v30 offset:0
    s_add_u32 m0, s49, 0
    s_nop 0
    buffer_load_dwordx4 v16, s[16:19], s53 offen lds
    v_mfma_f32_32x32x16_bf16 a[64:79], v[100:103], v[112:115], a[64:79]
    ds_read_b64_tr_b16 v[82:83], v30 offset:1024
    v_mfma_f32_32x32x16_bf16 a[80:95], v[100:103], v[116:119], a[80:95]
    ds_read_b128 v[68:71], v26 offset:4096
    buffer_load_dwordx4 v17, s[16:19], s53 offen offset:1024 lds
    v_mfma_f32_32x32x16_bf16 a[96:111], v[100:103], v[120:123], a[96:111]
    ds_read_b64_tr_b16 v[84:85], v31 offset:0
    v_mfma_f32_32x32x16_bf16 a[112:127], v[100:103], v[124:127], a[112:127]
    ds_read_b64_tr_b16 v[86:87], v31 offset:1024
    v_mfma_f32_32x32x16_bf16 a[128:143], v[104:107], v[112:115], a[128:143]
    ds_read_b128 v[72:75], v26 offset:8192
    buffer_load_dwordx4 v18, s[16:19], s53 offen offset:2048 lds
    v_mfma_f32_32x32x16_bf16 a[144:159], v[104:107], v[116:119], a[144:159]
    ds_read_b64_tr_b16 v[88:89], v32 offset:0
    v_mfma_f32_32x32x16_bf16 a[160:175], v[104:107], v[120:123], a[160:175]
    ds_read_b64_tr_b16 v[90:91], v32 offset:1024
    buffer_load_dwordx4 v19, s[16:19], s53 offen offset:3072 lds
    v_mfma_f32_32x32x16_bf16 a[176:191], v[104:107], v[124:127], a[176:191]
    ds_read_b128 v[76:79], v26 offset:12288
    v_mfma_f32_32x32x16_bf16 a[192:207], v[108:111], v[112:115], a[192:207]
    ds_read_b64_tr_b16 v[92:93], v33 offset:0
    v_mfma_f32_32x32x16_bf16 a[208:223], v[108:111], v[116:119], a[208:223]
    ds_read_b64_tr_b16 v[94:95], v33 offset:1024
    s_add_u32 m0, s49, 4096
    s_nop 0
    buffer_load_dwordx4 v20, s[16:19], s53 offen lds
    v_mfma_f32_32x32x16_bf16 a[224:239], v[108:111], v[120:123], a[224:239]
    v_mfma_f32_32x32x16_bf16 a[240:255], v[108:111], v[124:127], a[240:255]
    s_sub_u32 s57, s57, 1
    s_cmp_lg_u32 s57, 0
    s_cbranch_scc1 K1_p1loop_V
    s_waitcnt lgkmcnt(0)
    v_mfma_f32_32x32x16_bf16 a[0:15], v[64:67], v[80:83], a[0:15]
    ds_read_b128 v[96:99], v27 offset:0
    buffer_load_dwordx4 v21, s[16:19], s53 offen offset:1024 lds
    v_mfma_f32_32x32x16_bf16 a[16:31], v[64:67], v[84:87], a[16:31]
    ds_read_b64_tr_b16 v[112:113], v30 offset:4096
    v_mfma_f32_32x32x16_bf16 a[32:47], v[64:67], v[88:91], a[32:47]
    ds_read_b64_tr_b16 v[114:115], v30 offset:5120
    buffer_load_dwordx4 v22, s[16:19], s53 offen offset:2048 lds
    v_mfma_f32_32x32x16_bf16 a[48:63], v[64:67], v[92:95], a[48:63]
    ds_read_b128 v[100:103], v27 offset:4096
    v_mfma_f32_32x32x16_bf16 a[64:79], v[68:71], v[80:83], a[64:79]
    ds_read_b64_tr_b16 v[116:117], v31 offset:4096
    buffer_load_dwordx4 v23, s[16:19], s53 offen offset:3072 lds
    v_mfma_f32_32x32x16_bf16 a[80:95], v[68:71], v[84:87], a[80:95]
    ds_read_b64_tr_b16 v[118:119], v31 offset:5120
    v_mfma_f32_32x32x16_bf16 a[96:111], v[68:71], v[88:91], a[96:111]
    ds_read_b128 v[104:107], v27 offset:8192
    s_add_u32 m0, s48, 0
    s_nop 0
    buffer_load_dwordx4 v8, s[12:15], s52 offen lds
    v_mfma_f32_32x32x16_bf16 a[112:127], v[68:71], v[92:95], a[112:127]
    ds_read_b64_tr_b16 v[120:121], v32 offset:4096
    v_mfma_f32_32x32x16_bf16 a[128:143], v[72:75], v[80:83], a[128:143]
    ds_read_b64_tr_b16 v[122:123], v32 offset:5120
    v_mfma_f32_32x32x16_bf16 a[144:159], v[72:75], v[84:87], a[144:159]
    ds_read_b128 v[108:111], v27 offset:12288
    buffer_load_dwordx4 v9, s[12:15], s52 offen offset:1024 lds
    v_mfma_f32_32x32x16_bf16 a[160:175], v[72:75], v[88:91], a[160:175]
    ds_read_b64_tr_b16 v[124:125], v33 offset:4096
    v_mfma_f32_32x32x16_bf16 a[176:191], v[72:75], v[92:95], a[176:191]
    ds_read_b64_tr_b16 v[126:127], v33 offset:5120
    buffer_load_dwordx4 v10, s[12:15], s52 offen offset:2048 lds
    v_mfma_f32_32x32x16_bf16 a[192:207], v[76:79], v[80:83], a[192:207]
    v_mfma_f32_32x32x16_bf16 a[208:223], v[76:79], v[84:87], a[208:223]
    buffer_load_dwordx4 v11, s[12:15], s52 offen offset:3072 lds
    v_mfma_f32_32x32x16_bf16 a[224:239], v[76:79], v[88:91], a[224:239]
    v_mfma_f32_32x32x16_bf16 a[240:255], v[76:79], v[92:95], a[240:255]
    s_waitcnt lgkmcnt(0)
    v_mfma_f32_32x32x16_bf16 a[0:15], v[96:99], v[112:115], a[0:15]
    ds_read_b128 v[64:67], v28 offset:0
    s_add_u32 m0, s48, 4096
    s_nop 0
    buffer_load_dwordx4 v12, s[12:15], s52 offen lds
    v_mfma_f32_32x32x16_bf16 a[16:31], v[96:99], v[116:119], a[16:31]
    ds_read_b64_tr_b16 v[80:81], v30 offset:8192
    v_mfma_f32_32x32x16_bf16 a[32:47], v[96:99], v[120:123], a[32:47]
    ds_read_b64_tr_b16 v[82:83], v30 offset:9216
    buffer_load_dwordx4 v13, s[12:15], s52 offen offset:1024 lds
    v_mfma_f32_32x32x16_bf16 a[48:63], v[96:99], v[124:127], a[48:63]
    ds_read_b128 v[68:71], v28 offset:4096
    v_mfma_f32_32x32x16_bf16 a[64:79], v[100:103], v[112:115], a[64:79]
    ds_read_b64_tr_b16 v[84:85], v31 offset:8192
    v_mfma_f32_32x32x16_bf16 a[80:95], v[100:103], v[116:119], a[80:95]
    ds_read_b64_tr_b16 v[86:87], v31 offset:9216
    buffer_load_dwordx4 v14, s[12:15], s52 offen offset:2048 lds
    v_mfma_f32_32x32x16_bf16 a[96:111], v[100:103], v[120:123], a[96:111]
    ds_read_b128 v[72:75], v28 offset:8192
    v_mfma_f32_32x32x16_bf16 a[112:127], v[100:103], v[124:127], a[112:127]
    ds_read_b64_tr_b16 v[88:89], v32 offset:8192
    v_mfma_f32_32x32x16_bf16 a[128:143], v[104:107], v[112:115], a[128:143]
    ds_read_b64_tr_b16 v[90:91], v32 offset:9216
    buffer_load_dwordx4 v15, s[12:15], s52 offen offset:3072 lds
    v_mfma_f32_32x32x16_bf16 a[144:159], v[104:107], v[116:119], a[144:159]
    ds_read_b128 v[76:79], v28 offset:12288
    v_mfma_f32_32x32x16_bf16 a[160:175], v[104:107], v[120:123], a[160:175]
    ds_read_b64_tr_b16 v[92:93], v33 offset:8192
    s_add_u32 s52, s52, 128
    s_add_u32 s53, s53, 524288
    v_mfma_f32_32x32x16_bf16 a[176:191], v[104:107], v[124:127], a[176:191]
    ds_read_b64_tr_b16 v[94:95], v33 offset:9216
    v_mfma_f32_32x32x16_bf16 a[192:207], v[108:111], v[112:115], a[192:207]
    v_mfma_f32_32x32x16_bf16 a[208:223], v[108:111], v[116:119], a[208:223]
    s_xor_b32 s48, s48, 0x10000
    s_xor_b32 s49, s49, 0x10000
    s_xor_b32 s50, s50, 0x10000
    s_xor_b32 s51, s51, 0x10000
    v_mfma_f32_32x32x16_bf16 a[224:239], v[108:111], v[120:123], a[224:239]
    v_mfma_f32_32x32x16_bf16 a[240:255], v[108:111], v[124:127], a[240:255]
    s_waitcnt lgkmcnt(0)
    v_mfma_f32_32x32x16_bf16 a[0:15], v[64:67], v[80:83], a[0:15]
    ds_read_b128 v[96:99], v29 offset:0
    v_mfma_f32_32x32x16_bf16 a[16:31], v[64:67], v[84:87], a[16:31]
    ds_read_b64_tr_b16 v[112:113], v30 offset:12288
    v_mfma_f32_32x32x16_bf16 a[32:47], v[64:67], v[88:91], a[32:47]
    ds_read_b64_tr_b16 v[114:115], v30 offset:13312
    v_mfma_f32_32x32x16_bf16 a[48:63], v[64:67], v[92:95], a[48:63]
    ds_read_b128 v[100:103], v29 offset:4096
    v_mfma_f32_32x32x16_bf16 a[64:79], v[68:71], v[80:83], a[64:79]
    ds_read_b64_tr_b16 v[116:117], v31 offset:12288
    v_mfma_f32_32x32x16_bf16 a[80:95], v[68:71], v[84:87], a[80:95]
    ds_read_b64_tr_b16 v[118:119], v31 offset:13312
    v_mfma_f32_32x32x16_bf16 a[96:111], v[68:71], v[88:91], a[96:111]
    ds_read_b128 v[104:107], v29 offset:8192
    v_mfma_f32_32x32x16_bf16 a[112:127], v[68:71], v[92:95], a[112:127]
    ds_read_b64_tr_b16 v[120:121], v32 offset:12288
    v_mfma_f32_32x32x16_bf16 a[128:143], v[72:75], v[80:83], a[128:143]
    ds_read_b64_tr_b16 v[122:123], v32 offset:13312
    v_mfma_f32_32x32x16_bf16 a[144:159], v[72:75], v[84:87], a[144:159]
    ds_read_b128 v[108:111], v29 offset:12288
    v_mfma_f32_32x32x16_bf16 a[160:175], v[72:75], v[88:91], a[160:175]
    ds_read_b64_tr_b16 v[124:125], v33 offset:12288
    v_mfma_f32_32x32x16_bf16 a[176:191], v[72:75], v[92:95], a[176:191]
    ds_read_b64_tr_b16 v[126:127], v33 offset:13312
    v_mfma_f32_32x32x16_bf16 a[192:207], v[76:79], v[80:83], a[192:207]
    v_mfma_f32_32x32x16_bf16 a[208:223], v[76:79], v[84:87], a[208:223]
    v_mfma_f32_32x32x16_bf16 a[224:239], v[76:79], v[88:91], a[224:239]
    v_mfma_f32_32x32x16_bf16 a[240:255], v[76:79], v[92:95], a[240:255]
    s_waitcnt lgkmcnt(0)
    v_mfma_f32_32x32x16_bf16 a[0:15], v[96:99], v[112:115], a[0:15]
    v_mfma_f32_32x32x16_bf16 a[16:31], v[96:99], v[116:119], a[16:31]
    s_waitcnt vmcnt(0)
    s_barrier
    v_mfma_f32_32x32x16_bf16 a[32:47], v[96:99], v[120:123], a[32:47]
    v_xor_b32 v26, 0x10000, v26
    v_xor_b32 v27, 0x10000, v27
    v_xor_b32 v28, 0x10000, v28
    v_xor_b32 v29, 0x10000, v29
    v_xor_b32 v30, 0x10000, v30
    v_xor_b32 v31, 0x10000, v31
    v_xor_b32 v32, 0x10000, v32
    v_xor_b32 v33, 0x10000, v33
    v_mfma_f32_32x32x16_bf16 a[48:63], v[96:99], v[124:127], a[48:63]
    ds_read_b128 v[64:67], v26 offset:0
    ds_read_b64_tr_b16 v[80:81], v30 offset:0
    s_mov_b32 m0, s50
    s_nop 0
    buffer_load_dwordx4 v16, s[24:27], s55 offen lds
    v_mfma_f32_32x32x16_bf16 a[64:79], v[100:103], v[112:115], a[64:79]
    ds_read_b64_tr_b16 v[82:83], v30 offset:1024
    v_mfma_f32_32x32x16_bf16 a[80:95], v[100:103], v[116:119], a[80:95]
    ds_read_b128 v[68:71], v26 offset:4096
    v_mfma_f32_32x32x16_bf16 a[96:111], v[100:103], v[120:123], a[96:111]
    ds_read_b64_tr_b16 v[84:85], v31 offset:0
    buffer_load_dwordx4 v17, s[24:27], s55 offen offset:1024 lds
    v_mfma_f32_32x32x16_bf16 a[112:127], v[100:103], v[124:127], a[112:127]
    ds_read_b64_tr_b16 v[86:87], v31 offset:1024
    v_mfma_f32_32x32x16_bf16 a[128:143], v[104:107], v[112:115], a[128:143]
    ds_read_b128 v[72:75], v26 offset:8192
    v_mfma_f32_32x32x16_bf16 a[144:159], v[104:107], v[116:119], a[144:159]
    ds_read_b64_tr_b16 v[88:89], v32 offset:0
    buffer_load_dwordx4 v18, s[24:27], s55 offen offset:2048 lds
    v_mfma_f32_32x32x16_bf16 a[160:175], v[104:107], v[120:123], a[160:175]
    ds_read_b64_tr_b16 v[90:91], v32 offset:1024
    v_mfma_f32_32x32x16_bf16 a[176:191], v[104:107], v[124:127], a[176:191]
    ds_read_b128 v[76:79], v26 offset:12288
    v_mfma_f32_32x32x16_bf16 a[192:207], v[108:111], v[112:115], a[192:207]
    ds_read_b64_tr_b16 v[92:93], v33 offset:0
    buffer_load_dwordx4 v19, s[24:27], s55 offen offset:3072 lds
    v_mfma_f32_32x32x16_bf16 a[208:223], v[108:111], v[116:119], a[208:223]
    ds_read_b64_tr_b16 v[94:95], v33 offset:1024
    v_mfma_f32_32x32x16_bf16 a[224:239], v[108:111], v[120:123], a[224:239]
    v_mfma_f32_32x32x16_bf16 a[240:255], v[108:111], v[124:127], a[240:255]
    s_waitcnt lgkmcnt(0)
    v_mfma_f32_32x32x16_bf16 a[0:15], v[64:67], v[80:83], a[0:15]
    ds_read_b128 v[96:99], v27 offset:0
    s_mov_b32 m0, s51
    s_nop 0
    buffer_load_dwordx4 v24, s[28:31], s56 offen lds
    v_mfma_f32_32x32x16_bf16 a[16:31], v[64:67], v[84:87], a[16:31]
    ds_read_b64_tr_b16 v[112:113], v30 offset:4096
    v_mfma_f32_32x32x16_bf16 a[32:47], v[64:67], v[88:91], a[32:47]
    ds_read_b64_tr_b16 v[114:115], v30 offset:5120
    buffer_load_dwordx4 v25, s[28:31], s56 offen offset:1024 lds
    v_mfma_f32_32x32x16_bf16 a[48:63], v[64:67], v[92:95], a[48:63]
    ds_read_b128 v[100:103], v27 offset:4096
    v_mfma_f32_32x32x16_bf16 a[64:79], v[68:71], v[80:83], a[64:79]
    ds_read_b64_tr_b16 v[116:117], v31 offset:4096
    v_mfma_f32_32x32x16_bf16 a[80:95], v[68:71], v[84:87], a[80:95]
    ds_read_b64_tr_b16 v[118:119], v31 offset:5120
    s_add_u32 m0, s48, 0
    s_nop 0
    buffer_load_dwordx4 v8, s[8:11], s54 offen lds
    v_mfma_f32_32x32x16_bf16 a[96:111], v[68:71], v[88:91], a[96:111]
    ds_read_b128 v[104:107], v27 offset:8192
    v_mfma_f32_32x32x16_bf16 a[112:127], v[68:71], v[92:95], a[112:127]
    ds_read_b64_tr_b16 v[120:121], v32 offset:4096
    v_mfma_f32_32x32x16_bf16 a[128:143], v[72:75], v[80:83], a[128:143]
    ds_read_b64_tr_b16 v[122:123], v32 offset:5120
    buffer_load_dwordx4 v9, s[8:11], s54 offen offset:1024 lds
    v_mfma_f32_32x32x16_bf16 a[144:159], v[72:75], v[84:87], a[144:159]
    ds_read_b128 v[108:111], v27 offset:12288
    v_mfma_f32_32x32x16_bf16 a[160:175], v[72:75], v[88:91], a[160:175]
    ds_read_b64_tr_b16 v[124:125], v33 offset:4096
    buffer_load_dwordx4 v10, s[8:11], s54 offen offset:2048 lds
    v_mfma_f32_32x32x16_bf16 a[176:191], v[72:75], v[92:95], a[176:191]
    ds_read_b64_tr_b16 v[126:127], v33 offset:5120
    v_mfma_f32_32x32x16_bf16 a[192:207], v[76:79], v[80:83], a[192:207]
    v_mfma_f32_32x32x16_bf16 a[208:223], v[76:79], v[84:87], a[208:223]
    buffer_load_dwordx4 v11, s[8:11], s54 offen offset:3072 lds
    v_mfma_f32_32x32x16_bf16 a[224:239], v[76:79], v[88:91], a[224:239]
    v_mfma_f32_32x32x16_bf16 a[240:255], v[76:79], v[92:95], a[240:255]
    s_waitcnt lgkmcnt(0)
    v_mfma_f32_32x32x16_bf16 a[0:15], v[96:99], v[112:115], a[0:15]
    ds_read_b128 v[64:67], v28 offset:0
    s_add_u32 m0, s48, 4096
    s_nop 0
    buffer_load_dwordx4 v12, s[8:11], s54 offen lds
    v_mfma_f32_32x32x16_bf16 a[16:31], v[96:99], v[116:119], a[16:31]
    ds_read_b64_tr_b16 v[80:81], v30 offset:8192
    v_mfma_f32_32x32x16_bf16 a[32:47], v[96:99], v[120:123], a[32:47]
    ds_read_b64_tr_b16 v[82:83], v30 offset:9216
    buffer_load_dwordx4 v13, s[8:11], s54 offen offset:1024 lds
    v_mfma_f32_32x32x16_bf16 a[48:63], v[96:99], v[124:127], a[48:63]
    ds_read_b128 v[68:71], v28 offset:4096
    v_mfma_f32_32x32x16_bf16 a[64:79], v[100:103], v[112:115], a[64:79]
    ds_read_b64_tr_b16 v[84:85], v31 offset:8192
    v_mfma_f32_32x32x16_bf16 a[80:95], v[100:103], v[116:119], a[80:95]
    ds_read_b64_tr_b16 v[86:87], v31 offset:9216
    buffer_load_dwordx4 v14, s[8:11], s54 offen offset:2048 lds
    v_mfma_f32_32x32x16_bf16 a[96:111], v[100:103], v[120:123], a[96:111]
    ds_read_b128 v[72:75], v28 offset:8192
    v_mfma_f32_32x32x16_bf16 a[112:127], v[100:103], v[124:127], a[112:127]
    ds_read_b64_tr_b16 v[88:89], v32 offset:8192
    v_mfma_f32_32x32x16_bf16 a[128:143], v[104:107], v[112:115], a[128:143]
    ds_read_b64_tr_b16 v[90:91], v32 offset:9216
    buffer_load_dwordx4 v15, s[8:11], s54 offen offset:3072 lds
    v_mfma_f32_32x32x16_bf16 a[144:159], v[104:107], v[116:119], a[144:159]
    ds_read_b128 v[76:79], v28 offset:12288
    v_mfma_f32_32x32x16_bf16 a[160:175], v[104:107], v[120:123], a[160:175]
    ds_read_b64_tr_b16 v[92:93], v33 offset:8192
    s_add_u32 s54, s54, 128
    s_add_u32 s55, s55, 524288
    s_add_u32 s56, s56, 196608
    v_mfma_f32_32x32x16_bf16 a[176:191], v[104:107], v[124:127], a[176:191]
    ds_read_b64_tr_b16 v[94:95], v33 offset:9216
    v_mfma_f32_32x32x16_bf16 a[192:207], v[108:111], v[112:115], a[192:207]
    v_mfma_f32_32x32x16_bf16 a[208:223], v[108:111], v[116:119], a[208:223]
    s_xor_b32 s48, s48, 0x10000
    s_xor_b32 s49, s49, 0x10000
    s_xor_b32 s50, s50, 0x10000
    s_xor_b32 s51, s51, 0x10000
    v_mfma_f32_32x32x16_bf16 a[224:239], v[108:111], v[120:123], a[224:239]
    v_mfma_f32_32x32x16_bf16 a[240:255], v[108:111], v[124:127], a[240:255]
    s_waitcnt lgkmcnt(0)
    v_mfma_f32_32x32x16_bf16 a[0:15], v[64:67], v[80:83], a[0:15]
    ds_read_b128 v[96:99], v29 offset:0
    v_mfma_f32_32x32x16_bf16 a[16:31], v[64:67], v[84:87], a[16:31]
    ds_read_b64_tr_b16 v[112:113], v30 offset:12288
    v_mfma_f32_32x32x16_bf16 a[32:47], v[64:67], v[88:91], a[32:47]
    ds_read_b64_tr_b16 v[114:115], v30 offset:13312
    v_mfma_f32_32x32x16_bf16 a[48:63], v[64:67], v[92:95], a[48:63]
    ds_read_b128 v[100:103], v29 offset:4096
    v_mfma_f32_32x32x16_bf16 a[64:79], v[68:71], v[80:83], a[64:79]
    ds_read_b64_tr_b16 v[116:117], v31 offset:12288
    v_mfma_f32_32x32x16_bf16 a[80:95], v[68:71], v[84:87], a[80:95]
    ds_read_b64_tr_b16 v[118:119], v31 offset:13312
    v_mfma_f32_32x32x16_bf16 a[96:111], v[68:71], v[88:91], a[96:111]
    ds_read_b128 v[104:107], v29 offset:8192
    v_mfma_f32_32x32x16_bf16 a[112:127], v[68:71], v[92:95], a[112:127]
    ds_read_b64_tr_b16 v[120:121], v32 offset:12288
    v_mfma_f32_32x32x16_bf16 a[128:143], v[72:75], v[80:83], a[128:143]
    ds_read_b64_tr_b16 v[122:123], v32 offset:13312
    v_mfma_f32_32x32x16_bf16 a[144:159], v[72:75], v[84:87], a[144:159]
    ds_read_b128 v[108:111], v29 offset:12288
    v_mfma_f32_32x32x16_bf16 a[160:175], v[72:75], v[88:91], a[160:175]
    ds_read_b64_tr_b16 v[124:125], v33 offset:12288
    v_mfma_f32_32x32x16_bf16 a[176:191], v[72:75], v[92:95], a[176:191]
    ds_read_b64_tr_b16 v[126:127], v33 offset:13312
    v_mfma_f32_32x32x16_bf16 a[192:207], v[76:79], v[80:83], a[192:207]
    v_mfma_f32_32x32x16_bf16 a[208:223], v[76:79], v[84:87], a[208:223]
    v_mfma_f32_32x32x16_bf16 a[224:239], v[76:79], v[88:91], a[224:239]
    v_mfma_f32_32x32x16_bf16 a[240:255], v[76:79], v[92:95], a[240:255]
    s_waitcnt lgkmcnt(0)
    v_mfma_f32_32x32x16_bf16 a[0:15], v[96:99], v[112:115], a[0:15]
    v_mfma_f32_32x32x16_bf16 a[16:31], v[96:99], v[116:119], a[16:31]
    s_waitcnt vmcnt(0)
    s_barrier
    v_mfma_f32_32x32x16_bf16 a[32:47], v[96:99], v[120:123], a[32:47]
    s_mov_b32 m0, s50
    s_nop 0
    buffer_load_dwordx4 v16, s[24:27], s55 offen lds
    buffer_load_dwordx4 v17, s[24:27], s55 offen offset:1024 lds
    v_mfma_f32_32x32x16_bf16 a[48:63], v[96:99], v[124:127], a[48:63]
    buffer_load_dwordx4 v18, s[24:27], s55 offen offset:2048 lds
    v_mfma_f32_32x32x16_bf16 a[64:79], v[100:103], v[112:115], a[64:79]
    buffer_load_dwordx4 v19, s[24:27], s55 offen offset:3072 lds
    v_mfma_f32_32x32x16_bf16 a[80:95], v[100:103], v[116:119], a[80:95]
    s_mov_b32 m0, s51
    s_nop 0
    buffer_load_dwordx4 v24, s[28:31], s56 offen lds
    v_mfma_f32_32x32x16_bf16 a[96:111], v[100:103], v[120:123], a[96:111]
    buffer_load_dwordx4 v25, s[28:31], s56 offen offset:1024 lds
    v_mfma_f32_32x32x16_bf16 a[112:127], v[100:103], v[124:127], a[112:127]
    s_add_u32 m0, s48, 0
    s_nop 0
    buffer_load_dwordx4 v8, s[8:11], s54 offen lds
    v_mfma_f32_32x32x16_bf16 a[128:143], v[104:107], v[112:115], a[128:143]
    buffer_load_dwordx4 v9, s[8:11], s54 offen offset:1024 lds
    v_mfma_f32_32x32x16_bf16 a[144:159], v[104:107], v[116:119], a[144:159]
    buffer_load_dwordx4 v10, s[8:11], s54 offen offset:2048 lds
    buffer_load_dwordx4 v11, s[8:11], s54 offen offset:3072 lds
    v_mfma_f32_32x32x16_bf16 a[160:175], v[104:107], v[120:123], a[160:175]
    s_add_u32 m0, s48, 4096
    s_nop 0
    buffer_load_dwordx4 v12, s[8:11], s54 offen lds
    v_mfma_f32_32x32x16_bf16 a[176:191], v[104:107], v[124:127], a[176:191]
    buffer_load_dwordx4 v13, s[8:11], s54 offen offset:1024 lds
    v_mfma_f32_32x32x16_bf16 a[192:207], v[108:111], v[112:115], a[192:207]
    buffer_load_dwordx4 v14, s[8:11], s54 offen offset:2048 lds
    v_mfma_f32_32x32x16_bf16 a[208:223], v[108:111], v[116:119], a[208:223]
    buffer_load_dwordx4 v15, s[8:11], s54 offen offset:3072 lds
    v_mfma_f32_32x32x16_bf16 a[224:239], v[108:111], v[120:123], a[224:239]
    s_add_u32 s54, s54, 128
    s_add_u32 s55, s55, 524288
    s_add_u32 s56, s56, 196608
    v_mfma_f32_32x32x16_bf16 a[240:255], v[108:111], v[124:127], a[240:255]
    s_xor_b32 s48, s48, 0x10000
    s_xor_b32 s49, s49, 0x10000
    s_xor_b32 s50, s50, 0x10000
    s_xor_b32 s51, s51, 0x10000
    s_and_b32 s58, s46, 1
    s_cmp_eq_u32 s58, 0
    s_cselect_b32 s58, s61, s62
    s_lshl_b32 s58, s58, 16
    s_lshl_b32 s59, s44, 20
    s_add_u32 s58, s58, s59
    v_lshlrev_b32 v7, 4, v0
    s_add_u32 s76, s58, 16384
    s_add_u32 s77, s58, 20480
    s_add_u32 s78, s58, 17408
    s_add_u32 s79, s58, 21504
    s_add_u32 s80, s58, 18432
    s_add_u32 s81, s58, 22528
    s_add_u32 s82, s58, 19456
    s_add_u32 s83, s58, 23552
K1_pass2:
    s_nop 7
    v_accvgpr_read_b32 v40, a0
    v_accvgpr_read_b32 v41, a1
    v_accvgpr_read_b32 v42, a2
    v_accvgpr_read_b32 v43, a3
    v_accvgpr_read_b32 v44, a4
    v_accvgpr_read_b32 v45, a5
    v_accvgpr_read_b32 v46, a6
    v_accvgpr_read_b32 v47, a7
    v_cvt_pk_bf16_f32 v52, v40, v41
    v_cvt_pk_bf16_f32 v53, v42, v43
    v_cvt_pk_bf16_f32 v54, v44, v45
    v_cvt_pk_bf16_f32 v55, v46, v47
    buffer_store_dwordx4 v[52:55], v7, s[32:35], s76 offen sc1
    v_accvgpr_read_b32 v40, a8
    v_accvgpr_read_b32 v41, a9
    v_accvgpr_read_b32 v42, a10
    v_accvgpr_read_b32 v43, a11
    v_accvgpr_read_b32 v44, a12
    v_accvgpr_read_b32 v45, a13
    v_accvgpr_read_b32 v46, a14
    v_accvgpr_read_b32 v47, a15
    v_cvt_pk_bf16_f32 v48, v40, v41
    v_cvt_pk_bf16_f32 v49, v42, v43
    v_cvt_pk_bf16_f32 v50, v44, v45
    v_cvt_pk_bf16_f32 v51, v46, v47
    buffer_store_dwordx4 v[48:51], v7, s[32:35], s77 offen sc1
    v_accvgpr_read_b32 v40, a16
    v_accvgpr_read_b32 v41, a17
    v_accvgpr_read_b32 v42, a18
    v_accvgpr_read_b32 v43, a19
    v_accvgpr_read_b32 v44, a20
    v_accvgpr_read_b32 v45, a21
    v_accvgpr_read_b32 v46, a22
    v_accvgpr_read_b32 v47, a23
    v_cvt_pk_bf16_f32 v52, v40, v41
    v_cvt_pk_bf16_f32 v53, v42, v43
    v_cvt_pk_bf16_f32 v54, v44, v45
    v_cvt_pk_bf16_f32 v55, v46, v47
    buffer_store_dwordx4 v[52:55], v7, s[32:35], s78 offen sc1
    v_accvgpr_read_b32 v40, a24
    v_accvgpr_read_b32 v41, a25
    v_accvgpr_read_b32 v42, a26
    v_accvgpr_read_b32 v43, a27
    v_accvgpr_read_b32 v44, a28
    v_accvgpr_read_b32 v45, a29
    v_accvgpr_read_b32 v46, a30
    v_accvgpr_read_b32 v47, a31
    v_cvt_pk_bf16_f32 v48, v40, v41
    v_cvt_pk_bf16_f32 v49, v42, v43
    v_cvt_pk_bf16_f32 v50, v44, v45
    v_cvt_pk_bf16_f32 v51, v46, v47
    buffer_store_dwordx4 v[48:51], v7, s[32:35], s79 offen sc1
    v_and_b32 v1, 31, v0
    v_lshlrev_b32 v1, 7, v1
    v_lshrrev_b32 v2, 5, v0
    v_bfe_u32 v3, v0, 1, 3
    s_lshl_b32 s58, s46, 12
    v_add_u32 v1, s58, v1
    v_add_u32 v4, 0, v2
    v_xor_b32 v4, v4, v3
    v_lshlrev_b32 v4, 4, v4
    v_add_u32 v26, v4, v1
    v_add_u32 v4, 2, v2
    v_xor_b32 v4, v4, v3
    v_lshlrev_b32 v4, 4, v4
    v_add_u32 v27, v4, v1
    v_add_u32 v4, 4, v2
    v_xor_b32 v4, v4, v3
    v_lshlrev_b32 v4, 4, v4
    v_add_u32 v28, v4, v1
    v_add_u32 v4, 6, v2
    v_xor_b32 v4, v4, v3
    v_lshlrev_b32 v4, 4, v4
    v_add_u32 v29, v4, v1
    v_and_b32 v30, 0x3fff, v30
    v_or_b32 v30, 0x8000, v30
    v_and_b32 v31, 0x3fff, v31
    v_or_b32 v31, 0x8000, v31
    v_and_b32 v32, 0x3fff, v32
    v_or_b32 v32, 0x8000, v32
    v_and_b32 v33, 0x3fff, v33
    v_or_b32 v33, 0x8000, v33
    ds_read_b128 a[0:3], v26 offset:0
    ds_read_b64_tr_b16 a[8:9], v30 offset:0
    ds_read_b64_tr_b16 a[10:11], v30 offset:1024
    ds_read_b128 a[4:7], v26 offset:16384
    ds_read_b64_tr_b16 a[12:13], v31 offset:0
    ds_read_b64_tr_b16 a[14:15], v31 offset:1024
    ds_read_b64_tr_b16 a[16:17], v32 offset:0
    ds_read_b64_tr_b16 a[18:19], v32 offset:1024
    ds_read_b64_tr_b16 a[20:21], v33 offset:0
    ds_read_b64_tr_b16 a[22:23], v33 offset:1024
    ds_read_b64_tr_b16 a[24:25], v34 offset:0
    ds_read_b64_tr_b16 a[26:27], v34 offset:512
    ds_read_b64_tr_b16 a[28:29], v35 offset:0
    ds_read_b64_tr_b16 a[30:31], v35 offset:512
    v_accvgpr_read_b32 v40, a32
    v_accvgpr_read_b32 v41, a33
    v_accvgpr_read_b32 v42, a34
    v_accvgpr_read_b32 v43, a35
    v_accvgpr_read_b32 v44, a36
    v_accvgpr_read_b32 v45, a37
    v_accvgpr_read_b32 v46, a38
    v_accvgpr_read_b32 v47, a39
    v_cvt_pk_bf16_f32 v52, v40, v41
    v_cvt_pk_bf16_f32 v53, v42, v43
    v_cvt_pk_bf16_f32 v54, v44, v45
    v_cvt_pk_bf16_f32 v55, v46, v47
    buffer_store_dwordx4 v[52:55], v7, s[32:35], s80 offen sc1
    v_accvgpr_read_b32 v40, a40
    v_accvgpr_read_b32 v41, a41
    v_accvgpr_read_b32 v42, a42
    v_accvgpr_read_b32 v43, a43
    v_accvgpr_read_b32 v44, a44
    v_accvgpr_read_b32 v45, a45
    v_accvgpr_read_b32 v46, a46
    v_accvgpr_read_b32 v47, a47
    v_cvt_pk_bf16_f32 v48, v40, v41
    v_cvt_pk_bf16_f32 v49, v42, v43
    v_cvt_pk_bf16_f32 v50, v44, v45
    v_cvt_pk_bf16_f32 v51, v46, v47
    buffer_store_dwordx4 v[48:51], v7, s[32:35], s81 offen sc1
    v_accvgpr_read_b32 v40, a48
    v_accvgpr_read_b32 v41, a49
    v_accvgpr_read_b32 v42, a50
    v_accvgpr_read_b32 v43, a51
    v_accvgpr_read_b32 v44, a52
    v_accvgpr_read_b32 v45, a53
    v_accvgpr_read_b32 v46, a54
    v_accvgpr_read_b32 v47, a55
    v_cvt_pk_bf16_f32 v52, v40, v41
    v_cvt_pk_bf16_f32 v53, v42, v43
    v_cvt_pk_bf16_f32 v54, v44, v45
    v_cvt_pk_bf16_f32 v55, v46, v47
    buffer_store_dwordx4 v[52:55], v7, s[32:35], s82 offen sc1
    v_accvgpr_read_b32 v40, a56
    v_accvgpr_read_b32 v41, a57
    v_accvgpr_read_b32 v42, a58
    v_accvgpr_read_b32 v43, a59
    v_accvgpr_read_b32 v44, a60
    v_accvgpr_read_b32 v45, a61
    v_accvgpr_read_b32 v46, a62
    v_accvgpr_read_b32 v47, a63
    v_cvt_pk_bf16_f32 v48, v40, v41
    v_cvt_pk_bf16_f32 v49, v42, v43
    v_cvt_pk_bf16_f32 v50, v44, v45
    v_cvt_pk_bf16_f32 v51, v46, v47
    buffer_store_dwordx4 v[48:51], v7, s[32:35], s83 offen sc1
    s_waitcnt lgkmcnt(0)
    v_mfma_f32_32x32x16_bf16 v[64:79], a[8:11], a[0:3], 0
    ds_read_b128 a[32:35], v27 offset:0
    ds_read_b64_tr_b16 a[40:41], v30 offset:4096
    v_mfma_f32_32x32x16_bf16 v[128:143], a[8:11], a[4:7], 0
    ds_read_b64_tr_b16 a[42:43], v30 offset:5120
    v_mfma_f32_32x32x16_bf16 v[80:95], a[12:15], a[0:3], 0
    ds_read_b128 a[36:39], v27 offset:16384
    ds_read_b64_tr_b16 a[44:45], v31 offset:4096
    v_mfma_f32_32x32x16_bf16 v[144:159], a[12:15], a[4:7], 0
    ds_read_b64_tr_b16 a[46:47], v31 offset:5120
    v_mfma_f32_32x32x16_bf16 v[96:111], a[16:19], a[0:3], 0
    ds_read_b64_tr_b16 a[48:49], v32 offset:4096
    v_mfma_f32_32x32x16_bf16 v[160:175], a[16:19], a[4:7], 0
    ds_read_b64_tr_b16 a[50:51], v32 offset:5120
    ds_read_b64_tr_b16 a[52:53], v33 offset:4096
    v_mfma_f32_32x32x16_bf16 v[112:127], a[20:23], a[0:3], 0
    ds_read_b64_tr_b16 a[54:55], v33 offset:5120
    v_mfma_f32_32x32x16_bf16 v[176:191], a[20:23], a[4:7], 0
    ds_read_b64_tr_b16 a[56:57], v34 offset:2048
    ds_read_b64_tr_b16 a[58:59], v34 offset:2560
    v_mfma_f32_32x32x16_bf16 v[192:207], a[24:27], a[0:3], 0
    ds_read_b64_tr_b16 a[60:61], v35 offset:2048
    v_mfma_f32_32x32x16_bf16 v[208:223], a[24:27], a[4:7], 0
    ds_read_b64_tr_b16 a[62:63], v35 offset:2560
    v_mfma_f32_32x32x16_bf16 v[224:239], a[0:3], a[28:31], 0
    v_mfma_f32_32x32x16_bf16 v[240:255], a[4:7], a[28:31], 0
    s_waitcnt lgkmcnt(0)
    v_mfma_f32_32x32x16_bf16 v[64:79], a[40:43], a[32:35], v[64:79]
    ds_read_b128 a[0:3], v28 offset:0
    ds_read_b64_tr_b16 a[8:9], v30 offset:8192
    v_accvgpr_read_b32 v40, a64
    v_accvgpr_read_b32 v41, a65
    v_mfma_f32_32x32x16_bf16 v[128:143], a[40:43], a[36:39], v[128:143]
    ds_read_b64_tr_b16 a[10:11], v30 offset:9216
    v_accvgpr_read_b32 v42, a66
    v_accvgpr_read_b32 v43, a67
    v_mfma_f32_32x32x16_bf16 v[80:95], a[44:47], a[32:35], v[80:95]
    ds_read_b128 a[4:7], v28 offset:16384
    ds_read_b64_tr_b16 a[12:13], v31 offset:8192
    v_accvgpr_read_b32 v44, a68
    v_accvgpr_read_b32 v45, a69
    v_mfma_f32_32x32x16_bf16 v[144:159], a[44:47], a[36:39], v[144:159]
    ds_read_b64_tr_b16 a[14:15], v31 offset:9216
    v_accvgpr_read_b32 v46, a70
    v_accvgpr_read_b32 v47, a71
    v_mfma_f32_32x32x16_bf16 v[96:111], a[48:51], a[32:35], v[96:111]
    ds_read_b64_tr_b16 a[16:17], v32 offset:8192
    v_cvt_pk_bf16_f32 v52, v40, v41
    v_cvt_pk_bf16_f32 v53, v42, v43
    v_mfma_f32_32x32x16_bf16 v[160:175], a[48:51], a[36:39], v[160:175]
    ds_read_b64_tr_b16 a[18:19], v32 offset:9216
    ds_read_b64_tr_b16 a[20:21], v33 offset:8192
    v_cvt_pk_bf16_f32 v54, v44, v45
    v_cvt_pk_bf16_f32 v55, v46, v47
    v_mfma_f32_32x32x16_bf16 v[112:127], a[52:55], a[32:35], v[112:127]
    ds_read_b64_tr_b16 a[22:23], v33 offset:9216
    s_add_u32 s60, s76, 8192
    buffer_store_dwordx4 v[52:55], v7, s[32:35], s60 offen sc1
    v_mfma_f32_32x32x16_bf16 v[176:191], a[52:55], a[36:39], v[176:191]
    ds_read_b64_tr_b16 a[24:25], v34 offset:4096
    ds_read_b64_tr_b16 a[26:27], v34 offset:4608
    v_mfma_f32_32x32x16_bf16 v[192:207], a[56:59], a[32:35], v[192:207]
    ds_read_b64_tr_b16 a[28:29], v35 offset:4096
    v_accvgpr_read_b32 v40, a72
    v_accvgpr_read_b32 v41, a73
    v_mfma_f32_32x32x16_bf16 v[208:223], a[56:59], a[36:39], v[208:223]
    ds_read_b64_tr_b16 a[30:31], v35 offset:4608
    v_accvgpr_read_b32 v42, a74
    v_accvgpr_read_b32 v43, a75
    v_mfma_f32_32x32x16_bf16 v[224:239], a[32:35], a[60:63], v[224:239]
    v_accvgpr_read_b32 v44, a76
    v_accvgpr_read_b32 v45, a77
    v_mfma_f32_32x32x16_bf16 v[240:255], a[36:39], a[60:63], v[240:255]
    v_accvgpr_read_b32 v46, a78
    v_accvgpr_read_b32 v47, a79
    s_waitcnt lgkmcnt(0)
    v_mfma_f32_32x32x16_bf16 v[64:79], a[8:11], a[0:3], v[64:79]
    ds_read_b128 a[32:35], v29 offset:0
    ds_read_b64_tr_b16 a[40:41], v30 offset:12288
    v_cvt_pk_bf16_f32 v48, v40, v41
    v_cvt_pk_bf16_f32 v49, v42, v43
    v_mfma_f32_32x32x16_bf16 v[128:143], a[8:11], a[4:7], v[128:143]
    ds_read_b64_tr_b16 a[42:43], v30 offset:13312
    v_cvt_pk_bf16_f32 v50, v44, v45
    v_cvt_pk_bf16_f32 v51, v46, v47
    v_mfma_f32_32x32x16_bf16 v[80:95], a[12:15], a[0:3], v[80:95]
    ds_read_b128 a[36:39], v29 offset:16384
    ds_read_b64_tr_b16 a[44:45], v31 offset:12288
    s_add_u32 s60, s77, 8192
    buffer_store_dwordx4 v[48:51], v7, s[32:35], s60 offen sc1
    v_mfma_f32_32x32x16_bf16 v[144:159], a[12:15], a[4:7], v[144:159]
    ds_read_b64_tr_b16 a[46:47], v31 offset:13312
    v_mfma_f32_32x32x16_bf16 v[96:111], a[16:19], a[0:3], v[96:111]
    ds_read_b64_tr_b16 a[48:49], v32 offset:12288
    v_accvgpr_read_b32 v40, a80
    v_accvgpr_read_b32 v41, a81
    v_mfma_f32_32x32x16_bf16 v[160:175], a[16:19], a[4:7], v[160:175]
    ds_read_b64_tr_b16 a[50:51], v32 offset:13312
    ds_read_b64_tr_b16 a[52:53], v33 offset:12288
    v_accvgpr_read_b32 v42, a82
    v_accvgpr_read_b32 v43, a83
    v_mfma_f32_32x32x16_bf16 v[112:127], a[20:23], a[0:3], v[112:127]
    ds_read_b64_tr_b16 a[54:55], v33 offset:13312
    v_accvgpr_read_b32 v44, a84
    v_accvgpr_read_b32 v45, a85
    v_mfma_f32_32x32x16_bf16 v[176:191], a[20:23], a[4:7], v[176:191]
    ds_read_b64_tr_b16 a[56:57], v34 offset:6144
    ds_read_b64_tr_b16 a[58:59], v34 offset:6656
    v_accvgpr_read_b32 v46, a86
    v_accvgpr_read_b32 v47, a87
    v_mfma_f32_32x32x16_bf16 v[192:207], a[24:27], a[0:3], v[192:207]
    ds_read_b64_tr_b16 a[60:61], v35 offset:6144
    v_cvt_pk_bf16_f32 v52, v40, v41
    v_cvt_pk_bf16_f32 v53, v42, v43
    v_mfma_f32_32x32x16_bf16 v[208:223], a[24:27], a[4:7], v[208:223]
    ds_read_b64_tr_b16 a[62:63], v35 offset:6656
    v_cvt_pk_bf16_f32 v54, v44, v45
    v_cvt_pk_bf16_f32 v55, v46, v47
    v_mfma_f32_32x32x16_bf16 v[224:239], a[0:3], a[28:31], v[224:239]
    s_add_u32 s60, s78, 8192
    buffer_store_dwordx4 v[52:55], v7, s[32:35], s60 offen sc1
    v_mfma_f32_32x32x16_bf16 v[240:255], a[4:7], a[28:31], v[240:255]
    s_waitcnt lgkmcnt(0)
    v_mfma_f32_32x32x16_bf16 v[64:79], a[40:43], a[32:35], v[64:79]
    v_mfma_f32_32x32x16_bf16 v[128:143], a[40:43], a[36:39], v[128:143]
    s_waitcnt vmcnt(19)
    s_barrier
    v_mfma_f32_32x32x16_bf16 v[80:95], a[44:47], a[32:35], v[80:95]
    v_xor_b32 v26, 0x10000, v26
    v_xor_b32 v27, 0x10000, v27
    v_xor_b32 v28, 0x10000, v28
    v_xor_b32 v29, 0x10000, v29
    v_xor_b32 v30, 0x10000, v30
    v_xor_b32 v31, 0x10000, v31
    v_xor_b32 v32, 0x10000, v32
    v_xor_b32 v33, 0x10000, v33
    v_xor_b32 v34, 0x10000, v34
    v_xor_b32 v35, 0x10000, v35
    v_mfma_f32_32x32x16_bf16 v[144:159], a[44:47], a[36:39], v[144:159]
    ds_read_b128 a[0:3], v26 offset:0
    ds_read_b64_tr_b16 a[8:9], v30 offset:0
    s_mov_b32 m0, s50
    s_nop 0
    buffer_load_dwordx4 v16, s[24:27], s55 offen lds
    v_mfma_f32_32x32x16_bf16 v[96:111], a[48:51], a[32:35], v[96:111]
    ds_read_b64_tr_b16 a[10:11], v30 offset:1024
    ds_read_b128 a[4:7], v26 offset:16384
    buffer_load_dwordx4 v17, s[24:27], s55 offen offset:1024 lds
    v_mfma_f32_32x32x16_bf16 v[160:175], a[48:51], a[36:39], v[160:175]
    ds_read_b64_tr_b16 a[12:13], v31 offset:0
    ds_read_b64_tr_b16 a[14:15], v31 offset:1024
    v_mfma_f32_32x32x16_bf16 v[112:127], a[52:55], a[32:35], v[112:127]
    ds_read_b64_tr_b16 a[16:17], v32 offset:0
    buffer_load_dwordx4 v18, s[24:27], s55 offen offset:2048 lds
    v_mfma_f32_32x32x16_bf16 v[176:191], a[52:55], a[36:39], v[176:191]
    ds_read_b64_tr_b16 a[18:19], v32 offset:1024
    ds_read_b64_tr_b16 a[20:21], v33 offset:0
    v_mfma_f32_32x32x16_bf16 v[192:207], a[56:59], a[32:35], v[192:207]
    ds_read_b64_tr_b16 a[22:23], v33 offset:1024
    ds_read_b64_tr_b16 a[24:25], v34 offset:0
    buffer_load_dwordx4 v19, s[24:27], s55 offen offset:3072 lds
    v_mfma_f32_32x32x16_bf16 v[208:223], a[56:59], a[36:39], v[208:223]
    ds_read_b64_tr_b16 a[26:27], v34 offset:512
    ds_read_b64_tr_b16 a[28:29], v35 offset:0
    v_mfma_f32_32x32x16_bf16 v[224:239], a[32:35], a[60:63], v[224:239]
    ds_read_b64_tr_b16 a[30:31], v35 offset:512
    s_mov_b32 m0, s51
    s_nop 0
    buffer_load_dwordx4 v24, s[28:31], s56 offen lds
    v_mfma_f32_32x32x16_bf16 v[240:255], a[36:39], a[60:63], v[240:255]
    s_waitcnt lgkmcnt(0)
    v_mfma_f32_32x32x16_bf16 v[64:79], a[8:11], a[0:3], v[64:79]
    ds_read_b128 a[32:35], v27 offset:0
    ds_read_b64_tr_b16 a[40:41], v30 offset:4096
    buffer_load_dwordx4 v25, s[28:31], s56 offen offset:1024 lds
    v_mfma_f32_32x32x16_bf16 v[128:143], a[8:11], a[4:7], v[128:143]
    ds_read_b64_tr_b16 a[42:43], v30 offset:5120
    v_mfma_f32_32x32x16_bf16 v[80:95], a[12:15], a[0:3], v[80:95]
    ds_read_b128 a[36:39], v27 offset:16384
    ds_read_b64_tr_b16 a[44:45], v31 offset:4096
    s_add_u32 m0, s48, 0
    s_nop 0
    buffer_load_dwordx4 v8, s[8:11], s54 offen lds
    v_mfma_f32_32x32x16_bf16 v[144:159], a[12:15], a[4:7], v[144:159]
    ds_read_b64_tr_b16 a[46:47], v31 offset:5120
    v_mfma_f32_32x32x16_bf16 v[96:111], a[16:19], a[0:3], v[96:111]
    ds_read_b64_tr_b16 a[48:49], v32 offset:4096
    buffer_load_dwordx4 v9, s[8:11], s54 offen offset:1024 lds
    v_mfma_f32_32x32x16_bf16 v[160:175], a[16:19], a[4:7], v[160:175]
    ds_read_b64_tr_b16 a[50:51], v32 offset:5120
    ds_read_b64_tr_b16 a[52:53], v33 offset:4096
    v_mfma_f32_32x32x16_bf16 v[112:127], a[20:23], a[0:3], v[112:127]
    ds_read_b64_tr_b16 a[54:55], v33 offset:5120
    buffer_load_dwordx4 v10, s[8:11], s54 offen offset:2048 lds
    v_mfma_f32_32x32x16_bf16 v[176:191], a[20:23], a[4:7], v[176:191]
    ds_read_b64_tr_b16 a[56:57], v34 offset:2048
    ds_read_b64_tr_b16 a[58:59], v34 offset:2560
    v_mfma_f32_32x32x16_bf16 v[192:207], a[24:27], a[0:3], v[192:207]
    ds_read_b64_tr_b16 a[60:61], v35 offset:2048
    buffer_load_dwordx4 v11, s[8:11], s54 offen offset:3072 lds
    v_mfma_f32_32x32x16_bf16 v[208:223], a[24:27], a[4:7], v[208:223]
    ds_read_b64_tr_b16 a[62:63], v35 offset:2560
    v_mfma_f32_32x32x16_bf16 v[224:239], a[0:3], a[28:31], v[224:239]
    s_add_u32 m0, s48, 4096
    s_nop 0
    buffer_load_dwordx4 v12, s[8:11], s54 offen lds
    v_mfma_f32_32x32x16_bf16 v[240:255], a[4:7], a[28:31], v[240:255]
    s_waitcnt lgkmcnt(0)
    v_mfma_f32_32x32x16_bf16 v[64:79], a[40:43], a[32:35], v[64:79]
    ds_read_b128 a[0:3], v28 offset:0
    ds_read_b64_tr_b16 a[8:9], v30 offset:8192
    buffer_load_dwordx4 v13, s[8:11], s54 offen offset:1024 lds
    v_mfma_f32_32x32x16_bf16 v[128:143], a[40:43], a[36:39], v[128:143]
    ds_read_b64_tr_b16 a[10:11], v30 offset:9216
    v_mfma_f32_32x32x16_bf16 v[80:95], a[44:47], a[32:35], v[80:95]
    ds_read_b128 a[4:7], v28 offset:16384
    ds_read_b64_tr_b16 a[12:13], v31 offset:8192
    buffer_load_dwordx4 v14, s[8:11], s54 offen offset:2048 lds
    v_mfma_f32_32x32x16_bf16 v[144:159], a[44:47], a[36:39], v[144:159]
    ds_read_b64_tr_b16 a[14:15], v31 offset:9216
    v_mfma_f32_32x32x16_bf16 v[96:111], a[48:51], a[32:35], v[96:111]
    ds_read_b64_tr_b16 a[16:17], v32 offset:8192
    buffer_load_dwordx4 v15, s[8:11], s54 offen offset:3072 lds
    s_add_u32 s54, s54, 128
    s_add_u32 s55, s55, 524288
    s_add_u32 s56, s56, 196608
    s_xor_b32 s48, s48, 0x10000
    s_xor_b32 s49, s49, 0x10000
    s_xor_b32 s50, s50, 0x10000
    s_xor_b32 s51, s51, 0x10000
    v_mfma_f32_32x32x16_bf16 v[160:175], a[48:51], a[36:39], v[160:175]
    ds_read_b64_tr_b16 a[18:19], v32 offset:9216
    ds_read_b64_tr_b16 a[20:21], v33 offset:8192
    v_mfma_f32_32x32x16_bf16 v[112:127], a[52:55], a[32:35], v[112:127]
    ds_read_b64_tr_b16 a[22:23], v33 offset:9216
    v_mfma_f32_32x32x16_bf16 v[176:191], a[52:55], a[36:39], v[176:191]
    ds_read_b64_tr_b16 a[24:25], v34 offset:4096
    ds_read_b64_tr_b16 a[26:27], v34 offset:4608
    v_accvgpr_read_b32 v40, a88
    v_accvgpr_read_b32 v41, a89
    v_accvgpr_read_b32 v42, a90
    v_accvgpr_read_b32 v43, a91
    v_mfma_f32_32x32x16_bf16 v[192:207], a[56:59], a[32:35], v[192:207]
    ds_read_b64_tr_b16 a[28:29], v35 offset:4096
    v_accvgpr_read_b32 v44, a92
    v_accvgpr_read_b32 v45, a93
    v_mfma_f32_32x32x16_bf16 v[208:223], a[56:59], a[36:39], v[208:223]
    ds_read_b64_tr_b16 a[30:31], v35 offset:4608
    v_accvgpr_read_b32 v46, a94
    v_accvgpr_read_b32 v47, a95
    v_mfma_f32_32x32x16_bf16 v[224:239], a[32:35], a[60:63], v[224:239]
    v_cvt_pk_bf16_f32 v48, v40, v41
    v_cvt_pk_bf16_f32 v49, v42, v43
    v_mfma_f32_32x32x16_bf16 v[240:255], a[36:39], a[60:63], v[240:255]
    v_cvt_pk_bf16_f32 v50, v44, v45
    v_cvt_pk_bf16_f32 v51, v46, v47
    s_add_u32 s60, s79, 8192
    buffer_store_dwordx4 v[48:51], v7, s[32:35], s60 offen sc1
    s_waitcnt lgkmcnt(0)
    v_mfma_f32_32x32x16_bf16 v[64:79], a[8:11], a[0:3], v[64:79]
    ds_read_b128 a[32:35], v29 offset:0
    ds_read_b64_tr_b16 a[40:41], v30 offset:12288
    v_accvgpr_read_b32 v40, a96
    v_accvgpr_read_b32 v41, a97
    v_mfma_f32_32x32x16_bf16 v[128:143], a[8:11], a[4:7], v[128:143]
    ds_read_b64_tr_b16 a[42:43], v30 offset:13312
    v_accvgpr_read_b32 v42, a98
    v_accvgpr_read_b32 v43, a99
    v_mfma_f32_32x32x16_bf16 v[80:95], a[12:15], a[0:3], v[80:95]
    ds_read_b128 a[36:39], v29 offset:16384
    ds_read_b64_tr_b16 a[44:45], v31 offset:12288
    v_accvgpr_read_b32 v44, a100
    v_accvgpr_read_b32 v45, a101
    v_mfma_f32_32x32x16_bf16 v[144:159], a[12:15], a[4:7], v[144:159]
    ds_read_b64_tr_b16 a[46:47], v31 offset:13312
    v_accvgpr_read_b32 v46, a102
    v_accvgpr_read_b32 v47, a103
    v_cvt_pk_bf16_f32 v52, v40, v41
    v_cvt_pk_bf16_f32 v53, v42, v43
    v_mfma_f32_32x32x16_bf16 v[96:111], a[16:19], a[0:3], v[96:111]
    ds_read_b64_tr_b16 a[48:49], v32 offset:12288
    v_cvt_pk_bf16_f32 v54, v44, v45
    v_cvt_pk_bf16_f32 v55, v46, v47
    v_mfma_f32_32x32x16_bf16 v[160:175], a[16:19], a[4:7], v[160:175]
    ds_read_b64_tr_b16 a[50:51], v32 offset:13312
    ds_read_b64_tr_b16 a[52:53], v33 offset:12288
    s_add_u32 s60, s80, 8192
    buffer_store_dwordx4 v[52:55], v7, s[32:35], s60 offen sc1
    v_mfma_f32_32x32x16_bf16 v[112:127], a[20:23], a[0:3], v[112:127]
    ds_read_b64_tr_b16 a[54:55], v33 offset:13312
    v_accvgpr_read_b32 v40, a104
    v_accvgpr_read_b32 v41, a105
    v_mfma_f32_32x32x16_bf16 v[176:191], a[20:23], a[4:7], v[176:191]
    ds_read_b64_tr_b16 a[56:57], v34 offset:6144
    ds_read_b64_tr_b16 a[58:59], v34 offset:6656
    v_accvgpr_read_b32 v42, a106
    v_accvgpr_read_b32 v43, a107
    v_accvgpr_read_b32 v44, a108
    v_accvgpr_read_b32 v45, a109
    v_mfma_f32_32x32x16_bf16 v[192:207], a[24:27], a[0:3], v[192:207]
    ds_read_b64_tr_b16 a[60:61], v35 offset:6144
    v_accvgpr_read_b32 v46, a110
    v_accvgpr_read_b32 v47, a111
    v_mfma_f32_32x32x16_bf16 v[208:223], a[24:27], a[4:7], v[208:223]
    ds_read_b64_tr_b16 a[62:63], v35 offset:6656
    v_cvt_pk_bf16_f32 v48, v40, v41
    v_cvt_pk_bf16_f32 v49, v42, v43
    v_mfma_f32_32x32x16_bf16 v[224:239], a[0:3], a[28:31], v[224:239]
    v_cvt_pk_bf16_f32 v50, v44, v45
    v_cvt_pk_bf16_f32 v51, v46, v47
    v_mfma_f32_32x32x16_bf16 v[240:255], a[4:7], a[28:31], v[240:255]
    s_add_u32 s60, s81, 8192
    buffer_store_dwordx4 v[48:51], v7, s[32:35], s60 offen sc1
    s_waitcnt lgkmcnt(0)
    v_mfma_f32_32x32x16_bf16 v[64:79], a[40:43], a[32:35], v[64:79]
    v_mfma_f32_32x32x16_bf16 v[128:143], a[40:43], a[36:39], v[128:143]
    s_waitcnt vmcnt(3)
    s_barrier
    v_mfma_f32_32x32x16_bf16 v[80:95], a[44:47], a[32:35], v[80:95]
    v_xor_b32 v26, 0x10000, v26
    v_xor_b32 v27, 0x10000, v27
    v_xor_b32 v28, 0x10000, v28
    v_xor_b32 v29, 0x10000, v29
    v_xor_b32 v30, 0x10000, v30
    v_xor_b32 v31, 0x10000, v31
    v_xor_b32 v32, 0x10000, v32
    v_xor_b32 v33, 0x10000, v33
    v_xor_b32 v34, 0x10000, v34
    v_xor_b32 v35, 0x10000, v35
    v_mfma_f32_32x32x16_bf16 v[144:159], a[44:47], a[36:39], v[144:159]
    ds_read_b128 a[0:3], v26 offset:0
    ds_read_b64_tr_b16 a[8:9], v30 offset:0
    s_mov_b32 m0, s50
    s_nop 0
    buffer_load_dwordx4 v16, s[24:27], s55 offen lds
    v_mfma_f32_32x32x16_bf16 v[96:111], a[48:51], a[32:35], v[96:111]
    ds_read_b64_tr_b16 a[10:11], v30 offset:1024
    ds_read_b128 a[4:7], v26 offset:16384
    buffer_load_dwordx4 v17, s[24:27], s55 offen offset:1024 lds
    v_mfma_f32_32x32x16_bf16 v[160:175], a[48:51], a[36:39], v[160:175]
    ds_read_b64_tr_b16 a[12:13], v31 offset:0
    ds_read_b64_tr_b16 a[14:15], v31 offset:1024
    v_mfma_f32_32x32x16_bf16 v[112:127], a[52:55], a[32:35], v[112:127]
    ds_read_b64_tr_b16 a[16:17], v32 offset:0
    buffer_load_dwordx4 v18, s[24:27], s55 offen offset:2048 lds
    v_mfma_f32_32x32x16_bf16 v[176:191], a[52:55], a[36:39], v[176:191]
    ds_read_b64_tr_b16 a[18:19], v32 offset:1024
    ds_read_b64_tr_b16 a[20:21], v33 offset:0
    v_mfma_f32_32x32x16_bf16 v[192:207], a[56:59], a[32:35], v[192:207]
    ds_read_b64_tr_b16 a[22:23], v33 offset:1024
    ds_read_b64_tr_b16 a[24:25], v34 offset:0
    buffer_load_dwordx4 v19, s[24:27], s55 offen offset:3072 lds
    v_mfma_f32_32x32x16_bf16 v[208:223], a[56:59], a[36:39], v[208:223]
    ds_read_b64_tr_b16 a[26:27], v34 offset:512
    ds_read_b64_tr_b16 a[28:29], v35 offset:0
    v_mfma_f32_32x32x16_bf16 v[224:239], a[32:35], a[60:63], v[224:239]
    ds_read_b64_tr_b16 a[30:31], v35 offset:512
    s_mov_b32 m0, s51
    s_nop 0
    buffer_load_dwordx4 v24, s[28:31], s56 offen lds
    v_mfma_f32_32x32x16_bf16 v[240:255], a[36:39], a[60:63], v[240:255]
    s_waitcnt lgkmcnt(0)
    v_mfma_f32_32x32x16_bf16 v[64:79], a[8:11], a[0:3], v[64:79]
    ds_read_b128 a[32:35], v27 offset:0
    ds_read_b64_tr_b16 a[40:41], v30 offset:4096
    buffer_load_dwordx4 v25, s[28:31], s56 offen offset:1024 lds
    v_mfma_f32_32x32x16_bf16 v[128:143], a[8:11], a[4:7], v[128:143]
    ds_read_b64_tr_b16 a[42:43], v30 offset:5120
    v_mfma_f32_32x32x16_bf16 v[80:95], a[12:15], a[0:3], v[80:95]
    ds_read_b128 a[36:39], v27 offset:16384
    ds_read_b64_tr_b16 a[44:45], v31 offset:4096
    s_add_u32 m0, s48, 0
    s_nop 0
    buffer_load_dwordx4 v8, s[8:11], s54 offen lds
    v_mfma_f32_32x32x16_bf16 v[144:159], a[12:15], a[4:7], v[144:159]
    ds_read_b64_tr_b16 a[46:47], v31 offset:5120
    v_mfma_f32_32x32x16_bf16 v[96:111], a[16:19], a[0:3], v[96:111]
    ds_read_b64_tr_b16 a[48:49], v32 offset:4096
    buffer_load_dwordx4 v9, s[8:11], s54 offen offset:1024 lds
    v_mfma_f32_32x32x16_bf16 v[160:175], a[16:19], a[4:7], v[160:175]
    ds_read_b64_tr_b16 a[50:51], v32 offset:5120
    ds_read_b64_tr_b16 a[52:53], v33 offset:4096
    v_mfma_f32_32x32x16_bf16 v[112:127], a[20:23], a[0:3], v[112:127]
    ds_read_b64_tr_b16 a[54:55], v33 offset:5120
    buffer_load_dwordx4 v10, s[8:11], s54 offen offset:2048 lds
    v_mfma_f32_32x32x16_bf16 v[176:191], a[20:23], a[4:7], v[176:191]
    ds_read_b64_tr_b16 a[56:57], v34 offset:2048
    ds_read_b64_tr_b16 a[58:59], v34 offset:2560
    v_mfma_f32_32x32x16_bf16 v[192:207], a[24:27], a[0:3], v[192:207]
    ds_read_b64_tr_b16 a[60:61], v35 offset:2048
    buffer_load_dwordx4 v11, s[8:11], s54 offen offset:3072 lds
    v_mfma_f32_32x32x16_bf16 v[208:223], a[24:27], a[4:7], v[208:223]
    ds_read_b64_tr_b16 a[62:63], v35 offset:2560
    v_mfma_f32_32x32x16_bf16 v[224:239], a[0:3], a[28:31], v[224:239]
    s_add_u32 m0, s48, 4096
    s_nop 0
    buffer_load_dwordx4 v12, s[8:11], s54 offen lds
    v_mfma_f32_32x32x16_bf16 v[240:255], a[4:7], a[28:31], v[240:255]
    s_waitcnt lgkmcnt(0)
    v_mfma_f32_32x32x16_bf16 v[64:79], a[40:43], a[32:35], v[64:79]
    ds_read_b128 a[0:3], v28 offset:0
    ds_read_b64_tr_b16 a[8:9], v30 offset:8192
    buffer_load_dwordx4 v13, s[8:11], s54 offen offset:1024 lds
    v_mfma_f32_32x32x16_bf16 v[128:143], a[40:43], a[36:39], v[128:143]
    ds_read_b64_tr_b16 a[10:11], v30 offset:9216
    v_mfma_f32_32x32x16_bf16 v[80:95], a[44:47], a[32:35], v[80:95]
    ds_read_b128 a[4:7], v28 offset:16384
    ds_read_b64_tr_b16 a[12:13], v31 offset:8192
    buffer_load_dwordx4 v14, s[8:11], s54 offen offset:2048 lds
    v_mfma_f32_32x32x16_bf16 v[144:159], a[44:47], a[36:39], v[144:159]
    ds_read_b64_tr_b16 a[14:15], v31 offset:9216
    v_mfma_f32_32x32x16_bf16 v[96:111], a[48:51], a[32:35], v[96:111]
    ds_read_b64_tr_b16 a[16:17], v32 offset:8192
    buffer_load_dwordx4 v15, s[8:11], s54 offen offset:3072 lds
    s_add_u32 s54, s54, 128
    s_add_u32 s55, s55, 524288
    s_add_u32 s56, s56, 196608
    s_xor_b32 s48, s48, 0x10000
    s_xor_b32 s49, s49, 0x10000
    s_xor_b32 s50, s50, 0x10000
    s_xor_b32 s51, s51, 0x10000
    v_mfma_f32_32x32x16_bf16 v[160:175], a[48:51], a[36:39], v[160:175]
    ds_read_b64_tr_b16 a[18:19], v32 offset:9216
    ds_read_b64_tr_b16 a[20:21], v33 offset:8192
    v_mfma_f32_32x32x16_bf16 v[112:127], a[52:55], a[32:35], v[112:127]
    ds_read_b64_tr_b16 a[22:23], v33 offset:9216
    v_mfma_f32_32x32x16_bf16 v[176:191], a[52:55], a[36:39], v[176:191]
    ds_read_b64_tr_b16 a[24:25], v34 offset:4096
    ds_read_b64_tr_b16 a[26:27], v34 offset:4608
    v_accvgpr_read_b32 v40, a112
    v_accvgpr_read_b32 v41, a113
    v_accvgpr_read_b32 v42, a114
    v_accvgpr_read_b32 v43, a115
    v_mfma_f32_32x32x16_bf16 v[192:207], a[56:59], a[32:35], v[192:207]
    ds_read_b64_tr_b16 a[28:29], v35 offset:4096
    v_accvgpr_read_b32 v44, a116
    v_accvgpr_read_b32 v45, a117
    v_mfma_f32_32x32x16_bf16 v[208:223], a[56:59], a[36:39], v[208:223]
    ds_read_b64_tr_b16 a[30:31], v35 offset:4608
    v_accvgpr_read_b32 v46, a118
    v_accvgpr_read_b32 v47, a119
    v_mfma_f32_32x32x16_bf16 v[224:239], a[32:35], a[60:63], v[224:239]
    v_cvt_pk_bf16_f32 v52, v40, v41
    v_cvt_pk_bf16_f32 v53, v42, v43
    v_mfma_f32_32x32x16_bf16 v[240:255], a[36:39], a[60:63], v[240:255]
    v_cvt_pk_bf16_f32 v54, v44, v45
    v_cvt_pk_bf16_f32 v55, v46, v47
    s_add_u32 s60, s82, 8192
    buffer_store_dwordx4 v[52:55], v7, s[32:35], s60 offen sc1
    s_waitcnt lgkmcnt(0)
    v_mfma_f32_32x32x16_bf16 v[64:79], a[8:11], a[0:3], v[64:79]
    ds_read_b128 a[32:35], v29 offset:0
    ds_read_b64_tr_b16 a[40:41], v30 offset:12288
    v_accvgpr_read_b32 v40, a120
    v_accvgpr_read_b32 v41, a121
    v_mfma_f32_32x32x16_bf16 v[128:143], a[8:11], a[4:7], v[128:143]
    ds_read_b64_tr_b16 a[42:43], v30 offset:13312
    v_accvgpr_read_b32 v42, a122
    v_accvgpr_read_b32 v43, a123
    v_mfma_f32_32x32x16_bf16 v[80:95], a[12:15], a[0:3], v[80:95]
    ds_read_b128 a[36:39], v29 offset:16384
    ds_read_b64_tr_b16 a[44:45], v31 offset:12288
    v_accvgpr_read_b32 v44, a124
    v_accvgpr_read_b32 v45, a125
    v_mfma_f32_32x32x16_bf16 v[144:159], a[12:15], a[4:7], v[144:159]
    ds_read_b64_tr_b16 a[46:47], v31 offset:13312
    v_accvgpr_read_b32 v46, a126
    v_accvgpr_read_b32 v47, a127
    v_cvt_pk_bf16_f32 v48, v40, v41
    v_cvt_pk_bf16_f32 v49, v42, v43
    v_mfma_f32_32x32x16_bf16 v[96:111], a[16:19], a[0:3], v[96:111]
    ds_read_b64_tr_b16 a[48:49], v32 offset:12288
    v_cvt_pk_bf16_f32 v50, v44, v45
    v_cvt_pk_bf16_f32 v51, v46, v47
    v_mfma_f32_32x32x16_bf16 v[160:175], a[16:19], a[4:7], v[160:175]
    ds_read_b64_tr_b16 a[50:51], v32 offset:13312
    ds_read_b64_tr_b16 a[52:53], v33 offset:12288
    s_add_u32 s60, s83, 8192
    buffer_store_dwordx4 v[48:51], v7, s[32:35], s60 offen sc1
    v_mfma_f32_32x32x16_bf16 v[112:127], a[20:23], a[0:3], v[112:127]
    ds_read_b64_tr_b16 a[54:55], v33 offset:13312
    v_accvgpr_read_b32 v40, a128
    v_accvgpr_read_b32 v41, a129
    v_mfma_f32_32x32x16_bf16 v[176:191], a[20:23], a[4:7], v[176:191]
    ds_read_b64_tr_b16 a[56:57], v34 offset:6144
    ds_read_b64_tr_b16 a[58:59], v34 offset:6656
    v_accvgpr_read_b32 v42, a130
    v_accvgpr_read_b32 v43, a131
    v_accvgpr_read_b32 v44, a132
    v_accvgpr_read_b32 v45, a133
    v_mfma_f32_32x32x16_bf16 v[192:207], a[24:27], a[0:3], v[192:207]
    ds_read_b64_tr_b16 a[60:61], v35 offset:6144
    v_accvgpr_read_b32 v46, a134
    v_accvgpr_read_b32 v47, a135
    v_mfma_f32_32x32x16_bf16 v[208:223], a[24:27], a[4:7], v[208:223]
    ds_read_b64_tr_b16 a[62:63], v35 offset:6656
    v_cvt_pk_bf16_f32 v52, v40, v41
    v_cvt_pk_bf16_f32 v53, v42, v43
    v_mfma_f32_32x32x16_bf16 v[224:239], a[0:3], a[28:31], v[224:239]
    v_cvt_pk_bf16_f32 v54, v44, v45
    v_cvt_pk_bf16_f32 v55, v46, v47
    v_mfma_f32_32x32x16_bf16 v[240:255], a[4:7], a[28:31], v[240:255]
    s_add_u32 s60, s76, 32768
    buffer_store_dwordx4 v[52:55], v7, s[32:35], s60 offen sc1
    s_waitcnt lgkmcnt(0)
    v_mfma_f32_32x32x16_bf16 v[64:79], a[40:43], a[32:35], v[64:79]
    v_mfma_f32_32x32x16_bf16 v[128:143], a[40:43], a[36:39], v[128:143]
    s_waitcnt vmcnt(3)
    s_barrier
    v_mfma_f32_32x32x16_bf16 v[80:95], a[44:47], a[32:35], v[80:95]
    v_xor_b32 v26, 0x10000, v26
    v_xor_b32 v27, 0x10000, v27
    v_xor_b32 v28, 0x10000, v28
    v_xor_b32 v29, 0x10000, v29
    v_xor_b32 v30, 0x10000, v30
    v_xor_b32 v31, 0x10000, v31
    v_xor_b32 v32, 0x10000, v32
    v_xor_b32 v33, 0x10000, v33
    v_xor_b32 v34, 0x10000, v34
    v_xor_b32 v35, 0x10000, v35
    v_mfma_f32_32x32x16_bf16 v[144:159], a[44:47], a[36:39], v[144:159]
    ds_read_b128 a[0:3], v26 offset:0
    ds_read_b64_tr_b16 a[8:9], v30 offset:0
    s_mov_b32 m0, s50
    s_nop 0
    buffer_load_dwordx4 v16, s[24:27], s55 offen lds
    v_mfma_f32_32x32x16_bf16 v[96:111], a[48:51], a[32:35], v[96:111]
    ds_read_b64_tr_b16 a[10:11], v30 offset:1024
    ds_read_b128 a[4:7], v26 offset:16384
    buffer_load_dwordx4 v17, s[24:27], s55 offen offset:1024 lds
    v_mfma_f32_32x32x16_bf16 v[160:175], a[48:51], a[36:39], v[160:175]
    ds_read_b64_tr_b16 a[12:13], v31 offset:0
    ds_read_b64_tr_b16 a[14:15], v31 offset:1024
    v_mfma_f32_32x32x16_bf16 v[112:127], a[52:55], a[32:35], v[112:127]
    ds_read_b64_tr_b16 a[16:17], v32 offset:0
    buffer_load_dwordx4 v18, s[24:27], s55 offen offset:2048 lds
    v_mfma_f32_32x32x16_bf16 v[176:191], a[52:55], a[36:39], v[176:191]
    ds_read_b64_tr_b16 a[18:19], v32 offset:1024
    ds_read_b64_tr_b16 a[20:21], v33 offset:0
    v_mfma_f32_32x32x16_bf16 v[192:207], a[56:59], a[32:35], v[192:207]
    ds_read_b64_tr_b16 a[22:23], v33 offset:1024
    ds_read_b64_tr_b16 a[24:25], v34 offset:0
    buffer_load_dwordx4 v19, s[24:27], s55 offen offset:3072 lds
    v_mfma_f32_32x32x16_bf16 v[208:223], a[56:59], a[36:39], v[208:223]
    ds_read_b64_tr_b16 a[26:27], v34 offset:512
    ds_read_b64_tr_b16 a[28:29], v35 offset:0
    v_mfma_f32_32x32x16_bf16 v[224:239], a[32:35], a[60:63], v[224:239]
    ds_read_b64_tr_b16 a[30:31], v35 offset:512
    s_mov_b32 m0, s51
    s_nop 0
    buffer_load_dwordx4 v24, s[28:31], s56 offen lds
    v_mfma_f32_32x32x16_bf16 v[240:255], a[36:39], a[60:63], v[240:255]
    s_waitcnt lgkmcnt(0)
    v_mfma_f32_32x32x16_bf16 v[64:79], a[8:11], a[0:3], v[64:79]
    ds_read_b128 a[32:35], v27 offset:0
    ds_read_b64_tr_b16 a[40:41], v30 offset:4096
    buffer_load_dwordx4 v25, s[28:31], s56 offen offset:1024 lds
    v_mfma_f32_32x32x16_bf16 v[128:143], a[8:11], a[4:7], v[128:143]
    ds_read_b64_tr_b16 a[42:43], v30 offset:5120
    v_mfma_f32_32x32x16_bf16 v[80:95], a[12:15], a[0:3], v[80:95]
    ds_read_b128 a[36:39], v27 offset:16384
    ds_read_b64_tr_b16 a[44:45], v31 offset:4096
    s_add_u32 m0, s48, 0
    s_nop 0
    buffer_load_dwordx4 v8, s[8:11], s54 offen lds
    v_mfma_f32_32x32x16_bf16 v[144:159], a[12:15], a[4:7], v[144:159]
    ds_read_b64_tr_b16 a[46:47], v31 offset:5120
    v_mfma_f32_32x32x16_bf16 v[96:111], a[16:19], a[0:3], v[96:111]
    ds_read_b64_tr_b16 a[48:49], v32 offset:4096
    buffer_load_dwordx4 v9, s[8:11], s54 offen offset:1024 lds
    v_mfma_f32_32x32x16_bf16 v[160:175], a[16:19], a[4:7], v[160:175]
    ds_read_b64_tr_b16 a[50:51], v32 offset:5120
    ds_read_b64_tr_b16 a[52:53], v33 offset:4096
    v_mfma_f32_32x32x16_bf16 v[112:127], a[20:23], a[0:3], v[112:127]
    ds_read_b64_tr_b16 a[54:55], v33 offset:5120
    buffer_load_dwordx4 v10, s[8:11], s54 offen offset:2048 lds
    v_mfma_f32_32x32x16_bf16 v[176:191], a[20:23], a[4:7], v[176:191]
    ds_read_b64_tr_b16 a[56:57], v34 offset:2048
    ds_read_b64_tr_b16 a[58:59], v34 offset:2560
    v_mfma_f32_32x32x16_bf16 v[192:207], a[24:27], a[0:3], v[192:207]
    ds_read_b64_tr_b16 a[60:61], v35 offset:2048
    buffer_load_dwordx4 v11, s[8:11], s54 offen offset:3072 lds
    v_mfma_f32_32x32x16_bf16 v[208:223], a[24:27], a[4:7], v[208:223]
    ds_read_b64_tr_b16 a[62:63], v35 offset:2560
    v_mfma_f32_32x32x16_bf16 v[224:239], a[0:3], a[28:31], v[224:239]
    s_add_u32 m0, s48, 4096
    s_nop 0
    buffer_load_dwordx4 v12, s[8:11], s54 offen lds
    v_mfma_f32_32x32x16_bf16 v[240:255], a[4:7], a[28:31], v[240:255]
    s_waitcnt lgkmcnt(0)
    v_mfma_f32_32x32x16_bf16 v[64:79], a[40:43], a[32:35], v[64:79]
    ds_read_b128 a[0:3], v28 offset:0
    ds_read_b64_tr_b16 a[8:9], v30 offset:8192
    buffer_load_dwordx4 v13, s[8:11], s54 offen offset:1024 lds
    v_mfma_f32_32x32x16_bf16 v[128:143], a[40:43], a[36:39], v[128:143]
    ds_read_b64_tr_b16 a[10:11], v30 offset:9216
    v_mfma_f32_32x32x16_bf16 v[80:95], a[44:47], a[32:35], v[80:95]
    ds_read_b128 a[4:7], v28 offset:16384
    ds_read_b64_tr_b16 a[12:13], v31 offset:8192
    buffer_load_dwordx4 v14, s[8:11], s54 offen offset:2048 lds
    v_mfma_f32_32x32x16_bf16 v[144:159], a[44:47], a[36:39], v[144:159]
    ds_read_b64_tr_b16 a[14:15], v31 offset:9216
    v_mfma_f32_32x32x16_bf16 v[96:111], a[48:51], a[32:35], v[96:111]
    ds_read_b64_tr_b16 a[16:17], v32 offset:8192
    buffer_load_dwordx4 v15, s[8:11], s54 offen offset:3072 lds
    s_add_u32 s54, s54, 128
    s_add_u32 s55, s55, 524288
    s_add_u32 s56, s56, 196608
    s_xor_b32 s48, s48, 0x10000
    s_xor_b32 s49, s49, 0x10000
    s_xor_b32 s50, s50, 0x10000
    s_xor_b32 s51, s51, 0x10000
    v_mfma_f32_32x32x16_bf16 v[160:175], a[48:51], a[36:39], v[160:175]
    ds_read_b64_tr_b16 a[18:19], v32 offset:9216
    ds_read_b64_tr_b16 a[20:21], v33 offset:8192
    v_mfma_f32_32x32x16_bf16 v[112:127], a[52:55], a[32:35], v[112:127]
    ds_read_b64_tr_b16 a[22:23], v33 offset:9216
    v_mfma_f32_32x32x16_bf16 v[176:191], a[52:55], a[36:39], v[176:191]
    ds_read_b64_tr_b16 a[24:25], v34 offset:4096
    ds_read_b64_tr_b16 a[26:27], v34 offset:4608
    v_accvgpr_read_b32 v40, a136
    v_accvgpr_read_b32 v41, a137
    v_accvgpr_read_b32 v42, a138
    v_accvgpr_read_b32 v43, a139
    v_mfma_f32_32x32x16_bf16 v[192:207], a[56:59], a[32:35], v[192:207]
    ds_read_b64_tr_b16 a[28:29], v35 offset:4096
    v_accvgpr_read_b32 v44, a140
    v_accvgpr_read_b32 v45, a141
    v_mfma_f32_32x32x16_bf16 v[208:223], a[56:59], a[36:39], v[208:223]
    ds_read_b64_tr_b16 a[30:31], v35 offset:4608
    v_accvgpr_read_b32 v46, a142
    v_accvgpr_read_b32 v47, a143
    v_mfma_f32_32x32x16_bf16 v[224:239], a[32:35], a[60:63], v[224:239]
    v_cvt_pk_bf16_f32 v48, v40, v41
    v_cvt_pk_bf16_f32 v49, v42, v43
    v_mfma_f32_32x32x16_bf16 v[240:255], a[36:39], a[60:63], v[240:255]
    v_cvt_pk_bf16_f32 v50, v44, v45
    v_cvt_pk_bf16_f32 v51, v46, v47
    s_add_u32 s60, s77, 32768
    buffer_store_dwordx4 v[48:51], v7, s[32:35], s60 offen sc1
    s_waitcnt lgkmcnt(0)
    v_mfma_f32_32x32x16_bf16 v[64:79], a[8:11], a[0:3], v[64:79]
    ds_read_b128 a[32:35], v29 offset:0
    ds_read_b64_tr_b16 a[40:41], v30 offset:12288
    v_accvgpr_read_b32 v40, a144
    v_accvgpr_read_b32 v41, a145
    v_mfma_f32_32x32x16_bf16 v[128:143], a[8:11], a[4:7], v[128:143]
    ds_read_b64_tr_b16 a[42:43], v30 offset:13312
    v_accvgpr_read_b32 v42, a146
    v_accvgpr_read_b32 v43, a147
    v_mfma_f32_32x32x16_bf16 v[80:95], a[12:15], a[0:3], v[80:95]
    ds_read_b128 a[36:39], v29 offset:16384
    ds_read_b64_tr_b16 a[44:45], v31 offset:12288
    v_accvgpr_read_b32 v44, a148
    v_accvgpr_read_b32 v45, a149
    v_mfma_f32_32x32x16_bf16 v[144:159], a[12:15], a[4:7], v[144:159]
    ds_read_b64_tr_b16 a[46:47], v31 offset:13312
    v_accvgpr_read_b32 v46, a150
    v_accvgpr_read_b32 v47, a151
    v_cvt_pk_bf16_f32 v52, v40, v41
    v_cvt_pk_bf16_f32 v53, v42, v43
    v_mfma_f32_32x32x16_bf16 v[96:111], a[16:19], a[0:3], v[96:111]
    ds_read_b64_tr_b16 a[48:49], v32 offset:12288
    v_cvt_pk_bf16_f32 v54, v44, v45
    v_cvt_pk_bf16_f32 v55, v46, v47
    v_mfma_f32_32x32x16_bf16 v[160:175], a[16:19], a[4:7], v[160:175]
    ds_read_b64_tr_b16 a[50:51], v32 offset:13312
    ds_read_b64_tr_b16 a[52:53], v33 offset:12288
    s_add_u32 s60, s78, 32768
    buffer_store_dwordx4 v[52:55], v7, s[32:35], s60 offen sc1
    v_mfma_f32_32x32x16_bf16 v[112:127], a[20:23], a[0:3], v[112:127]
    ds_read_b64_tr_b16 a[54:55], v33 offset:13312
    v_accvgpr_read_b32 v40, a152
    v_accvgpr_read_b32 v41, a153
    v_mfma_f32_32x32x16_bf16 v[176:191], a[20:23], a[4:7], v[176:191]
    ds_read_b64_tr_b16 a[56:57], v34 offset:6144
    ds_read_b64_tr_b16 a[58:59], v34 offset:6656
    v_accvgpr_read_b32 v42, a154
    v_accvgpr_read_b32 v43, a155
    v_accvgpr_read_b32 v44, a156
    v_accvgpr_read_b32 v45, a157
    v_mfma_f32_32x32x16_bf16 v[192:207], a[24:27], a[0:3], v[192:207]
    ds_read_b64_tr_b16 a[60:61], v35 offset:6144
    v_accvgpr_read_b32 v46, a158
    v_accvgpr_read_b32 v47, a159
    v_mfma_f32_32x32x16_bf16 v[208:223], a[24:27], a[4:7], v[208:223]
    ds_read_b64_tr_b16 a[62:63], v35 offset:6656
    v_cvt_pk_bf16_f32 v48, v40, v41
    v_cvt_pk_bf16_f32 v49, v42, v43
    v_mfma_f32_32x32x16_bf16 v[224:239], a[0:3], a[28:31], v[224:239]
    v_cvt_pk_bf16_f32 v50, v44, v45
    v_cvt_pk_bf16_f32 v51, v46, v47
    v_mfma_f32_32x32x16_bf16 v[240:255], a[4:7], a[28:31], v[240:255]
    s_add_u32 s60, s79, 32768
    buffer_store_dwordx4 v[48:51], v7, s[32:35], s60 offen sc1
    s_waitcnt lgkmcnt(0)
    v_mfma_f32_32x32x16_bf16 v[64:79], a[40:43], a[32:35], v[64:79]
    v_mfma_f32_32x32x16_bf16 v[128:143], a[40:43], a[36:39], v[128:143]
    s_waitcnt vmcnt(3)
    s_barrier
    v_mfma_f32_32x32x16_bf16 v[80:95], a[44:47], a[32:35], v[80:95]
    v_xor_b32 v26, 0x10000, v26
    v_xor_b32 v27, 0x10000, v27
    v_xor_b32 v28, 0x10000, v28
    v_xor_b32 v29, 0x10000, v29
    v_xor_b32 v30, 0x10000, v30
    v_xor_b32 v31, 0x10000, v31
    v_xor_b32 v32, 0x10000, v32
    v_xor_b32 v33, 0x10000, v33
    v_xor_b32 v34, 0x10000, v34
    v_xor_b32 v35, 0x10000, v35
    v_mfma_f32_32x32x16_bf16 v[144:159], a[44:47], a[36:39], v[144:159]
    ds_read_b128 a[0:3], v26 offset:0
    ds_read_b64_tr_b16 a[8:9], v30 offset:0
    s_mov_b32 m0, s50
    s_nop 0
    buffer_load_dwordx4 v16, s[24:27], s55 offen lds
    v_mfma_f32_32x32x16_bf16 v[96:111], a[48:51], a[32:35], v[96:111]
    ds_read_b64_tr_b16 a[10:11], v30 offset:1024
    ds_read_b128 a[4:7], v26 offset:16384
    buffer_load_dwordx4 v17, s[24:27], s55 offen offset:1024 lds
    v_mfma_f32_32x32x16_bf16 v[160:175], a[48:51], a[36:39], v[160:175]
    ds_read_b64_tr_b16 a[12:13], v31 offset:0
    ds_read_b64_tr_b16 a[14:15], v31 offset:1024
    v_mfma_f32_32x32x16_bf16 v[112:127], a[52:55], a[32:35], v[112:127]
    ds_read_b64_tr_b16 a[16:17], v32 offset:0
    buffer_load_dwordx4 v18, s[24:27], s55 offen offset:2048 lds
    v_mfma_f32_32x32x16_bf16 v[176:191], a[52:55], a[36:39], v[176:191]
    ds_read_b64_tr_b16 a[18:19], v32 offset:1024
    ds_read_b64_tr_b16 a[20:21], v33 offset:0
    v_mfma_f32_32x32x16_bf16 v[192:207], a[56:59], a[32:35], v[192:207]
    ds_read_b64_tr_b16 a[22:23], v33 offset:1024
    ds_read_b64_tr_b16 a[24:25], v34 offset:0
    buffer_load_dwordx4 v19, s[24:27], s55 offen offset:3072 lds
    v_mfma_f32_32x32x16_bf16 v[208:223], a[56:59], a[36:39], v[208:223]
    ds_read_b64_tr_b16 a[26:27], v34 offset:512
    ds_read_b64_tr_b16 a[28:29], v35 offset:0
    v_mfma_f32_32x32x16_bf16 v[224:239], a[32:35], a[60:63], v[224:239]
    ds_read_b64_tr_b16 a[30:31], v35 offset:512
    s_mov_b32 m0, s51
    s_nop 0
    buffer_load_dwordx4 v24, s[28:31], s56 offen lds
    v_mfma_f32_32x32x16_bf16 v[240:255], a[36:39], a[60:63], v[240:255]
    s_cmp_eq_u32 s46, 0
    s_cbranch_scc0 K12_f1
    s_lshl_b32 s58, s44, 3
    s_add_u32 s58, s58, s45
    v_mov_b32 v2, s58
    v_mov_b32 v3, 1
    s_mov_b64 exec, 1
    global_store_byte v2, v3, s[100:101] sc1
    s_mov_b64 exec, -1
K12_f1:
    s_waitcnt lgkmcnt(0)
    v_mfma_f32_32x32x16_bf16 v[64:79], a[8:11], a[0:3], v[64:79]
    ds_read_b128 a[32:35], v27 offset:0
    ds_read_b64_tr_b16 a[40:41], v30 offset:4096
    buffer_load_dwordx4 v25, s[28:31], s56 offen offset:1024 lds
    v_mfma_f32_32x32x16_bf16 v[128:143], a[8:11], a[4:7], v[128:143]
    ds_read_b64_tr_b16 a[42:43], v30 offset:5120
    v_mfma_f32_32x32x16_bf16 v[80:95], a[12:15], a[0:3], v[80:95]
    ds_read_b128 a[36:39], v27 offset:16384
    ds_read_b64_tr_b16 a[44:45], v31 offset:4096
    s_add_u32 m0, s48, 0
    s_nop 0
    buffer_load_dwordx4 v8, s[8:11], s54 offen lds
    v_mfma_f32_32x32x16_bf16 v[144:159], a[12:15], a[4:7], v[144:159]
    ds_read_b64_tr_b16 a[46:47], v31 offset:5120
    v_mfma_f32_32x32x16_bf16 v[96:111], a[16:19], a[0:3], v[96:111]
    ds_read_b64_tr_b16 a[48:49], v32 offset:4096
    buffer_load_dwordx4 v9, s[8:11], s54 offen offset:1024 lds
    v_mfma_f32_32x32x16_bf16 v[160:175], a[16:19], a[4:7], v[160:175]
    ds_read_b64_tr_b16 a[50:51], v32 offset:5120
    ds_read_b64_tr_b16 a[52:53], v33 offset:4096
    v_mfma_f32_32x32x16_bf16 v[112:127], a[20:23], a[0:3], v[112:127]
    ds_read_b64_tr_b16 a[54:55], v33 offset:5120
    buffer_load_dwordx4 v10, s[8:11], s54 offen offset:2048 lds
    v_mfma_f32_32x32x16_bf16 v[176:191], a[20:23], a[4:7], v[176:191]
    ds_read_b64_tr_b16 a[56:57], v34 offset:2048
    ds_read_b64_tr_b16 a[58:59], v34 offset:2560
    v_mfma_f32_32x32x16_bf16 v[192:207], a[24:27], a[0:3], v[192:207]
    ds_read_b64_tr_b16 a[60:61], v35 offset:2048
    buffer_load_dwordx4 v11, s[8:11], s54 offen offset:3072 lds
    v_mfma_f32_32x32x16_bf16 v[208:223], a[24:27], a[4:7], v[208:223]
    ds_read_b64_tr_b16 a[62:63], v35 offset:2560
    v_mfma_f32_32x32x16_bf16 v[224:239], a[0:3], a[28:31], v[224:239]
    s_add_u32 m0, s48, 4096
    s_nop 0
    buffer_load_dwordx4 v12, s[8:11], s54 offen lds
    v_mfma_f32_32x32x16_bf16 v[240:255], a[4:7], a[28:31], v[240:255]
    s_waitcnt lgkmcnt(0)
    v_mfma_f32_32x32x16_bf16 v[64:79], a[40:43], a[32:35], v[64:79]
    ds_read_b128 a[0:3], v28 offset:0
    ds_read_b64_tr_b16 a[8:9], v30 offset:8192
    buffer_load_dwordx4 v13, s[8:11], s54 offen offset:1024 lds
    v_mfma_f32_32x32x16_bf16 v[128:143], a[40:43], a[36:39], v[128:143]
    ds_read_b64_tr_b16 a[10:11], v30 offset:9216
    v_mfma_f32_32x32x16_bf16 v[80:95], a[44:47], a[32:35], v[80:95]
    ds_read_b128 a[4:7], v28 offset:16384
    ds_read_b64_tr_b16 a[12:13], v31 offset:8192
    buffer_load_dwordx4 v14, s[8:11], s54 offen offset:2048 lds
    v_mfma_f32_32x32x16_bf16 v[144:159], a[44:47], a[36:39], v[144:159]
    ds_read_b64_tr_b16 a[14:15], v31 offset:9216
    v_mfma_f32_32x32x16_bf16 v[96:111], a[48:51], a[32:35], v[96:111]
    ds_read_b64_tr_b16 a[16:17], v32 offset:8192
    buffer_load_dwordx4 v15, s[8:11], s54 offen offset:3072 lds
    s_add_u32 s54, s54, 128
    s_add_u32 s55, s55, 524288
    s_add_u32 s56, s56, 196608
    s_xor_b32 s48, s48, 0x10000
    s_xor_b32 s49, s49, 0x10000
    s_xor_b32 s50, s50, 0x10000
    s_xor_b32 s51, s51, 0x10000
    v_mfma_f32_32x32x16_bf16 v[160:175], a[48:51], a[36:39], v[160:175]
    ds_read_b64_tr_b16 a[18:19], v32 offset:9216
    ds_read_b64_tr_b16 a[20:21], v33 offset:8192
    v_mfma_f32_32x32x16_bf16 v[112:127], a[52:55], a[32:35], v[112:127]
    ds_read_b64_tr_b16 a[22:23], v33 offset:9216
    v_mfma_f32_32x32x16_bf16 v[176:191], a[52:55], a[36:39], v[176:191]
    ds_read_b64_tr_b16 a[24:25], v34 offset:4096
    ds_read_b64_tr_b16 a[26:27], v34 offset:4608
    v_accvgpr_read_b32 v40, a160
    v_accvgpr_read_b32 v41, a161
    v_accvgpr_read_b32 v42, a162
    v_accvgpr_read_b32 v43, a163
    v_mfma_f32_32x32x16_bf16 v[192:207], a[56:59], a[32:35], v[192:207]
    ds_read_b64_tr_b16 a[28:29], v35 offset:4096
    v_accvgpr_read_b32 v44, a164
    v_accvgpr_read_b32 v45, a165
    v_mfma_f32_32x32x16_bf16 v[208:223], a[56:59], a[36:39], v[208:223]
    ds_read_b64_tr_b16 a[30:31], v35 offset:4608
    v_accvgpr_read_b32 v46, a166
    v_accvgpr_read_b32 v47, a167
    v_mfma_f32_32x32x16_bf16 v[224:239], a[32:35], a[60:63], v[224:239]
    v_cvt_pk_bf16_f32 v52, v40, v41
    v_cvt_pk_bf16_f32 v53, v42, v43
    v_mfma_f32_32x32x16_bf16 v[240:255], a[36:39], a[60:63], v[240:255]
    v_cvt_pk_bf16_f32 v54, v44, v45
    v_cvt_pk_bf16_f32 v55, v46, v47
    s_add_u32 s60, s80, 32768
    buffer_store_dwordx4 v[52:55], v7, s[32:35], s60 offen sc1
    s_waitcnt lgkmcnt(0)
    v_mfma_f32_32x32x16_bf16 v[64:79], a[8:11], a[0:3], v[64:79]
    ds_read_b128 a[32:35], v29 offset:0
    ds_read_b64_tr_b16 a[40:41], v30 offset:12288
    v_accvgpr_read_b32 v40, a168
    v_accvgpr_read_b32 v41, a169
    v_mfma_f32_32x32x16_bf16 v[128:143], a[8:11], a[4:7], v[128:143]
    ds_read_b64_tr_b16 a[42:43], v30 offset:13312
    v_accvgpr_read_b32 v42, a170
    v_accvgpr_read_b32 v43, a171
    v_mfma_f32_32x32x16_bf16 v[80:95], a[12:15], a[0:3], v[80:95]
    ds_read_b128 a[36:39], v29 offset:16384
    ds_read_b64_tr_b16 a[44:45], v31 offset:12288
    v_accvgpr_read_b32 v44, a172
    v_accvgpr_read_b32 v45, a173
    v_mfma_f32_32x32x16_bf16 v[144:159], a[12:15], a[4:7], v[144:159]
    ds_read_b64_tr_b16 a[46:47], v31 offset:13312
    v_accvgpr_read_b32 v46, a174
    v_accvgpr_read_b32 v47, a175
    v_cvt_pk_bf16_f32 v48, v40, v41
    v_cvt_pk_bf16_f32 v49, v42, v43
    v_mfma_f32_32x32x16_bf16 v[96:111], a[16:19], a[0:3], v[96:111]
    ds_read_b64_tr_b16 a[48:49], v32 offset:12288
    v_cvt_pk_bf16_f32 v50, v44, v45
    v_cvt_pk_bf16_f32 v51, v46, v47
    v_mfma_f32_32x32x16_bf16 v[160:175], a[16:19], a[4:7], v[160:175]
    ds_read_b64_tr_b16 a[50:51], v32 offset:13312
    ds_read_b64_tr_b16 a[52:53], v33 offset:12288
    s_add_u32 s60, s81, 32768
    buffer_store_dwordx4 v[48:51], v7, s[32:35], s60 offen sc1
    v_mfma_f32_32x32x16_bf16 v[112:127], a[20:23], a[0:3], v[112:127]
    ds_read_b64_tr_b16 a[54:55], v33 offset:13312
    v_accvgpr_read_b32 v40, a176
    v_accvgpr_read_b32 v41, a177
    v_mfma_f32_32x32x16_bf16 v[176:191], a[20:23], a[4:7], v[176:191]
    ds_read_b64_tr_b16 a[56:57], v34 offset:6144
    ds_read_b64_tr_b16 a[58:59], v34 offset:6656
    v_accvgpr_read_b32 v42, a178
    v_accvgpr_read_b32 v43, a179
    v_accvgpr_read_b32 v44, a180
    v_accvgpr_read_b32 v45, a181
    v_mfma_f32_32x32x16_bf16 v[192:207], a[24:27], a[0:3], v[192:207]
    ds_read_b64_tr_b16 a[60:61], v35 offset:6144
    v_accvgpr_read_b32 v46, a182
    v_accvgpr_read_b32 v47, a183
    v_mfma_f32_32x32x16_bf16 v[208:223], a[24:27], a[4:7], v[208:223]
    ds_read_b64_tr_b16 a[62:63], v35 offset:6656
    v_cvt_pk_bf16_f32 v52, v40, v41
    v_cvt_pk_bf16_f32 v53, v42, v43
    v_mfma_f32_32x32x16_bf16 v[224:239], a[0:3], a[28:31], v[224:239]
    v_cvt_pk_bf16_f32 v54, v44, v45
    v_cvt_pk_bf16_f32 v55, v46, v47
    v_mfma_f32_32x32x16_bf16 v[240:255], a[4:7], a[28:31], v[240:255]
    s_add_u32 s60, s82, 32768
    buffer_store_dwordx4 v[52:55], v7, s[32:35], s60 offen sc1
    s_waitcnt lgkmcnt(0)
    v_mfma_f32_32x32x16_bf16 v[64:79], a[40:43], a[32:35], v[64:79]
    v_mfma_f32_32x32x16_bf16 v[128:143], a[40:43], a[36:39], v[128:143]
    s_waitcnt vmcnt(3)
    s_barrier
    v_mfma_f32_32x32x16_bf16 v[80:95], a[44:47], a[32:35], v[80:95]
    v_xor_b32 v26, 0x10000, v26
    v_xor_b32 v27, 0x10000, v27
    v_xor_b32 v28, 0x10000, v28
    v_xor_b32 v29, 0x10000, v29
    v_xor_b32 v30, 0x10000, v30
    v_xor_b32 v31, 0x10000, v31
    v_xor_b32 v32, 0x10000, v32
    v_xor_b32 v33, 0x10000, v33
    v_xor_b32 v34, 0x10000, v34
    v_xor_b32 v35, 0x10000, v35
    v_mfma_f32_32x32x16_bf16 v[144:159], a[44:47], a[36:39], v[144:159]
    ds_read_b128 a[0:3], v26 offset:0
    ds_read_b64_tr_b16 a[8:9], v30 offset:0
    s_mov_b32 m0, s50
    s_nop 0
    buffer_load_dwordx4 v16, s[24:27], s55 offen lds
    v_mfma_f32_32x32x16_bf16 v[96:111], a[48:51], a[32:35], v[96:111]
    ds_read_b64_tr_b16 a[10:11], v30 offset:1024
    ds_read_b128 a[4:7], v26 offset:16384
    buffer_load_dwordx4 v17, s[24:27], s55 offen offset:1024 lds
    v_mfma_f32_32x32x16_bf16 v[160:175], a[48:51], a[36:39], v[160:175]
    ds_read_b64_tr_b16 a[12:13], v31 offset:0
    ds_read_b64_tr_b16 a[14:15], v31 offset:1024
    v_mfma_f32_32x32x16_bf16 v[112:127], a[52:55], a[32:35], v[112:127]
    ds_read_b64_tr_b16 a[16:17], v32 offset:0
    buffer_load_dwordx4 v18, s[24:27], s55 offen offset:2048 lds
    v_mfma_f32_32x32x16_bf16 v[176:191], a[52:55], a[36:39], v[176:191]
    ds_read_b64_tr_b16 a[18:19], v32 offset:1024
    ds_read_b64_tr_b16 a[20:21], v33 offset:0
    v_mfma_f32_32x32x16_bf16 v[192:207], a[56:59], a[32:35], v[192:207]
    ds_read_b64_tr_b16 a[22:23], v33 offset:1024
    ds_read_b64_tr_b16 a[24:25], v34 offset:0
    buffer_load_dwordx4 v19, s[24:27], s55 offen offset:3072 lds
    v_mfma_f32_32x32x16_bf16 v[208:223], a[56:59], a[36:39], v[208:223]
    ds_read_b64_tr_b16 a[26:27], v34 offset:512
    ds_read_b64_tr_b16 a[28:29], v35 offset:0
    v_mfma_f32_32x32x16_bf16 v[224:239], a[32:35], a[60:63], v[224:239]
    ds_read_b64_tr_b16 a[30:31], v35 offset:512
    s_mov_b32 m0, s51
    s_nop 0
    buffer_load_dwordx4 v24, s[28:31], s56 offen lds
    v_mfma_f32_32x32x16_bf16 v[240:255], a[36:39], a[60:63], v[240:255]
    s_waitcnt lgkmcnt(0)
    v_mfma_f32_32x32x16_bf16 v[64:79], a[8:11], a[0:3], v[64:79]
    ds_read_b128 a[32:35], v27 offset:0
    ds_read_b64_tr_b16 a[40:41], v30 offset:4096
    buffer_load_dwordx4 v25, s[28:31], s56 offen offset:1024 lds
    v_mfma_f32_32x32x16_bf16 v[128:143], a[8:11], a[4:7], v[128:143]
    ds_read_b64_tr_b16 a[42:43], v30 offset:5120
    v_mfma_f32_32x32x16_bf16 v[80:95], a[12:15], a[0:3], v[80:95]
    ds_read_b128 a[36:39], v27 offset:16384
    ds_read_b64_tr_b16 a[44:45], v31 offset:4096
    s_add_u32 m0, s48, 0
    s_nop 0
    buffer_load_dwordx4 v8, s[8:11], s54 offen lds
    v_mfma_f32_32x32x16_bf16 v[144:159], a[12:15], a[4:7], v[144:159]
    ds_read_b64_tr_b16 a[46:47], v31 offset:5120
    v_mfma_f32_32x32x16_bf16 v[96:111], a[16:19], a[0:3], v[96:111]
    ds_read_b64_tr_b16 a[48:49], v32 offset:4096
    buffer_load_dwordx4 v9, s[8:11], s54 offen offset:1024 lds
    v_mfma_f32_32x32x16_bf16 v[160:175], a[16:19], a[4:7], v[160:175]
    ds_read_b64_tr_b16 a[50:51], v32 offset:5120
    ds_read_b64_tr_b16 a[52:53], v33 offset:4096
    v_mfma_f32_32x32x16_bf16 v[112:127], a[20:23], a[0:3], v[112:127]
    ds_read_b64_tr_b16 a[54:55], v33 offset:5120
    buffer_load_dwordx4 v10, s[8:11], s54 offen offset:2048 lds
    v_mfma_f32_32x32x16_bf16 v[176:191], a[20:23], a[4:7], v[176:191]
    ds_read_b64_tr_b16 a[56:57], v34 offset:2048
    ds_read_b64_tr_b16 a[58:59], v34 offset:2560
    v_mfma_f32_32x32x16_bf16 v[192:207], a[24:27], a[0:3], v[192:207]
    ds_read_b64_tr_b16 a[60:61], v35 offset:2048
    buffer_load_dwordx4 v11, s[8:11], s54 offen offset:3072 lds
    v_mfma_f32_32x32x16_bf16 v[208:223], a[24:27], a[4:7], v[208:223]
    ds_read_b64_tr_b16 a[62:63], v35 offset:2560
    v_mfma_f32_32x32x16_bf16 v[224:239], a[0:3], a[28:31], v[224:239]
    s_add_u32 m0, s48, 4096
    s_nop 0
    buffer_load_dwordx4 v12, s[8:11], s54 offen lds
    v_mfma_f32_32x32x16_bf16 v[240:255], a[4:7], a[28:31], v[240:255]
    s_waitcnt lgkmcnt(0)
    v_mfma_f32_32x32x16_bf16 v[64:79], a[40:43], a[32:35], v[64:79]
    ds_read_b128 a[0:3], v28 offset:0
    ds_read_b64_tr_b16 a[8:9], v30 offset:8192
    buffer_load_dwordx4 v13, s[8:11], s54 offen offset:1024 lds
    v_mfma_f32_32x32x16_bf16 v[128:143], a[40:43], a[36:39], v[128:143]
    ds_read_b64_tr_b16 a[10:11], v30 offset:9216
    v_mfma_f32_32x32x16_bf16 v[80:95], a[44:47], a[32:35], v[80:95]
    ds_read_b128 a[4:7], v28 offset:16384
    ds_read_b64_tr_b16 a[12:13], v31 offset:8192
    buffer_load_dwordx4 v14, s[8:11], s54 offen offset:2048 lds
    v_mfma_f32_32x32x16_bf16 v[144:159], a[44:47], a[36:39], v[144:159]
    ds_read_b64_tr_b16 a[14:15], v31 offset:9216
    v_mfma_f32_32x32x16_bf16 v[96:111], a[48:51], a[32:35], v[96:111]
    ds_read_b64_tr_b16 a[16:17], v32 offset:8192
    buffer_load_dwordx4 v15, s[8:11], s54 offen offset:3072 lds
    s_add_u32 s54, s54, 128
    s_add_u32 s55, s55, 524288
    s_add_u32 s56, s56, 196608
    s_xor_b32 s48, s48, 0x10000
    s_xor_b32 s49, s49, 0x10000
    s_xor_b32 s50, s50, 0x10000
    s_xor_b32 s51, s51, 0x10000
    v_mfma_f32_32x32x16_bf16 v[160:175], a[48:51], a[36:39], v[160:175]
    ds_read_b64_tr_b16 a[18:19], v32 offset:9216
    ds_read_b64_tr_b16 a[20:21], v33 offset:8192
    v_mfma_f32_32x32x16_bf16 v[112:127], a[52:55], a[32:35], v[112:127]
    ds_read_b64_tr_b16 a[22:23], v33 offset:9216
    v_mfma_f32_32x32x16_bf16 v[176:191], a[52:55], a[36:39], v[176:191]
    ds_read_b64_tr_b16 a[24:25], v34 offset:4096
    ds_read_b64_tr_b16 a[26:27], v34 offset:4608
    v_accvgpr_read_b32 v40, a184
    v_accvgpr_read_b32 v41, a185
    v_accvgpr_read_b32 v42, a186
    v_accvgpr_read_b32 v43, a187
    v_mfma_f32_32x32x16_bf16 v[192:207], a[56:59], a[32:35], v[192:207]
    ds_read_b64_tr_b16 a[28:29], v35 offset:4096
    v_accvgpr_read_b32 v44, a188
    v_accvgpr_read_b32 v45, a189
    v_mfma_f32_32x32x16_bf16 v[208:223], a[56:59], a[36:39], v[208:223]
    ds_read_b64_tr_b16 a[30:31], v35 offset:4608
    v_accvgpr_read_b32 v46, a190
    v_accvgpr_read_b32 v47, a191
    v_mfma_f32_32x32x16_bf16 v[224:239], a[32:35], a[60:63], v[224:239]
    v_cvt_pk_bf16_f32 v48, v40, v41
    v_cvt_pk_bf16_f32 v49, v42, v43
    v_mfma_f32_32x32x16_bf16 v[240:255], a[36:39], a[60:63], v[240:255]
    v_cvt_pk_bf16_f32 v50, v44, v45
    v_cvt_pk_bf16_f32 v51, v46, v47
    s_add_u32 s60, s83, 32768
    buffer_store_dwordx4 v[48:51], v7, s[32:35], s60 offen sc1
    s_waitcnt lgkmcnt(0)
    v_mfma_f32_32x32x16_bf16 v[64:79], a[8:11], a[0:3], v[64:79]
    ds_read_b128 a[32:35], v29 offset:0
    ds_read_b64_tr_b16 a[40:41], v30 offset:12288
    v_accvgpr_read_b32 v40, a192
    v_accvgpr_read_b32 v41, a193
    v_mfma_f32_32x32x16_bf16 v[128:143], a[8:11], a[4:7], v[128:143]
    ds_read_b64_tr_b16 a[42:43], v30 offset:13312
    v_accvgpr_read_b32 v42, a194
    v_accvgpr_read_b32 v43, a195
    v_mfma_f32_32x32x16_bf16 v[80:95], a[12:15], a[0:3], v[80:95]
    ds_read_b128 a[36:39], v29 offset:16384
    ds_read_b64_tr_b16 a[44:45], v31 offset:12288
    v_accvgpr_read_b32 v44, a196
    v_accvgpr_read_b32 v45, a197
    v_mfma_f32_32x32x16_bf16 v[144:159], a[12:15], a[4:7], v[144:159]
    ds_read_b64_tr_b16 a[46:47], v31 offset:13312
    v_accvgpr_read_b32 v46, a198
    v_accvgpr_read_b32 v47, a199
    v_cvt_pk_bf16_f32 v52, v40, v41
    v_cvt_pk_bf16_f32 v53, v42, v43
    v_mfma_f32_32x32x16_bf16 v[96:111], a[16:19], a[0:3], v[96:111]
    ds_read_b64_tr_b16 a[48:49], v32 offset:12288
    v_cvt_pk_bf16_f32 v54, v44, v45
    v_cvt_pk_bf16_f32 v55, v46, v47
    v_mfma_f32_32x32x16_bf16 v[160:175], a[16:19], a[4:7], v[160:175]
    ds_read_b64_tr_b16 a[50:51], v32 offset:13312
    ds_read_b64_tr_b16 a[52:53], v33 offset:12288
    s_add_u32 s60, s76, 40960
    buffer_store_dwordx4 v[52:55], v7, s[32:35], s60 offen sc1
    v_mfma_f32_32x32x16_bf16 v[112:127], a[20:23], a[0:3], v[112:127]
    ds_read_b64_tr_b16 a[54:55], v33 offset:13312
    v_accvgpr_read_b32 v40, a200
    v_accvgpr_read_b32 v41, a201
    v_mfma_f32_32x32x16_bf16 v[176:191], a[20:23], a[4:7], v[176:191]
    ds_read_b64_tr_b16 a[56:57], v34 offset:6144
    ds_read_b64_tr_b16 a[58:59], v34 offset:6656
    v_accvgpr_read_b32 v42, a202
    v_accvgpr_read_b32 v43, a203
    v_accvgpr_read_b32 v44, a204
    v_accvgpr_read_b32 v45, a205
    v_mfma_f32_32x32x16_bf16 v[192:207], a[24:27], a[0:3], v[192:207]
    ds_read_b64_tr_b16 a[60:61], v35 offset:6144
    v_accvgpr_read_b32 v46, a206
    v_accvgpr_read_b32 v47, a207
    v_mfma_f32_32x32x16_bf16 v[208:223], a[24:27], a[4:7], v[208:223]
    ds_read_b64_tr_b16 a[62:63], v35 offset:6656
    v_cvt_pk_bf16_f32 v48, v40, v41
    v_cvt_pk_bf16_f32 v49, v42, v43
    v_mfma_f32_32x32x16_bf16 v[224:239], a[0:3], a[28:31], v[224:239]
    v_cvt_pk_bf16_f32 v50, v44, v45
    v_cvt_pk_bf16_f32 v51, v46, v47
    v_mfma_f32_32x32x16_bf16 v[240:255], a[4:7], a[28:31], v[240:255]
    s_add_u32 s60, s77, 40960
    buffer_store_dwordx4 v[48:51], v7, s[32:35], s60 offen sc1
    s_waitcnt lgkmcnt(0)
    v_mfma_f32_32x32x16_bf16 v[64:79], a[40:43], a[32:35], v[64:79]
    v_mfma_f32_32x32x16_bf16 v[128:143], a[40:43], a[36:39], v[128:143]
    s_waitcnt vmcnt(3)
    s_barrier
    v_mfma_f32_32x32x16_bf16 v[80:95], a[44:47], a[32:35], v[80:95]
    v_xor_b32 v26, 0x10000, v26
    v_xor_b32 v27, 0x10000, v27
    v_xor_b32 v28, 0x10000, v28
    v_xor_b32 v29, 0x10000, v29
    v_xor_b32 v30, 0x10000, v30
    v_xor_b32 v31, 0x10000, v31
    v_xor_b32 v32, 0x10000, v32
    v_xor_b32 v33, 0x10000, v33
    v_xor_b32 v34, 0x10000, v34
    v_xor_b32 v35, 0x10000, v35
    v_mfma_f32_32x32x16_bf16 v[144:159], a[44:47], a[36:39], v[144:159]
    ds_read_b128 a[0:3], v26 offset:0
    ds_read_b64_tr_b16 a[8:9], v30 offset:0
    s_mov_b32 m0, s50
    s_nop 0
    buffer_load_dwordx4 v16, s[24:27], s55 offen lds
    v_mfma_f32_32x32x16_bf16 v[96:111], a[48:51], a[32:35], v[96:111]
    ds_read_b64_tr_b16 a[10:11], v30 offset:1024
    ds_read_b128 a[4:7], v26 offset:16384
    buffer_load_dwordx4 v17, s[24:27], s55 offen offset:1024 lds
    v_mfma_f32_32x32x16_bf16 v[160:175], a[48:51], a[36:39], v[160:175]
    ds_read_b64_tr_b16 a[12:13], v31 offset:0
    ds_read_b64_tr_b16 a[14:15], v31 offset:1024
    v_mfma_f32_32x32x16_bf16 v[112:127], a[52:55], a[32:35], v[112:127]
    ds_read_b64_tr_b16 a[16:17], v32 offset:0
    buffer_load_dwordx4 v18, s[24:27], s55 offen offset:2048 lds
    v_mfma_f32_32x32x16_bf16 v[176:191], a[52:55], a[36:39], v[176:191]
    ds_read_b64_tr_b16 a[18:19], v32 offset:1024
    ds_read_b64_tr_b16 a[20:21], v33 offset:0
    v_mfma_f32_32x32x16_bf16 v[192:207], a[56:59], a[32:35], v[192:207]
    ds_read_b64_tr_b16 a[22:23], v33 offset:1024
    ds_read_b64_tr_b16 a[24:25], v34 offset:0
    buffer_load_dwordx4 v19, s[24:27], s55 offen offset:3072 lds
    v_mfma_f32_32x32x16_bf16 v[208:223], a[56:59], a[36:39], v[208:223]
    ds_read_b64_tr_b16 a[26:27], v34 offset:512
    ds_read_b64_tr_b16 a[28:29], v35 offset:0
    v_mfma_f32_32x32x16_bf16 v[224:239], a[32:35], a[60:63], v[224:239]
    ds_read_b64_tr_b16 a[30:31], v35 offset:512
    s_mov_b32 m0, s51
    s_nop 0
    buffer_load_dwordx4 v24, s[28:31], s56 offen lds
    v_mfma_f32_32x32x16_bf16 v[240:255], a[36:39], a[60:63], v[240:255]
    s_waitcnt lgkmcnt(0)
    v_mfma_f32_32x32x16_bf16 v[64:79], a[8:11], a[0:3], v[64:79]
    ds_read_b128 a[32:35], v27 offset:0
    ds_read_b64_tr_b16 a[40:41], v30 offset:4096
    buffer_load_dwordx4 v25, s[28:31], s56 offen offset:1024 lds
    v_mfma_f32_32x32x16_bf16 v[128:143], a[8:11], a[4:7], v[128:143]
    ds_read_b64_tr_b16 a[42:43], v30 offset:5120
    v_mfma_f32_32x32x16_bf16 v[80:95], a[12:15], a[0:3], v[80:95]
    ds_read_b128 a[36:39], v27 offset:16384
    ds_read_b64_tr_b16 a[44:45], v31 offset:4096
    s_add_u32 m0, s48, 0
    s_nop 0
    buffer_load_dwordx4 v8, s[8:11], s54 offen lds
    v_mfma_f32_32x32x16_bf16 v[144:159], a[12:15], a[4:7], v[144:159]
    ds_read_b64_tr_b16 a[46:47], v31 offset:5120
    v_mfma_f32_32x32x16_bf16 v[96:111], a[16:19], a[0:3], v[96:111]
    ds_read_b64_tr_b16 a[48:49], v32 offset:4096
    buffer_load_dwordx4 v9, s[8:11], s54 offen offset:1024 lds
    v_mfma_f32_32x32x16_bf16 v[160:175], a[16:19], a[4:7], v[160:175]
    ds_read_b64_tr_b16 a[50:51], v32 offset:5120
    ds_read_b64_tr_b16 a[52:53], v33 offset:4096
    v_mfma_f32_32x32x16_bf16 v[112:127], a[20:23], a[0:3], v[112:127]
    ds_read_b64_tr_b16 a[54:55], v33 offset:5120
    buffer_load_dwordx4 v10, s[8:11], s54 offen offset:2048 lds
    v_mfma_f32_32x32x16_bf16 v[176:191], a[20:23], a[4:7], v[176:191]
    ds_read_b64_tr_b16 a[56:57], v34 offset:2048
    ds_read_b64_tr_b16 a[58:59], v34 offset:2560
    v_mfma_f32_32x32x16_bf16 v[192:207], a[24:27], a[0:3], v[192:207]
    ds_read_b64_tr_b16 a[60:61], v35 offset:2048
    buffer_load_dwordx4 v11, s[8:11], s54 offen offset:3072 lds
    v_mfma_f32_32x32x16_bf16 v[208:223], a[24:27], a[4:7], v[208:223]
    ds_read_b64_tr_b16 a[62:63], v35 offset:2560
    v_mfma_f32_32x32x16_bf16 v[224:239], a[0:3], a[28:31], v[224:239]
    s_add_u32 m0, s48, 4096
    s_nop 0
    buffer_load_dwordx4 v12, s[8:11], s54 offen lds
    v_mfma_f32_32x32x16_bf16 v[240:255], a[4:7], a[28:31], v[240:255]
    s_waitcnt lgkmcnt(0)
    v_mfma_f32_32x32x16_bf16 v[64:79], a[40:43], a[32:35], v[64:79]
    ds_read_b128 a[0:3], v28 offset:0
    ds_read_b64_tr_b16 a[8:9], v30 offset:8192
    buffer_load_dwordx4 v13, s[8:11], s54 offen offset:1024 lds
    v_mfma_f32_32x32x16_bf16 v[128:143], a[40:43], a[36:39], v[128:143]
    ds_read_b64_tr_b16 a[10:11], v30 offset:9216
    v_mfma_f32_32x32x16_bf16 v[80:95], a[44:47], a[32:35], v[80:95]
    ds_read_b128 a[4:7], v28 offset:16384
    ds_read_b64_tr_b16 a[12:13], v31 offset:8192
    buffer_load_dwordx4 v14, s[8:11], s54 offen offset:2048 lds
    v_mfma_f32_32x32x16_bf16 v[144:159], a[44:47], a[36:39], v[144:159]
    ds_read_b64_tr_b16 a[14:15], v31 offset:9216
    v_mfma_f32_32x32x16_bf16 v[96:111], a[48:51], a[32:35], v[96:111]
    ds_read_b64_tr_b16 a[16:17], v32 offset:8192
    buffer_load_dwordx4 v15, s[8:11], s54 offen offset:3072 lds
    s_add_u32 s54, s54, 128
    s_add_u32 s55, s55, 524288
    s_add_u32 s56, s56, 196608
    s_xor_b32 s48, s48, 0x10000
    s_xor_b32 s49, s49, 0x10000
    s_xor_b32 s50, s50, 0x10000
    s_xor_b32 s51, s51, 0x10000
    v_mfma_f32_32x32x16_bf16 v[160:175], a[48:51], a[36:39], v[160:175]
    ds_read_b64_tr_b16 a[18:19], v32 offset:9216
    ds_read_b64_tr_b16 a[20:21], v33 offset:8192
    v_mfma_f32_32x32x16_bf16 v[112:127], a[52:55], a[32:35], v[112:127]
    ds_read_b64_tr_b16 a[22:23], v33 offset:9216
    v_mfma_f32_32x32x16_bf16 v[176:191], a[52:55], a[36:39], v[176:191]
    ds_read_b64_tr_b16 a[24:25], v34 offset:4096
    ds_read_b64_tr_b16 a[26:27], v34 offset:4608
    v_accvgpr_read_b32 v40, a208
    v_accvgpr_read_b32 v41, a209
    v_accvgpr_read_b32 v42, a210
    v_accvgpr_read_b32 v43, a211
    v_mfma_f32_32x32x16_bf16 v[192:207], a[56:59], a[32:35], v[192:207]
    ds_read_b64_tr_b16 a[28:29], v35 offset:4096
    v_accvgpr_read_b32 v44, a212
    v_accvgpr_read_b32 v45, a213
    v_mfma_f32_32x32x16_bf16 v[208:223], a[56:59], a[36:39], v[208:223]
    ds_read_b64_tr_b16 a[30:31], v35 offset:4608
    v_accvgpr_read_b32 v46, a214
    v_accvgpr_read_b32 v47, a215
    v_mfma_f32_32x32x16_bf16 v[224:239], a[32:35], a[60:63], v[224:239]
    v_cvt_pk_bf16_f32 v52, v40, v41
    v_cvt_pk_bf16_f32 v53, v42, v43
    v_mfma_f32_32x32x16_bf16 v[240:255], a[36:39], a[60:63], v[240:255]
    v_cvt_pk_bf16_f32 v54, v44, v45
    v_cvt_pk_bf16_f32 v55, v46, v47
    s_add_u32 s60, s78, 40960
    buffer_store_dwordx4 v[52:55], v7, s[32:35], s60 offen sc1
    s_waitcnt lgkmcnt(0)
    v_mfma_f32_32x32x16_bf16 v[64:79], a[8:11], a[0:3], v[64:79]
    ds_read_b128 a[32:35], v29 offset:0
    ds_read_b64_tr_b16 a[40:41], v30 offset:12288
    v_accvgpr_read_b32 v40, a216
    v_accvgpr_read_b32 v41, a217
    v_mfma_f32_32x32x16_bf16 v[128:143], a[8:11], a[4:7], v[128:143]
    ds_read_b64_tr_b16 a[42:43], v30 offset:13312
    v_accvgpr_read_b32 v42, a218
    v_accvgpr_read_b32 v43, a219
    v_mfma_f32_32x32x16_bf16 v[80:95], a[12:15], a[0:3], v[80:95]
    ds_read_b128 a[36:39], v29 offset:16384
    ds_read_b64_tr_b16 a[44:45], v31 offset:12288
    v_accvgpr_read_b32 v44, a220
    v_accvgpr_read_b32 v45, a221
    v_mfma_f32_32x32x16_bf16 v[144:159], a[12:15], a[4:7], v[144:159]
    ds_read_b64_tr_b16 a[46:47], v31 offset:13312
    v_accvgpr_read_b32 v46, a222
    v_accvgpr_read_b32 v47, a223
    v_cvt_pk_bf16_f32 v48, v40, v41
    v_cvt_pk_bf16_f32 v49, v42, v43
    v_mfma_f32_32x32x16_bf16 v[96:111], a[16:19], a[0:3], v[96:111]
    ds_read_b64_tr_b16 a[48:49], v32 offset:12288
    v_cvt_pk_bf16_f32 v50, v44, v45
    v_cvt_pk_bf16_f32 v51, v46, v47
    v_mfma_f32_32x32x16_bf16 v[160:175], a[16:19], a[4:7], v[160:175]
    ds_read_b64_tr_b16 a[50:51], v32 offset:13312
    ds_read_b64_tr_b16 a[52:53], v33 offset:12288
    s_add_u32 s60, s79, 40960
    buffer_store_dwordx4 v[48:51], v7, s[32:35], s60 offen sc1
    v_mfma_f32_32x32x16_bf16 v[112:127], a[20:23], a[0:3], v[112:127]
    ds_read_b64_tr_b16 a[54:55], v33 offset:13312
    v_accvgpr_read_b32 v40, a224
    v_accvgpr_read_b32 v41, a225
    v_mfma_f32_32x32x16_bf16 v[176:191], a[20:23], a[4:7], v[176:191]
    ds_read_b64_tr_b16 a[56:57], v34 offset:6144
    ds_read_b64_tr_b16 a[58:59], v34 offset:6656
    v_accvgpr_read_b32 v42, a226
    v_accvgpr_read_b32 v43, a227
    v_accvgpr_read_b32 v44, a228
    v_accvgpr_read_b32 v45, a229
    v_mfma_f32_32x32x16_bf16 v[192:207], a[24:27], a[0:3], v[192:207]
    ds_read_b64_tr_b16 a[60:61], v35 offset:6144
    v_accvgpr_read_b32 v46, a230
    v_accvgpr_read_b32 v47, a231
    v_mfma_f32_32x32x16_bf16 v[208:223], a[24:27], a[4:7], v[208:223]
    ds_read_b64_tr_b16 a[62:63], v35 offset:6656
    v_cvt_pk_bf16_f32 v52, v40, v41
    v_cvt_pk_bf16_f32 v53, v42, v43
    v_mfma_f32_32x32x16_bf16 v[224:239], a[0:3], a[28:31], v[224:239]
    v_cvt_pk_bf16_f32 v54, v44, v45
    v_cvt_pk_bf16_f32 v55, v46, v47
    v_mfma_f32_32x32x16_bf16 v[240:255], a[4:7], a[28:31], v[240:255]
    s_add_u32 s60, s80, 40960
    buffer_store_dwordx4 v[52:55], v7, s[32:35], s60 offen sc1
    s_waitcnt lgkmcnt(0)
    v_mfma_f32_32x32x16_bf16 v[64:79], a[40:43], a[32:35], v[64:79]
    v_mfma_f32_32x32x16_bf16 v[128:143], a[40:43], a[36:39], v[128:143]
    s_waitcnt vmcnt(3)
    s_barrier
    v_mfma_f32_32x32x16_bf16 v[80:95], a[44:47], a[32:35], v[80:95]
    v_xor_b32 v26, 0x10000, v26
    v_xor_b32 v27, 0x10000, v27
    v_xor_b32 v28, 0x10000, v28
    v_xor_b32 v29, 0x10000, v29
    v_xor_b32 v30, 0x10000, v30
    v_xor_b32 v31, 0x10000, v31
    v_xor_b32 v32, 0x10000, v32
    v_xor_b32 v33, 0x10000, v33
    v_xor_b32 v34, 0x10000, v34
    v_xor_b32 v35, 0x10000, v35
    v_mfma_f32_32x32x16_bf16 v[144:159], a[44:47], a[36:39], v[144:159]
    ds_read_b128 a[0:3], v26 offset:0
    ds_read_b64_tr_b16 a[8:9], v30 offset:0
    v_mfma_f32_32x32x16_bf16 v[96:111], a[48:51], a[32:35], v[96:111]
    ds_read_b64_tr_b16 a[10:11], v30 offset:1024
    ds_read_b128 a[4:7], v26 offset:16384
    v_mfma_f32_32x32x16_bf16 v[160:175], a[48:51], a[36:39], v[160:175]
    ds_read_b64_tr_b16 a[12:13], v31 offset:0
    ds_read_b64_tr_b16 a[14:15], v31 offset:1024
    v_mfma_f32_32x32x16_bf16 v[112:127], a[52:55], a[32:35], v[112:127]
    ds_read_b64_tr_b16 a[16:17], v32 offset:0
    v_mfma_f32_32x32x16_bf16 v[176:191], a[52:55], a[36:39], v[176:191]
    ds_read_b64_tr_b16 a[18:19], v32 offset:1024
    ds_read_b64_tr_b16 a[20:21], v33 offset:0
    v_mfma_f32_32x32x16_bf16 v[192:207], a[56:59], a[32:35], v[192:207]
    ds_read_b64_tr_b16 a[22:23], v33 offset:1024
    ds_read_b64_tr_b16 a[24:25], v34 offset:0
    v_mfma_f32_32x32x16_bf16 v[208:223], a[56:59], a[36:39], v[208:223]
    ds_read_b64_tr_b16 a[26:27], v34 offset:512
    ds_read_b64_tr_b16 a[28:29], v35 offset:0
    v_mfma_f32_32x32x16_bf16 v[224:239], a[32:35], a[60:63], v[224:239]
    ds_read_b64_tr_b16 a[30:31], v35 offset:512
    v_mfma_f32_32x32x16_bf16 v[240:255], a[36:39], a[60:63], v[240:255]
    s_waitcnt lgkmcnt(0)
    v_mfma_f32_32x32x16_bf16 v[64:79], a[8:11], a[0:3], v[64:79]
    ds_read_b128 a[32:35], v27 offset:0
    ds_read_b64_tr_b16 a[40:41], v30 offset:4096
    v_mfma_f32_32x32x16_bf16 v[128:143], a[8:11], a[4:7], v[128:143]
    ds_read_b64_tr_b16 a[42:43], v30 offset:5120
    v_mfma_f32_32x32x16_bf16 v[80:95], a[12:15], a[0:3], v[80:95]
    ds_read_b128 a[36:39], v27 offset:16384
    ds_read_b64_tr_b16 a[44:45], v31 offset:4096
    v_mfma_f32_32x32x16_bf16 v[144:159], a[12:15], a[4:7], v[144:159]
    ds_read_b64_tr_b16 a[46:47], v31 offset:5120
    v_mfma_f32_32x32x16_bf16 v[96:111], a[16:19], a[0:3], v[96:111]
    ds_read_b64_tr_b16 a[48:49], v32 offset:4096
    v_mfma_f32_32x32x16_bf16 v[160:175], a[16:19], a[4:7], v[160:175]
    ds_read_b64_tr_b16 a[50:51], v32 offset:5120
    ds_read_b64_tr_b16 a[52:53], v33 offset:4096
    v_mfma_f32_32x32x16_bf16 v[112:127], a[20:23], a[0:3], v[112:127]
    ds_read_b64_tr_b16 a[54:55], v33 offset:5120
    v_mfma_f32_32x32x16_bf16 v[176:191], a[20:23], a[4:7], v[176:191]
    ds_read_b64_tr_b16 a[56:57], v34 offset:2048
    ds_read_b64_tr_b16 a[58:59], v34 offset:2560
    v_mfma_f32_32x32x16_bf16 v[192:207], a[24:27], a[0:3], v[192:207]
    ds_read_b64_tr_b16 a[60:61], v35 offset:2048
    v_mfma_f32_32x32x16_bf16 v[208:223], a[24:27], a[4:7], v[208:223]
    ds_read_b64_tr_b16 a[62:63], v35 offset:2560
    v_mfma_f32_32x32x16_bf16 v[224:239], a[0:3], a[28:31], v[224:239]
    v_mfma_f32_32x32x16_bf16 v[240:255], a[4:7], a[28:31], v[240:255]
    s_waitcnt lgkmcnt(0)
    v_mfma_f32_32x32x16_bf16 v[64:79], a[40:43], a[32:35], v[64:79]
    ds_read_b128 a[0:3], v28 offset:0
    ds_read_b64_tr_b16 a[8:9], v30 offset:8192
    v_accvgpr_read_b32 v40, a232
    v_accvgpr_read_b32 v41, a233
    v_mfma_f32_32x32x16_bf16 v[128:143], a[40:43], a[36:39], v[128:143]
    ds_read_b64_tr_b16 a[10:11], v30 offset:9216
    v_accvgpr_read_b32 v42, a234
    v_accvgpr_read_b32 v43, a235
    v_mfma_f32_32x32x16_bf16 v[80:95], a[44:47], a[32:35], v[80:95]
    ds_read_b128 a[4:7], v28 offset:16384
    ds_read_b64_tr_b16 a[12:13], v31 offset:8192
    v_accvgpr_read_b32 v44, a236
    v_accvgpr_read_b32 v45, a237
    v_mfma_f32_32x32x16_bf16 v[144:159], a[44:47], a[36:39], v[144:159]
    ds_read_b64_tr_b16 a[14:15], v31 offset:9216
    v_accvgpr_read_b32 v46, a238
    v_accvgpr_read_b32 v47, a239
    v_mfma_f32_32x32x16_bf16 v[96:111], a[48:51], a[32:35], v[96:111]
    ds_read_b64_tr_b16 a[16:17], v32 offset:8192
    v_cvt_pk_bf16_f32 v48, v40, v41
    v_cvt_pk_bf16_f32 v49, v42, v43
    v_mfma_f32_32x32x16_bf16 v[160:175], a[48:51], a[36:39], v[160:175]
    ds_read_b64_tr_b16 a[18:19], v32 offset:9216
    ds_read_b64_tr_b16 a[20:21], v33 offset:8192
    v_cvt_pk_bf16_f32 v50, v44, v45
    v_cvt_pk_bf16_f32 v51, v46, v47
    v_mfma_f32_32x32x16_bf16 v[112:127], a[52:55], a[32:35], v[112:127]
    ds_read_b64_tr_b16 a[22:23], v33 offset:9216
    s_add_u32 s60, s81, 40960
    buffer_store_dwordx4 v[48:51], v7, s[32:35], s60 offen sc1
    v_mfma_f32_32x32x16_bf16 v[176:191], a[52:55], a[36:39], v[176:191]
    ds_read_b64_tr_b16 a[24:25], v34 offset:4096
    ds_read_b64_tr_b16 a[26:27], v34 offset:4608
    v_mfma_f32_32x32x16_bf16 v[192:207], a[56:59], a[32:35], v[192:207]
    ds_read_b64_tr_b16 a[28:29], v35 offset:4096
    v_accvgpr_read_b32 v40, a240
    v_accvgpr_read_b32 v41, a241
    v_mfma_f32_32x32x16_bf16 v[208:223], a[56:59], a[36:39], v[208:223]
    ds_read_b64_tr_b16 a[30:31], v35 offset:4608
    v_accvgpr_read_b32 v42, a242
    v_accvgpr_read_b32 v43, a243
    v_mfma_f32_32x32x16_bf16 v[224:239], a[32:35], a[60:63], v[224:239]
    v_accvgpr_read_b32 v44, a244
    v_accvgpr_read_b32 v45, a245
    v_mfma_f32_32x32x16_bf16 v[240:255], a[36:39], a[60:63], v[240:255]
    v_accvgpr_read_b32 v46, a246
    v_accvgpr_read_b32 v47, a247
    s_waitcnt lgkmcnt(0)
    v_mfma_f32_32x32x16_bf16 v[64:79], a[8:11], a[0:3], v[64:79]
    ds_read_b128 a[32:35], v29 offset:0
    ds_read_b64_tr_b16 a[40:41], v30 offset:12288
    v_cvt_pk_bf16_f32 v52, v40, v41
    v_cvt_pk_bf16_f32 v53, v42, v43
    v_mfma_f32_32x32x16_bf16 v[128:143], a[8:11], a[4:7], v[128:143]
    ds_read_b64_tr_b16 a[42:43], v30 offset:13312
    v_cvt_pk_bf16_f32 v54, v44, v45
    v_cvt_pk_bf16_f32 v55, v46, v47
    v_mfma_f32_32x32x16_bf16 v[80:95], a[12:15], a[0:3], v[80:95]
    ds_read_b128 a[36:39], v29 offset:16384
    ds_read_b64_tr_b16 a[44:45], v31 offset:12288
    s_add_u32 s60, s82, 40960
    buffer_store_dwordx4 v[52:55], v7, s[32:35], s60 offen sc1
    v_mfma_f32_32x32x16_bf16 v[144:159], a[12:15], a[4:7], v[144:159]
    ds_read_b64_tr_b16 a[46:47], v31 offset:13312
    v_mfma_f32_32x32x16_bf16 v[96:111], a[16:19], a[0:3], v[96:111]
    ds_read_b64_tr_b16 a[48:49], v32 offset:12288
    v_accvgpr_read_b32 v40, a248
    v_accvgpr_read_b32 v41, a249
    v_mfma_f32_32x32x16_bf16 v[160:175], a[16:19], a[4:7], v[160:175]
    ds_read_b64_tr_b16 a[50:51], v32 offset:13312
    ds_read_b64_tr_b16 a[52:53], v33 offset:12288
    v_accvgpr_read_b32 v42, a250
    v_accvgpr_read_b32 v43, a251
    v_mfma_f32_32x32x16_bf16 v[112:127], a[20:23], a[0:3], v[112:127]
    ds_read_b64_tr_b16 a[54:55], v33 offset:13312
    v_accvgpr_read_b32 v44, a252
    v_accvgpr_read_b32 v45, a253
    v_mfma_f32_32x32x16_bf16 v[176:191], a[20:23], a[4:7], v[176:191]
    ds_read_b64_tr_b16 a[56:57], v34 offset:6144
    ds_read_b64_tr_b16 a[58:59], v34 offset:6656
    v_accvgpr_read_b32 v46, a254
    v_accvgpr_read_b32 v47, a255
    v_mfma_f32_32x32x16_bf16 v[192:207], a[24:27], a[0:3], v[192:207]
    ds_read_b64_tr_b16 a[60:61], v35 offset:6144
    v_cvt_pk_bf16_f32 v48, v40, v41
    v_cvt_pk_bf16_f32 v49, v42, v43
    v_mfma_f32_32x32x16_bf16 v[208:223], a[24:27], a[4:7], v[208:223]
    ds_read_b64_tr_b16 a[62:63], v35 offset:6656
    v_cvt_pk_bf16_f32 v50, v44, v45
    v_cvt_pk_bf16_f32 v51, v46, v47
    v_mfma_f32_32x32x16_bf16 v[224:239], a[0:3], a[28:31], v[224:239]
    s_add_u32 s60, s83, 40960
    buffer_store_dwordx4 v[48:51], v7, s[32:35], s60 offen sc1
    v_mfma_f32_32x32x16_bf16 v[240:255], a[4:7], a[28:31], v[240:255]
    s_waitcnt lgkmcnt(0)
    v_mfma_f32_32x32x16_bf16 v[64:79], a[40:43], a[32:35], v[64:79]
    v_mfma_f32_32x32x16_bf16 v[128:143], a[40:43], a[36:39], v[128:143]
    s_waitcnt vmcnt(63)
    s_barrier
    v_mfma_f32_32x32x16_bf16 v[80:95], a[44:47], a[32:35], v[80:95]
    v_mfma_f32_32x32x16_bf16 v[144:159], a[44:47], a[36:39], v[144:159]
    v_mfma_f32_32x32x16_bf16 v[96:111], a[48:51], a[32:35], v[96:111]
    v_mfma_f32_32x32x16_bf16 v[160:175], a[48:51], a[36:39], v[160:175]
    v_mfma_f32_32x32x16_bf16 v[112:127], a[52:55], a[32:35], v[112:127]
    v_mfma_f32_32x32x16_bf16 v[176:191], a[52:55], a[36:39], v[176:191]
    v_mfma_f32_32x32x16_bf16 v[192:207], a[56:59], a[32:35], v[192:207]
    v_mfma_f32_32x32x16_bf16 v[208:223], a[56:59], a[36:39], v[208:223]
    v_mfma_f32_32x32x16_bf16 v[224:239], a[32:35], a[60:63], v[224:239]
    v_mfma_f32_32x32x16_bf16 v[240:255], a[36:39], a[60:63], v[240:255]
    s_cmp_eq_u32 s46, 0
    s_cbranch_scc0 K12_e1
    v_lshlrev_b32 v62, 2, v0
    global_load_dword v63, v62, s[100:101] sc1
K12_e1:
    s_lshl_b32 s58, s2, 2
    s_add_u32 s58, s58, s46
    s_lshl_b32 s59, s58, 9
    s_lshl_b32 s58, s58, 12
    v_and_b32 v2, 31, v0
    v_lshlrev_b32 v2, 7, v2
    v_and_b32 v3, 3, v0
    v_lshlrev_b32 v3, 7, v3
    s_mov_b32 s68, s66
    s_and_b32 s69, s67, 0xffff
    s_mov_b32 s70, 0x400000
    s_mov_b32 s71, 0x20000
    s_mov_b32 s96, s64
    s_and_b32 s97, s65, 0xffff
    s_mov_b32 s98, 0x80000
    s_mov_b32 s99, 0x20000
    buffer_load_dword v4, v2, s[68:71], s58 offen
    buffer_load_dword v5, v3, s[96:99], s59 offen
    s_mov_b32 s60, 0x3e0293ee
    v_lshlrev_b32 v1, 4, v0
    s_lshl_b32 s58, s44, 19
    s_lshl_b32 s59, s46, 13
    s_add_u32 s58, s58, s59
    s_add_u32 s58, s58, 33554432
    s_lshl_b32 s76, s61, 15
    s_add_u32 s76, s76, s58
    s_add_u32 s77, s76, 4096
    s_lshl_b32 s78, s62, 15
    s_add_u32 s78, s78, s58
    s_add_u32 s79, s78, 4096
    s_nop 7
    v_mul_f32 v64, s60, v64
    v_mul_f32 v65, s60, v65
    v_mul_f32 v66, s60, v66
    v_mul_f32 v67, s60, v67
    v_mul_f32 v68, s60, v68
    v_mul_f32 v69, s60, v69
    v_mul_f32 v70, s60, v70
    v_mul_f32 v71, s60, v71
    v_mul_f32 v72, s60, v72
    v_mul_f32 v73, s60, v73
    v_mul_f32 v74, s60, v74
    v_mul_f32 v75, s60, v75
    v_mul_f32 v76, s60, v76
    v_mul_f32 v77, s60, v77
    v_mul_f32 v78, s60, v78
    v_mul_f32 v79, s60, v79
    v_cvt_pk_bf16_f32 v64, v64, v65
    v_cvt_pk_bf16_f32 v65, v66, v67
    v_cvt_pk_bf16_f32 v66, v68, v69
    v_cvt_pk_bf16_f32 v67, v70, v71
    v_cvt_pk_bf16_f32 v68, v72, v73
    v_cvt_pk_bf16_f32 v69, v74, v75
    v_cvt_pk_bf16_f32 v70, v76, v77
    v_cvt_pk_bf16_f32 v71, v78, v79
    v_accvgpr_write_b32 a96, v64
    v_accvgpr_write_b32 a97, v65
    v_accvgpr_write_b32 a98, v66
    v_accvgpr_write_b32 a99, v67
    v_accvgpr_write_b32 a100, v68
    v_accvgpr_write_b32 a101, v69
    v_accvgpr_write_b32 a102, v70
    v_accvgpr_write_b32 a103, v71
    v_mul_f32 v80, s60, v80
    v_mul_f32 v81, s60, v81
    v_mul_f32 v82, s60, v82
    v_mul_f32 v83, s60, v83
    v_mul_f32 v84, s60, v84
    v_mul_f32 v85, s60, v85
    v_mul_f32 v86, s60, v86
    v_mul_f32 v87, s60, v87
    v_mul_f32 v88, s60, v88
    v_mul_f32 v89, s60, v89
    v_mul_f32 v90, s60, v90
    v_mul_f32 v91, s60, v91
    v_mul_f32 v92, s60, v92
    v_mul_f32 v93, s60, v93
    v_mul_f32 v94, s60, v94
    v_mul_f32 v95, s60, v95
    v_cvt_pk_bf16_f32 v72, v80, v81
    v_cvt_pk_bf16_f32 v73, v82, v83
    v_cvt_pk_bf16_f32 v74, v84, v85
    v_cvt_pk_bf16_f32 v75, v86, v87
    v_cvt_pk_bf16_f32 v76, v88, v89
    v_cvt_pk_bf16_f32 v77, v90, v91
    v_cvt_pk_bf16_f32 v78, v92, v93
    v_cvt_pk_bf16_f32 v79, v94, v95
    v_accvgpr_write_b32 a104, v72
    v_accvgpr_write_b32 a105, v73
    v_accvgpr_write_b32 a106, v74
    v_accvgpr_write_b32 a107, v75
    v_accvgpr_write_b32 a108, v76
    v_accvgpr_write_b32 a109, v77
    v_accvgpr_write_b32 a110, v78
    v_accvgpr_write_b32 a111, v79
    v_mul_f32 v96, s60, v96
    v_mul_f32 v97, s60, v97
    v_mul_f32 v98, s60, v98
    v_mul_f32 v99, s60, v99
    v_mul_f32 v100, s60, v100
    v_mul_f32 v101, s60, v101
    v_mul_f32 v102, s60, v102
    v_mul_f32 v103, s60, v103
    v_mul_f32 v104, s60, v104
    v_mul_f32 v105, s60, v105
    v_mul_f32 v106, s60, v106
    v_mul_f32 v107, s60, v107
    v_mul_f32 v108, s60, v108
    v_mul_f32 v109, s60, v109
    v_mul_f32 v110, s60, v110
    v_mul_f32 v111, s60, v111
    v_cvt_pk_bf16_f32 v80, v96, v97
    v_cvt_pk_bf16_f32 v81, v98, v99
    v_cvt_pk_bf16_f32 v82, v100, v101
    v_cvt_pk_bf16_f32 v83, v102, v103
    v_cvt_pk_bf16_f32 v84, v104, v105
    v_cvt_pk_bf16_f32 v85, v106, v107
    v_cvt_pk_bf16_f32 v86, v108, v109
    v_cvt_pk_bf16_f32 v87, v110, v111
    v_accvgpr_write_b32 a112, v80
    v_accvgpr_write_b32 a113, v81
    v_accvgpr_write_b32 a114, v82
    v_accvgpr_write_b32 a115, v83
    v_accvgpr_write_b32 a116, v84
    v_accvgpr_write_b32 a117, v85
    v_accvgpr_write_b32 a118, v86
    v_accvgpr_write_b32 a119, v87
    v_mul_f32 v112, s60, v112
    v_mul_f32 v113, s60, v113
    v_mul_f32 v114, s60, v114
    v_mul_f32 v115, s60, v115
    v_mul_f32 v116, s60, v116
    v_mul_f32 v117, s60, v117
    v_mul_f32 v118, s60, v118
    v_mul_f32 v119, s60, v119
    v_mul_f32 v120, s60, v120
    v_mul_f32 v121, s60, v121
    v_mul_f32 v122, s60, v122
    v_mul_f32 v123, s60, v123
    v_mul_f32 v124, s60, v124
    v_mul_f32 v125, s60, v125
    v_mul_f32 v126, s60, v126
    v_mul_f32 v127, s60, v127
    v_cvt_pk_bf16_f32 v88, v112, v113
    v_cvt_pk_bf16_f32 v89, v114, v115
    v_cvt_pk_bf16_f32 v90, v116, v117
    v_cvt_pk_bf16_f32 v91, v118, v119
    v_cvt_pk_bf16_f32 v92, v120, v121
    v_cvt_pk_bf16_f32 v93, v122, v123
    v_cvt_pk_bf16_f32 v94, v124, v125
    v_cvt_pk_bf16_f32 v95, v126, v127
    v_accvgpr_write_b32 a120, v88
    v_accvgpr_write_b32 a121, v89
    v_accvgpr_write_b32 a122, v90
    v_accvgpr_write_b32 a123, v91
    v_accvgpr_write_b32 a124, v92
    v_accvgpr_write_b32 a125, v93
    v_accvgpr_write_b32 a126, v94
    v_accvgpr_write_b32 a127, v95
    v_mul_f32 v128, s60, v128
    v_mul_f32 v129, s60, v129
    v_mul_f32 v130, s60, v130
    v_mul_f32 v131, s60, v131
    v_mul_f32 v132, s60, v132
    v_mul_f32 v133, s60, v133
    v_mul_f32 v134, s60, v134
    v_mul_f32 v135, s60, v135
    v_mul_f32 v136, s60, v136
    v_mul_f32 v137, s60, v137
    v_mul_f32 v138, s60, v138
    v_mul_f32 v139, s60, v139
    v_mul_f32 v140, s60, v140
    v_mul_f32 v141, s60, v141
    v_mul_f32 v142, s60, v142
    v_mul_f32 v143, s60, v143
    v_cvt_pk_bf16_f32 v96, v128, v129
    v_cvt_pk_bf16_f32 v97, v130, v131
    v_cvt_pk_bf16_f32 v98, v132, v133
    v_cvt_pk_bf16_f32 v99, v134, v135
    v_cvt_pk_bf16_f32 v100, v136, v137
    v_cvt_pk_bf16_f32 v101, v138, v139
    v_cvt_pk_bf16_f32 v102, v140, v141
    v_cvt_pk_bf16_f32 v103, v142, v143
    v_accvgpr_write_b32 a0, v96
    v_accvgpr_write_b32 a1, v97
    v_accvgpr_write_b32 a2, v98
    v_accvgpr_write_b32 a3, v99
    v_accvgpr_write_b32 a4, v100
    v_accvgpr_write_b32 a5, v101
    v_accvgpr_write_b32 a6, v102
    v_accvgpr_write_b32 a7, v103
    v_mul_f32 v144, s60, v144
    v_mul_f32 v145, s60, v145
    v_mul_f32 v146, s60, v146
    v_mul_f32 v147, s60, v147
    v_mul_f32 v148, s60, v148
    v_mul_f32 v149, s60, v149
    v_mul_f32 v150, s60, v150
    v_mul_f32 v151, s60, v151
    v_mul_f32 v152, s60, v152
    v_mul_f32 v153, s60, v153
    v_mul_f32 v154, s60, v154
    v_mul_f32 v155, s60, v155
    v_mul_f32 v156, s60, v156
    v_mul_f32 v157, s60, v157
    v_mul_f32 v158, s60, v158
    v_mul_f32 v159, s60, v159
    v_cvt_pk_bf16_f32 v104, v144, v145
    v_cvt_pk_bf16_f32 v105, v146, v147
    v_cvt_pk_bf16_f32 v106, v148, v149
    v_cvt_pk_bf16_f32 v107, v150, v151
    v_cvt_pk_bf16_f32 v108, v152, v153
    v_cvt_pk_bf16_f32 v109, v154, v155
    v_cvt_pk_bf16_f32 v110, v156, v157
    v_cvt_pk_bf16_f32 v111, v158, v159
    v_accvgpr_write_b32 a8, v104
    v_accvgpr_write_b32 a9, v105
    v_accvgpr_write_b32 a10, v106
    v_accvgpr_write_b32 a11, v107
    v_accvgpr_write_b32 a12, v108
    v_accvgpr_write_b32 a13, v109
    v_accvgpr_write_b32 a14, v110
    v_accvgpr_write_b32 a15, v111
    v_mul_f32 v160, s60, v160
    v_mul_f32 v161, s60, v161
    v_mul_f32 v162, s60, v162
    v_mul_f32 v163, s60, v163
    v_mul_f32 v164, s60, v164
    v_mul_f32 v165, s60, v165
    v_mul_f32 v166, s60, v166
    v_mul_f32 v167, s60, v167
    v_mul_f32 v168, s60, v168
    v_mul_f32 v169, s60, v169
    v_mul_f32 v170, s60, v170
    v_mul_f32 v171, s60, v171
    v_mul_f32 v172, s60, v172
    v_mul_f32 v173, s60, v173
    v_mul_f32 v174, s60, v174
    v_mul_f32 v175, s60, v175
    v_cvt_pk_bf16_f32 v112, v160, v161
    v_cvt_pk_bf16_f32 v113, v162, v163
    v_cvt_pk_bf16_f32 v114, v164, v165
    v_cvt_pk_bf16_f32 v115, v166, v167
    v_cvt_pk_bf16_f32 v116, v168, v169
    v_cvt_pk_bf16_f32 v117, v170, v171
    v_cvt_pk_bf16_f32 v118, v172, v173
    v_cvt_pk_bf16_f32 v119, v174, v175
    v_accvgpr_write_b32 a16, v112
    v_accvgpr_write_b32 a17, v113
    v_accvgpr_write_b32 a18, v114
    v_accvgpr_write_b32 a19, v115
    v_accvgpr_write_b32 a20, v116
    v_accvgpr_write_b32 a21, v117
    v_accvgpr_write_b32 a22, v118
    v_accvgpr_write_b32 a23, v119
    v_mul_f32 v176, s60, v176
    v_mul_f32 v177, s60, v177
    v_mul_f32 v178, s60, v178
    v_mul_f32 v179, s60, v179
    v_mul_f32 v180, s60, v180
    v_mul_f32 v181, s60, v181
    v_mul_f32 v182, s60, v182
    v_mul_f32 v183, s60, v183
    v_mul_f32 v184, s60, v184
    v_mul_f32 v185, s60, v185
    v_mul_f32 v186, s60, v186
    v_mul_f32 v187, s60, v187
    v_mul_f32 v188, s60, v188
    v_mul_f32 v189, s60, v189
    v_mul_f32 v190, s60, v190
    v_mul_f32 v191, s60, v191
    v_cvt_pk_bf16_f32 v120, v176, v177
    v_cvt_pk_bf16_f32 v121, v178, v179
    v_cvt_pk_bf16_f32 v122, v180, v181
    v_cvt_pk_bf16_f32 v123, v182, v183
    v_cvt_pk_bf16_f32 v124, v184, v185
    v_cvt_pk_bf16_f32 v125, v186, v187
    v_cvt_pk_bf16_f32 v126, v188, v189
    v_cvt_pk_bf16_f32 v127, v190, v191
    v_accvgpr_write_b32 a24, v120
    v_accvgpr_write_b32 a25, v121
    v_accvgpr_write_b32 a26, v122
    v_accvgpr_write_b32 a27, v123
    v_accvgpr_write_b32 a28, v124
    v_accvgpr_write_b32 a29, v125
    v_accvgpr_write_b32 a30, v126
    v_accvgpr_write_b32 a31, v127
    v_and_b32 v2, 31, v0
    v_lshlrev_b32 v2, 6, v2
    v_lshrrev_b32 v3, 5, v0
    v_lshl_add_u32 v2, v3, 3, v2
    s_lshl_b32 s59, s46, 12
    v_add_u32 v40, s59, v2
    v_bfe_u32 v2, v0, 2, 2
    v_lshl_add_u32 v2, v3, 2, v2
    v_lshlrev_b32 v2, 6, v2
    v_bfe_u32 v3, v0, 4, 1
    v_lshl_add_u32 v2, v3, 5, v2
    v_and_b32 v3, 3, v0
    v_lshl_add_u32 v2, v3, 3, v2
    v_add_u32 v41, s59, v2
    v_and_b32 v2, 27, v0
    v_cmp_eq_u32 s[72:73], 16, v2
    v_mov_b32 v42, 0x3f803f80
    s_lshl_b32 s58, s44, 17
    s_lshl_b32 s59, s46, 11
    s_add_u32 s58, s58, s59
    s_add_u32 s58, s58, 50331648
    v_cvt_pk_bf16_f32 v44, v192, v193
    v_cvt_pk_bf16_f32 v45, v194, v195
    v_cvt_pk_bf16_f32 v46, v196, v197
    v_cvt_pk_bf16_f32 v47, v198, v199
    v_cvt_pk_bf16_f32 v48, v200, v201
    v_cvt_pk_bf16_f32 v49, v202, v203
    v_cvt_pk_bf16_f32 v50, v204, v205
    v_cvt_pk_bf16_f32 v51, v206, v207
    s_nop 1
    v_mfma_f32_32x32x16_bf16 v[128:143], v[36:39], v[44:47], 0
    v_mfma_f32_32x32x16_bf16 v[144:159], v[36:39], v[48:51], 0
    v_cvt_pk_bf16_f32 v160, v224, v225
    v_cvt_pk_bf16_f32 v161, v226, v227
    v_cvt_pk_bf16_f32 v162, v228, v229
    v_cvt_pk_bf16_f32 v163, v230, v231
    v_cvt_pk_bf16_f32 v164, v232, v233
    v_cvt_pk_bf16_f32 v165, v234, v235
    v_cvt_pk_bf16_f32 v166, v236, v237
    v_cvt_pk_bf16_f32 v167, v238, v239
    v_cndmask_b32 v160, v160, v42, s[72:73]
    v_cndmask_b32 v161, v161, v42, s[72:73]
    v_cndmask_b32 v162, v162, v42, s[72:73]
    v_cndmask_b32 v163, v163, v42, s[72:73]
    v_cndmask_b32 v164, v164, v42, s[72:73]
    v_cndmask_b32 v165, v165, v42, s[72:73]
    v_cndmask_b32 v166, v166, v42, s[72:73]
    v_cndmask_b32 v167, v167, v42, s[72:73]
    s_nop 7
    v_max3_f32 v52, v144, v145, v146
    v_max3_f32 v56, v152, v153, v154
    v_max3_f32 v52, v52, v147, v148
    v_max3_f32 v56, v56, v155, v156
    v_max3_f32 v52, v52, v149, v150
    v_max3_f32 v56, v56, v157, v158
    v_max_f32 v52, v52, v151
    v_max_f32 v56, v56, v159
    v_mov_b32 v53, v52
    s_nop 1
    v_permlane32_swap_b32 v52, v53
    s_nop 0
    v_mov_b32 v57, v56
    s_nop 1
    v_permlane32_swap_b32 v56, v57
    s_nop 0
    v_max_f32 v52, v52, v53
    v_max_f32 v56, v56, v57
    v_mul_f32 v52, s63, v52
    v_mul_f32 v56, s63, v56
    v_fma_f32 v144, v144, s63, -v52
    v_fma_f32 v152, v152, s63, -v56
    v_fma_f32 v145, v145, s63, -v52
    v_fma_f32 v153, v153, s63, -v56
    v_fma_f32 v146, v146, s63, -v52
    v_fma_f32 v154, v154, s63, -v56
    v_fma_f32 v147, v147, s63, -v52
    v_fma_f32 v155, v155, s63, -v56
    v_fma_f32 v148, v148, s63, -v52
    v_fma_f32 v156, v156, s63, -v56
    v_fma_f32 v149, v149, s63, -v52
    v_fma_f32 v157, v157, s63, -v56
    v_fma_f32 v150, v150, s63, -v52
    v_fma_f32 v158, v158, s63, -v56
    v_fma_f32 v151, v151, s63, -v52
    v_fma_f32 v159, v159, s63, -v56
    v_exp_f32 v144, v144
    v_exp_f32 v152, v152
    v_exp_f32 v145, v145
    v_exp_f32 v153, v153
    v_exp_f32 v146, v146
    v_exp_f32 v154, v154
    v_exp_f32 v147, v147
    v_exp_f32 v155, v155
    v_exp_f32 v148, v148
    v_exp_f32 v156, v156
    v_exp_f32 v149, v149
    v_exp_f32 v157, v157
    v_exp_f32 v150, v150
    v_exp_f32 v158, v158
    v_exp_f32 v151, v151
    v_exp_f32 v159, v159
    s_nop 0
    v_add_f32 v54, v144, v145
    s_nop 0
    v_add_f32 v58, v152, v153
    v_add_f32 v54, v54, v146
    v_add_f32 v58, v58, v154
    v_add_f32 v54, v54, v147
    v_add_f32 v58, v58, v155
    v_add_f32 v54, v54, v148
    v_add_f32 v58, v58, v156
    v_add_f32 v54, v54, v149
    v_add_f32 v58, v58, v157
    v_add_f32 v54, v54, v150
    v_add_f32 v58, v58, v158
    v_add_f32 v54, v54, v151
    v_add_f32 v58, v58, v159
    v_mov_b32 v53, v54
    s_nop 1
    v_permlane32_swap_b32 v54, v53
    s_nop 0
    v_mov_b32 v57, v58
    s_nop 1
    v_permlane32_swap_b32 v58, v57
    s_nop 0
    v_add_f32 v54, v54, v53
    v_add_f32 v58, v58, v57
    v_rcp_f32 v54, v54
    v_rcp_f32 v58, v58
    s_nop 0
    v_mul_f32 v144, v144, v54
    s_nop 0
    v_mul_f32 v152, v152, v58
    v_mul_f32 v145, v145, v54
    v_mul_f32 v153, v153, v58
    v_mul_f32 v146, v146, v54
    v_mul_f32 v154, v154, v58
    v_mul_f32 v147, v147, v54
    v_mul_f32 v155, v155, v58
    v_mul_f32 v148, v148, v54
    v_mul_f32 v156, v156, v58
    v_mul_f32 v149, v149, v54
    v_mul_f32 v157, v157, v58
    v_mul_f32 v150, v150, v54
    v_mul_f32 v158, v158, v58
    v_mul_f32 v151, v151, v54
    v_mul_f32 v159, v159, v58
    v_cvt_pk_bf16_f32 v176, v144, v145
    v_cvt_pk_bf16_f32 v180, v152, v153
    v_cvt_pk_bf16_f32 v177, v146, v147
    v_cvt_pk_bf16_f32 v181, v154, v155
    v_cvt_pk_bf16_f32 v178, v148, v149
    v_cvt_pk_bf16_f32 v182, v156, v157
    v_cvt_pk_bf16_f32 v179, v150, v151
    v_cvt_pk_bf16_f32 v183, v158, v159
    ds_write_b64 v40, v[176:177] offset:0
    ds_write_b64 v40, v[178:179] offset:16
    ds_write_b64 v40, v[180:181] offset:32
    ds_write_b64 v40, v[182:183] offset:48
    s_waitcnt lgkmcnt(0)
    ds_read_b64_tr_b16 v[184:185], v41 offset:0
    ds_read_b64_tr_b16 v[186:187], v41 offset:512
    ds_read_b64_tr_b16 v[188:189], v41 offset:1024
    ds_read_b64_tr_b16 v[190:191], v41 offset:1536
    v_max3_f32 v52, v128, v129, v130
    v_max3_f32 v56, v136, v137, v138
    v_max3_f32 v52, v52, v131, v132
    v_max3_f32 v56, v56, v139, v140
    v_max3_f32 v52, v52, v133, v134
    v_max3_f32 v56, v56, v141, v142
    v_max_f32 v52, v52, v135
    v_max_f32 v56, v56, v143
    v_mov_b32 v53, v52
    s_nop 1
    v_permlane32_swap_b32 v52, v53
    s_nop 0
    v_mov_b32 v57, v56
    s_nop 1
    v_permlane32_swap_b32 v56, v57
    s_nop 0
    v_max_f32 v52, v52, v53
    v_max_f32 v56, v56, v57
    v_mul_f32 v52, s63, v52
    v_mul_f32 v56, s63, v56
    v_fma_f32 v128, v128, s63, -v52
    v_fma_f32 v136, v136, s63, -v56
    v_fma_f32 v129, v129, s63, -v52
    v_fma_f32 v137, v137, s63, -v56
    v_fma_f32 v130, v130, s63, -v52
    v_fma_f32 v138, v138, s63, -v56
    v_fma_f32 v131, v131, s63, -v52
    v_fma_f32 v139, v139, s63, -v56
    v_fma_f32 v132, v132, s63, -v52
    v_fma_f32 v140, v140, s63, -v56
    v_fma_f32 v133, v133, s63, -v52
    v_fma_f32 v141, v141, s63, -v56
    v_fma_f32 v134, v134, s63, -v52
    v_fma_f32 v142, v142, s63, -v56
    v_fma_f32 v135, v135, s63, -v52
    v_fma_f32 v143, v143, s63, -v56
    v_exp_f32 v128, v128
    v_exp_f32 v136, v136
    v_exp_f32 v129, v129
    v_exp_f32 v137, v137
    v_exp_f32 v130, v130
    v_exp_f32 v138, v138
    v_exp_f32 v131, v131
    v_exp_f32 v139, v139
    v_exp_f32 v132, v132
    v_exp_f32 v140, v140
    v_exp_f32 v133, v133
    v_exp_f32 v141, v141
    v_exp_f32 v134, v134
    v_exp_f32 v142, v142
    v_exp_f32 v135, v135
    v_exp_f32 v143, v143
    s_nop 0
    v_add_f32 v54, v128, v129
    s_nop 0
    v_add_f32 v58, v136, v137
    v_add_f32 v54, v54, v130
    v_add_f32 v58, v58, v138
    v_add_f32 v54, v54, v131
    v_add_f32 v58, v58, v139
    v_add_f32 v54, v54, v132
    v_add_f32 v58, v58, v140
    v_add_f32 v54, v54, v133
    v_add_f32 v58, v58, v141
    v_add_f32 v54, v54, v134
    v_add_f32 v58, v58, v142
    v_add_f32 v54, v54, v135
    v_add_f32 v58, v58, v143
    v_mov_b32 v53, v54
    s_nop 1
    v_permlane32_swap_b32 v54, v53
    s_nop 0
    v_mov_b32 v57, v58
    s_nop 1
    v_permlane32_swap_b32 v58, v57
    s_nop 0
    v_add_f32 v54, v54, v53
    v_add_f32 v58, v58, v57
    v_rcp_f32 v54, v54
    v_rcp_f32 v58, v58
    s_nop 0
    v_mul_f32 v128, v128, v54
    s_nop 0
    v_mul_f32 v136, v136, v58
    v_mul_f32 v129, v129, v54
    v_mul_f32 v137, v137, v58
    v_mul_f32 v130, v130, v54
    v_mul_f32 v138, v138, v58
    v_mul_f32 v131, v131, v54
    v_mul_f32 v139, v139, v58
    v_mul_f32 v132, v132, v54
    v_mul_f32 v140, v140, v58
    v_mul_f32 v133, v133, v54
    v_mul_f32 v141, v141, v58
    v_mul_f32 v134, v134, v54
    v_mul_f32 v142, v142, v58
    v_mul_f32 v135, v135, v54
    v_mul_f32 v143, v143, v58
    v_cvt_pk_bf16_f32 v168, v128, v129
    v_cvt_pk_bf16_f32 v172, v136, v137
    v_cvt_pk_bf16_f32 v169, v130, v131
    v_cvt_pk_bf16_f32 v173, v138, v139
    v_cvt_pk_bf16_f32 v170, v132, v133
    v_cvt_pk_bf16_f32 v174, v140, v141
    v_cvt_pk_bf16_f32 v171, v134, v135
    v_cvt_pk_bf16_f32 v175, v142, v143
    s_lshl_b32 s59, s61, 13
    s_add_u32 s59, s59, s58
    s_nop 1
    v_accvgpr_write_b32 a128, v168
    v_accvgpr_write_b32 a129, v169
    v_accvgpr_write_b32 a130, v170
    v_accvgpr_write_b32 a131, v171
    v_accvgpr_write_b32 a132, v172
    v_accvgpr_write_b32 a133, v173
    v_accvgpr_write_b32 a134, v174
    v_accvgpr_write_b32 a135, v175
    s_waitcnt lgkmcnt(0)
    v_mfma_f32_32x32x16_bf16 v[8:23], v[184:187], v[160:163], 0
    v_mfma_f32_32x32x16_bf16 v[8:23], v[188:191], v[164:167], v[8:23]
    v_cvt_pk_bf16_f32 v44, v208, v209
    v_cvt_pk_bf16_f32 v45, v210, v211
    v_cvt_pk_bf16_f32 v46, v212, v213
    v_cvt_pk_bf16_f32 v47, v214, v215
    v_cvt_pk_bf16_f32 v48, v216, v217
    v_cvt_pk_bf16_f32 v49, v218, v219
    v_cvt_pk_bf16_f32 v50, v220, v221
    v_cvt_pk_bf16_f32 v51, v222, v223
    s_nop 1
    v_mfma_f32_32x32x16_bf16 v[128:143], v[36:39], v[44:47], 0
    v_mfma_f32_32x32x16_bf16 v[144:159], v[36:39], v[48:51], 0
    v_cvt_pk_bf16_f32 v160, v240, v241
    v_cvt_pk_bf16_f32 v161, v242, v243
    v_cvt_pk_bf16_f32 v162, v244, v245
    v_cvt_pk_bf16_f32 v163, v246, v247
    v_cvt_pk_bf16_f32 v164, v248, v249
    v_cvt_pk_bf16_f32 v165, v250, v251
    v_cvt_pk_bf16_f32 v166, v252, v253
    v_cvt_pk_bf16_f32 v167, v254, v255
    v_cndmask_b32 v160, v160, v42, s[72:73]
    v_cndmask_b32 v161, v161, v42, s[72:73]
    v_cndmask_b32 v162, v162, v42, s[72:73]
    v_cndmask_b32 v163, v163, v42, s[72:73]
    v_cndmask_b32 v164, v164, v42, s[72:73]
    v_cndmask_b32 v165, v165, v42, s[72:73]
    v_cndmask_b32 v166, v166, v42, s[72:73]
    v_cndmask_b32 v167, v167, v42, s[72:73]
    s_nop 7
    v_max3_f32 v52, v144, v145, v146
    v_max3_f32 v56, v152, v153, v154
    v_max3_f32 v52, v52, v147, v148
    v_max3_f32 v56, v56, v155, v156
    v_max3_f32 v52, v52, v149, v150
    v_max3_f32 v56, v56, v157, v158
    v_max_f32 v52, v52, v151
    v_max_f32 v56, v56, v159
    v_mov_b32 v53, v52
    s_nop 1
    v_permlane32_swap_b32 v52, v53
    s_nop 0
    v_mov_b32 v57, v56
    s_nop 1
    v_permlane32_swap_b32 v56, v57
    s_nop 0
    v_max_f32 v52, v52, v53
    v_max_f32 v56, v56, v57
    v_mul_f32 v52, s63, v52
    v_mul_f32 v56, s63, v56
    v_fma_f32 v144, v144, s63, -v52
    v_fma_f32 v152, v152, s63, -v56
    v_fma_f32 v145, v145, s63, -v52
    v_fma_f32 v153, v153, s63, -v56
    v_fma_f32 v146, v146, s63, -v52
    v_fma_f32 v154, v154, s63, -v56
    v_fma_f32 v147, v147, s63, -v52
    v_fma_f32 v155, v155, s63, -v56
    v_fma_f32 v148, v148, s63, -v52
    v_fma_f32 v156, v156, s63, -v56
    v_fma_f32 v149, v149, s63, -v52
    v_fma_f32 v157, v157, s63, -v56
    v_fma_f32 v150, v150, s63, -v52
    v_fma_f32 v158, v158, s63, -v56
    v_fma_f32 v151, v151, s63, -v52
    v_fma_f32 v159, v159, s63, -v56
    v_exp_f32 v144, v144
    v_exp_f32 v152, v152
    v_exp_f32 v145, v145
    v_exp_f32 v153, v153
    v_exp_f32 v146, v146
    v_exp_f32 v154, v154
    v_exp_f32 v147, v147
    v_exp_f32 v155, v155
    v_exp_f32 v148, v148
    v_exp_f32 v156, v156
    v_exp_f32 v149, v149
    v_exp_f32 v157, v157
    v_exp_f32 v150, v150
    v_exp_f32 v158, v158
    v_exp_f32 v151, v151
    v_exp_f32 v159, v159
    s_nop 0
    v_add_f32 v54, v144, v145
    s_nop 0
    v_add_f32 v58, v152, v153
    v_add_f32 v54, v54, v146
    v_add_f32 v58, v58, v154
    v_add_f32 v54, v54, v147
    v_add_f32 v58, v58, v155
    v_add_f32 v54, v54, v148
    v_add_f32 v58, v58, v156
    v_add_f32 v54, v54, v149
    v_add_f32 v58, v58, v157
    v_add_f32 v54, v54, v150
    v_add_f32 v58, v58, v158
    v_add_f32 v54, v54, v151
    v_add_f32 v58, v58, v159
    v_mov_b32 v53, v54
    s_nop 1
    v_permlane32_swap_b32 v54, v53
    s_nop 0
    v_mov_b32 v57, v58
    s_nop 1
    v_permlane32_swap_b32 v58, v57
    s_nop 0
    v_add_f32 v54, v54, v53
    v_add_f32 v58, v58, v57
    v_rcp_f32 v54, v54
    v_rcp_f32 v58, v58
    s_nop 0
    v_mul_f32 v144, v144, v54
    s_nop 0
    v_mul_f32 v152, v152, v58
    v_mul_f32 v145, v145, v54
    v_mul_f32 v153, v153, v58
    v_mul_f32 v146, v146, v54
    v_mul_f32 v154, v154, v58
    v_mul_f32 v147, v147, v54
    v_mul_f32 v155, v155, v58
    v_mul_f32 v148, v148, v54
    v_mul_f32 v156, v156, v58
    v_mul_f32 v149, v149, v54
    v_mul_f32 v157, v157, v58
    v_mul_f32 v150, v150, v54
    v_mul_f32 v158, v158, v58
    v_mul_f32 v151, v151, v54
    v_mul_f32 v159, v159, v58
    v_cvt_pk_bf16_f32 v176, v144, v145
    v_cvt_pk_bf16_f32 v180, v152, v153
    v_cvt_pk_bf16_f32 v177, v146, v147
    v_cvt_pk_bf16_f32 v181, v154, v155
    v_cvt_pk_bf16_f32 v178, v148, v149
    v_cvt_pk_bf16_f32 v182, v156, v157
    v_cvt_pk_bf16_f32 v179, v150, v151
    v_cvt_pk_bf16_f32 v183, v158, v159
    ds_write_b64 v40, v[176:177] offset:2048
    ds_write_b64 v40, v[178:179] offset:2064
    ds_write_b64 v40, v[180:181] offset:2080
    ds_write_b64 v40, v[182:183] offset:2096
    s_waitcnt lgkmcnt(0)
    ds_read_b64_tr_b16 v[184:185], v41 offset:2048
    ds_read_b64_tr_b16 v[186:187], v41 offset:2560
    ds_read_b64_tr_b16 v[188:189], v41 offset:3072
    ds_read_b64_tr_b16 v[190:191], v41 offset:3584
    v_max3_f32 v52, v128, v129, v130
    v_max3_f32 v56, v136, v137, v138
    v_max3_f32 v52, v52, v131, v132
    v_max3_f32 v56, v56, v139, v140
    v_max3_f32 v52, v52, v133, v134
    v_max3_f32 v56, v56, v141, v142
    v_max_f32 v52, v52, v135
    v_max_f32 v56, v56, v143
    v_mov_b32 v53, v52
    s_nop 1
    v_permlane32_swap_b32 v52, v53
    s_nop 0
    v_mov_b32 v57, v56
    s_nop 1
    v_permlane32_swap_b32 v56, v57
    s_nop 0
    v_max_f32 v52, v52, v53
    v_max_f32 v56, v56, v57
    v_mul_f32 v52, s63, v52
    v_mul_f32 v56, s63, v56
    v_fma_f32 v128, v128, s63, -v52
    v_fma_f32 v136, v136, s63, -v56
    v_fma_f32 v129, v129, s63, -v52
    v_fma_f32 v137, v137, s63, -v56
    v_fma_f32 v130, v130, s63, -v52
    v_fma_f32 v138, v138, s63, -v56
    v_fma_f32 v131, v131, s63, -v52
    v_fma_f32 v139, v139, s63, -v56
    v_fma_f32 v132, v132, s63, -v52
    v_fma_f32 v140, v140, s63, -v56
    v_fma_f32 v133, v133, s63, -v52
    v_fma_f32 v141, v141, s63, -v56
    v_fma_f32 v134, v134, s63, -v52
    v_fma_f32 v142, v142, s63, -v56
    v_fma_f32 v135, v135, s63, -v52
    v_fma_f32 v143, v143, s63, -v56
    v_exp_f32 v128, v128
    v_exp_f32 v136, v136
    v_exp_f32 v129, v129
    v_exp_f32 v137, v137
    v_exp_f32 v130, v130
    v_exp_f32 v138, v138
    v_exp_f32 v131, v131
    v_exp_f32 v139, v139
    v_exp_f32 v132, v132
    v_exp_f32 v140, v140
    v_exp_f32 v133, v133
    v_exp_f32 v141, v141
    v_exp_f32 v134, v134
    v_exp_f32 v142, v142
    v_exp_f32 v135, v135
    v_exp_f32 v143, v143
    s_nop 0
    v_add_f32 v54, v128, v129
    s_nop 0
    v_add_f32 v58, v136, v137
    v_add_f32 v54, v54, v130
    v_add_f32 v58, v58, v138
    v_add_f32 v54, v54, v131
    v_add_f32 v58, v58, v139
    v_add_f32 v54, v54, v132
    v_add_f32 v58, v58, v140
    v_add_f32 v54, v54, v133
    v_add_f32 v58, v58, v141
    v_add_f32 v54, v54, v134
    v_add_f32 v58, v58, v142
    v_add_f32 v54, v54, v135
    v_add_f32 v58, v58, v143
    v_mov_b32 v53, v54
    s_nop 1
    v_permlane32_swap_b32 v54, v53
    s_nop 0
    v_mov_b32 v57, v58
    s_nop 1
    v_permlane32_swap_b32 v58, v57
    s_nop 0
    v_add_f32 v54, v54, v53
    v_add_f32 v58, v58, v57
    v_rcp_f32 v54, v54
    v_rcp_f32 v58, v58
    s_nop 0
    v_mul_f32 v128, v128, v54
    s_nop 0
    v_mul_f32 v136, v136, v58
    v_mul_f32 v129, v129, v54
    v_mul_f32 v137, v137, v58
    v_mul_f32 v130, v130, v54
    v_mul_f32 v138, v138, v58
    v_mul_f32 v131, v131, v54
    v_mul_f32 v139, v139, v58
    v_mul_f32 v132, v132, v54
    v_mul_f32 v140, v140, v58
    v_mul_f32 v133, v133, v54
    v_mul_f32 v141, v141, v58
    v_mul_f32 v134, v134, v54
    v_mul_f32 v142, v142, v58
    v_mul_f32 v135, v135, v54
    v_mul_f32 v143, v143, v58
    v_cvt_pk_bf16_f32 v168, v128, v129
    v_cvt_pk_bf16_f32 v172, v136, v137
    v_cvt_pk_bf16_f32 v169, v130, v131
    v_cvt_pk_bf16_f32 v173, v138, v139
    v_cvt_pk_bf16_f32 v170, v132, v133
    v_cvt_pk_bf16_f32 v174, v140, v141
    v_cvt_pk_bf16_f32 v171, v134, v135
    v_cvt_pk_bf16_f32 v175, v142, v143
    s_lshl_b32 s59, s62, 13
    s_add_u32 s59, s59, s58
    s_nop 1
    v_accvgpr_write_b32 a136, v168
    v_accvgpr_write_b32 a137, v169
    v_accvgpr_write_b32 a138, v170
    v_accvgpr_write_b32 a139, v171
    v_accvgpr_write_b32 a140, v172
    v_accvgpr_write_b32 a141, v173
    v_accvgpr_write_b32 a142, v174
    v_accvgpr_write_b32 a143, v175
    s_waitcnt lgkmcnt(0)
    v_mfma_f32_32x32x16_bf16 v[8:23], v[184:187], v[160:163], v[8:23]
    v_mfma_f32_32x32x16_bf16 v[8:23], v[188:191], v[164:167], v[8:23]
    s_nop 7
    s_nop 7
    s_lshl_b32 s59, s46, 12
    s_add_u32 s59, s59, 32768
    v_add_u32 v2, s59, v1
    ds_write_b128 v2, v[8:11] offset:0
    ds_write_b128 v2, v[12:15] offset:1024
    ds_write_b128 v2, v[16:19] offset:2048
    ds_write_b128 v2, v[20:23] offset:3072
    s_waitcnt lgkmcnt(0)
    s_barrier
    s_lshl_b32 s59, s46, 10
    s_add_u32 s59, s59, 32768
    v_add_u32 v2, s59, v1
    ds_read_b128 v[128:131], v2 offset:0
    ds_read_b128 v[132:135], v2 offset:4096
    ds_read_b128 v[136:139], v2 offset:8192
    ds_read_b128 v[140:143], v2 offset:12288
    s_waitcnt lgkmcnt(0)
    v_add_f32 v128, v128, v132
    v_add_f32 v136, v136, v140
    v_add_f32 v129, v129, v133
    v_add_f32 v137, v137, v141
    v_add_f32 v130, v130, v134
    v_add_f32 v138, v138, v142
    v_add_f32 v131, v131, v135
    v_add_f32 v139, v139, v143
    v_add_f32 v128, v128, v136
    v_add_f32 v129, v129, v137
    v_add_f32 v130, v130, v138
    v_add_f32 v131, v131, v139
    s_lshl_b32 s58, s44, 15
    s_lshl_b32 s59, s45, 12
    s_add_u32 s58, s58, s59
    s_lshl_b32 s59, s46, 10
    s_add_u32 s58, s58, s59
    s_add_u32 s58, s58, 54525952
    buffer_store_dwordx4 v[128:131], v1, s[32:35], s58 offen sc1
    s_lshl_b32 s58, s2, 2
    s_add_u32 s58, s58, s46
    s_lshl_b32 s58, s58, 7
    s_add_u32 s58, s58, 100663296
    v_mov_b32 v2, 0
    v_and_b32 v3, 31, v0
    v_lshlrev_b32 v3, 2, v3
    buffer_store_dword v2, v3, s[32:35], s58 offen
    s_waitcnt vmcnt(0)
    s_waitcnt lgkmcnt(0)
    s_barrier
    s_cmp_eq_u32 s46, 0
    s_cbranch_scc0 K12_f3
    s_lshl_b32 s58, s44, 3
    s_add_u32 s58, s58, s45
    s_lshl_b32 s58, s58, 7
    s_add_u32 s58, s58, 101711872
    v_and_b32 v3, 31, v0
    v_lshlrev_b32 v3, 2, v3
    v_mov_b32 v2, 1
    buffer_store_dword v2, v3, s[32:35], s58 offen sc1
K12_f3:
    s_branch K2_start
K1_end:
    s_endpgm
.p2align 6
K2_start:
    s_load_dwordx2 s[82:83], s[0:1], 104
    s_and_b32 s44, s2, 7
    s_lshl_b32 s44, s44, 2
    s_bfe_u32 s45, s2, 0x20003
    s_add_u32 s44, s44, s45
    s_lshr_b32 s45, s2, 5
    s_lshl_b32 s51, s46, 12
    s_mov_b32 s58, 0x41000000
    v_lshlrev_b32 v1, 4, v0
    v_add_u32 v2, 0x10000, v1
    s_waitcnt lgkmcnt(0)
    s_mov_b32 s12, s82
    s_and_b32 s13, s83, 0xffff
    s_mov_b32 s14, 0x10000000
    s_mov_b32 s15, 0x20000
    s_lshl_b32 s54, s44, 20
    s_add_u32 s84, s82, s54
    s_addc_u32 s85, s83, 0
    s_mov_b32 s8, s84
    s_and_b32 s9, s85, 0xffff
    s_mov_b32 s10, 0x100000
    s_mov_b32 s11, 0x20000
    s_lshl_b32 s54, s44, 15
    s_lshl_b32 s55, s46, 10
    s_add_u32 s54, s54, s55
    s_add_u32 s54, s54, 54525952
    v_and_b32 v14, 31, v0
    v_lshlrev_b32 v14, 2, v14
    s_sub_u32 s66, 15, s45
    s_mov_b32 s60, 1
    s_cmp_eq_u32 s46, 0
    s_cbranch_scc0 K12_go
    v_lshlrev_b32 v16, 2, v0
    v_mov_b32 v18, 0x01010101
    s_mov_b32 s52, 200000
    v_cmp_ne_u32 vcc, v63, v18
    s_cbranch_vccz K12_p2
    K12_poll:
    global_load_dword v20, v16, s[100:101] sc1
    s_waitcnt vmcnt(0)
    v_cmp_ne_u32 vcc, v20, v18
    s_cbranch_vccz K12_p2
    s_sub_u32 s52, s52, 1
    s_cbranch_scc0 K12_poll
    K12_p2:
    v_and_b32 v16, 7, v0
    v_lshlrev_b32 v16, 7, v16
    s_lshl_b32 s55, s44, 10
    s_add_u32 s55, s55, 101711872
    s_mov_b32 s52, 200000
    K12_poll2:
    buffer_load_dword v20, v16, s[12:15], s55 offen sc1
    s_waitcnt vmcnt(0)
    v_cmp_ne_u32 vcc, 1, v20
    s_cbranch_vccz K12_go
    s_sub_u32 s52, s52, 1
    s_cbranch_scc0 K12_poll2
    K12_go:
    s_barrier
    buffer_load_dwordx4 v[64:67], v1, s[12:15], s54 offen
    s_add_u32 s54, s54, 4096
    buffer_load_dwordx4 v[68:71], v1, s[12:15], s54 offen
    s_add_u32 s54, s54, 4096
    buffer_load_dwordx4 v[72:75], v1, s[12:15], s54 offen
    s_add_u32 s54, s54, 4096
    buffer_load_dwordx4 v[76:79], v1, s[12:15], s54 offen
    s_add_u32 s54, s54, 4096
    buffer_load_dwordx4 v[80:83], v1, s[12:15], s54 offen
    s_add_u32 s54, s54, 4096
    buffer_load_dwordx4 v[84:87], v1, s[12:15], s54 offen
    s_add_u32 s54, s54, 4096
    buffer_load_dwordx4 v[88:91], v1, s[12:15], s54 offen
    s_add_u32 s54, s54, 4096
    buffer_load_dwordx4 v[92:95], v1, s[12:15], s54 offen
    s_add_u32 s54, s54, 4096
    s_lshl_b32 s54, s66, 1
    s_sub_u32 s61, 1, s54
    s_and_b32 s61, s61, 3
    s_lshl_b32 s62, s66, 2
    s_add_u32 s62, s62, s46
    s_lshl_b32 s63, s61, 15
    s_add_u32 s63, s63, s51
    s_add_u32 s54, s61, 1
    s_and_b32 s54, s54, 3
    s_lshl_b32 s54, s54, 15
    s_add_u32 s64, s54, s51
    s_add_u32 s65, s51, 32768
    s_add_u32 s54, s61, 0
    s_and_b32 s54, s54, 3
    s_lshl_b32 s54, s54, 15
    s_add_u32 s54, s54, s51
    s_add_u32 m0, s54, 0
    s_add_u32 s55, s51, 0
    buffer_load_dwordx4 v1, s[8:11], s55 offen lds
    buffer_load_dwordx4 v1, s[8:11], s55 offen offset:1024 lds
    buffer_load_dwordx4 v1, s[8:11], s55 offen offset:2048 lds
    buffer_load_dwordx4 v1, s[8:11], s55 offen offset:3072 lds
    s_add_u32 s54, s61, 1
    s_and_b32 s54, s54, 3
    s_lshl_b32 s54, s54, 15
    s_add_u32 s54, s54, s51
    s_add_u32 m0, s54, 0
    s_add_u32 s55, s51, 32768
    buffer_load_dwordx4 v1, s[8:11], s55 offen lds
    buffer_load_dwordx4 v1, s[8:11], s55 offen offset:1024 lds
    buffer_load_dwordx4 v1, s[8:11], s55 offen offset:2048 lds
    buffer_load_dwordx4 v1, s[8:11], s55 offen offset:3072 lds
    s_add_u32 s54, s61, 2
    s_and_b32 s54, s54, 3
    s_lshl_b32 s54, s54, 15
    s_add_u32 s54, s54, s51
    s_add_u32 m0, s54, 0
    s_add_u32 s55, s51, 65536
    buffer_load_dwordx4 v1, s[8:11], s55 offen lds
    buffer_load_dwordx4 v1, s[8:11], s55 offen offset:1024 lds
    buffer_load_dwordx4 v1, s[8:11], s55 offen offset:2048 lds
    buffer_load_dwordx4 v1, s[8:11], s55 offen offset:3072 lds
    s_lshl_b32 s54, s62, 7
    s_add_u32 s54, s54, 55574528
    buffer_load_dword v12, v14, s[12:15], s54 offen sc1
    v_accvgpr_read_b32 v32, a136
    v_accvgpr_read_b32 v33, a137
    v_accvgpr_read_b32 v34, a138
    v_accvgpr_read_b32 v35, a139
    v_accvgpr_read_b32 v36, a140
    v_accvgpr_read_b32 v37, a141
    v_accvgpr_read_b32 v38, a142
    v_accvgpr_read_b32 v39, a143
    v_and_b32 v16, 31, v0
    v_lshrrev_b32 v17, 5, v0
    v_lshlrev_b32 v17, 2, v17
    s_lshl_b32 s55, s46, 5
    v_add_u32 v16, s55, v16
    v_sub_u32 v16, v16, v17
    v_cvt_f32_i32 v16, v16
    v_add_f32 v16, 0.5, v16
    v_mul_f32 v11, 0x71800000, v16
    s_waitcnt vmcnt(13)
    v_add_f32 v64, v64, v68
    v_add_f32 v72, v72, v76
    v_add_f32 v80, v80, v84
    v_add_f32 v88, v88, v92
    v_add_f32 v65, v65, v69
    v_add_f32 v73, v73, v77
    v_add_f32 v81, v81, v85
    v_add_f32 v89, v89, v93
    v_add_f32 v66, v66, v70
    v_add_f32 v74, v74, v78
    v_add_f32 v82, v82, v86
    v_add_f32 v90, v90, v94
    v_add_f32 v67, v67, v71
    v_add_f32 v75, v75, v79
    v_add_f32 v83, v83, v87
    v_add_f32 v91, v91, v95
    v_add_f32 v64, v64, v72
    v_add_f32 v80, v80, v88
    v_add_f32 v65, v65, v73
    v_add_f32 v81, v81, v89
    v_add_f32 v66, v66, v74
    v_add_f32 v82, v82, v90
    v_add_f32 v67, v67, v75
    v_add_f32 v83, v83, v91
    v_add_f32 v64, v64, v80
    v_add_f32 v65, v65, v81
    v_add_f32 v66, v66, v82
    v_add_f32 v67, v67, v83
    s_add_u32 s54, s61, 0
    s_and_b32 s54, s54, 3
    s_lshl_b32 s54, s54, 15
    s_add_u32 s54, s54, s51
    s_add_u32 m0, s54, 16384
    s_add_u32 s55, s51, 16384
    buffer_load_dwordx4 v1, s[8:11], s55 offen lds
    buffer_load_dwordx4 v1, s[8:11], s55 offen offset:1024 lds
    buffer_load_dwordx4 v1, s[8:11], s55 offen offset:2048 lds
    buffer_load_dwordx4 v1, s[8:11], s55 offen offset:3072 lds
    s_add_u32 s54, s61, 1
    s_and_b32 s54, s54, 3
    s_lshl_b32 s54, s54, 15
    s_add_u32 s54, s54, s51
    s_add_u32 m0, s54, 16384
    s_add_u32 s55, s51, 49152
    buffer_load_dwordx4 v1, s[8:11], s55 offen lds
    buffer_load_dwordx4 v1, s[8:11], s55 offen offset:1024 lds
    buffer_load_dwordx4 v1, s[8:11], s55 offen offset:2048 lds
    buffer_load_dwordx4 v1, s[8:11], s55 offen offset:3072 lds
    s_add_u32 s54, s61, 3
    s_and_b32 s54, s54, 3
    s_lshl_b32 s54, s54, 15
    s_add_u32 s54, s54, s51
    s_add_u32 m0, s54, 0
    s_add_u32 s55, s51, 98304
    buffer_load_dwordx4 v1, s[8:11], s55 offen lds
    buffer_load_dwordx4 v1, s[8:11], s55 offen offset:1024 lds
    buffer_load_dwordx4 v1, s[8:11], s55 offen offset:2048 lds
    buffer_load_dwordx4 v1, s[8:11], s55 offen offset:3072 lds
    v_cvt_pk_bf16_f32 v64, v64, v65
    v_cvt_pk_bf16_f32 v65, v66, v67
    v_lshlrev_b32 v16, 3, v0
    s_lshl_b32 s55, s46, 9
    v_add_u32 v17, s55, v16
    v_add_u32 v17, 0x20000, v17
    v_add_u32 v16, 0x20000, v16
    ds_write_b64 v17, v[64:65]
    s_waitcnt lgkmcnt(0)
    s_barrier
    ds_read_b64 v[40:41], v16 offset:0
    ds_read_b64 v[42:43], v16 offset:512
    ds_read_b64 v[44:45], v16 offset:1024
    ds_read_b64 v[46:47], v16 offset:1536
    s_waitcnt lgkmcnt(0)
K2_block:
    s_mov_b32 s47, s66
    s_mov_b32 s53, s61
    s_mov_b32 s59, s62
    s_lshl_b32 s48, s47, 1
    s_add_u32 s48, s48, 2
    s_add_u32 s52, s48, s53
    s_sub_u32 s52, s52, 7
    s_lshr_b32 s52, s52, 2
    s_add_u32 s49, s51, 131072
    s_add_u32 s50, s51, 81920
    s_mul_i32 s56, s59, 294912
    s_lshl_b32 s55, s44, 10
    s_add_u32 s56, s56, s55
    s_add_u32 s56, s56, 56885248
    s_lshl_b32 s54, s53, 15
    v_add_u32 v17, s54, v1
    s_add_u32 s54, s53, 1
    s_and_b32 s54, s54, 3
    s_lshl_b32 s54, s54, 15
    v_add_u32 v18, s54, v1
    s_mov_b32 s66, s45
    s_lshl_b32 s54, s66, 1
    s_sub_u32 s61, 1, s54
    s_and_b32 s61, s61, 3
    s_lshl_b32 s62, s66, 2
    s_add_u32 s62, s62, s46
    s_lshl_b32 s63, s61, 15
    s_add_u32 s63, s63, s51
    s_add_u32 s54, s61, 1
    s_and_b32 s54, s54, 3
    s_lshl_b32 s54, s54, 15
    s_add_u32 s64, s54, s51
    s_add_u32 s65, s51, 32768
    s_cmp_eq_u32 s60, 1
    s_cbranch_scc1 K2_w1a
    s_waitcnt vmcnt(20)
    s_branch K2_w1b
K2_w1a:
    s_waitcnt vmcnt(12)
K2_w1b:
    v_mfma_f32_32x32x16_bf16 v[64:79], v[40:43], v[32:35], 0
    v_mfma_f32_32x32x16_bf16 v[64:79], v[44:47], v[36:39], v[64:79]
    v_sub_f32 v13, 1.0, v12
    v_mov_b32 v6, 0
    v_mov_b32 v7, 0
    v_mov_b32 v8, 0
    v_mov_b32 v9, 0
    v_mov_b32 v160, 0
    v_mov_b32 v161, 0
    v_mov_b32 v162, 0
    v_mov_b32 v163, 0
    v_mov_b32 v164, 0
    v_mov_b32 v165, 0
    v_mov_b32 v166, 0
    v_mov_b32 v167, 0
    v_mov_b32 v168, 0
    v_mov_b32 v169, 0
    v_mov_b32 v170, 0
    v_mov_b32 v171, 0
    v_mov_b32 v172, 0
    v_mov_b32 v173, 0
    v_mov_b32 v174, 0
    v_mov_b32 v175, 0
    v_add_f32 v16, 0x358637bd, v72
    v_rcp_f32 v16, v16
    s_nop 0
    v_mul_f32 v16, v16, v12
    v_mul_f32 v64, v64, v16
    v_mul_f32 v65, v65, v16
    v_mul_f32 v66, v66, v16
    v_mul_f32 v67, v67, v16
    v_mul_f32 v68, v68, v16
    v_mul_f32 v69, v69, v16
    v_mul_f32 v70, v70, v16
    v_mul_f32 v71, v71, v16
    v_cvt_pk_bf16_f32 v64, v64, v65
    v_cvt_pk_bf16_f32 v65, v66, v67
    v_cvt_pk_bf16_f32 v66, v68, v69
    v_cvt_pk_bf16_f32 v67, v70, v71
    buffer_store_dwordx4 v[64:67], v1, s[12:15], s56 offen sc1
    s_cmp_eq_u32 s60, 1
    s_cbranch_scc1 K2_w2a
    s_waitcnt vmcnt(17)
    s_branch K2_w2b
K2_w2a:
    s_waitcnt vmcnt(9)
K2_w2b:
    s_barrier
    ds_read_b128 a[32:35], v17 offset:0
    ds_read_b128 a[36:39], v17 offset:1024
    ds_read_b128 a[40:43], v17 offset:2048
    ds_read_b128 a[44:47], v17 offset:3072
    ds_read_b128 a[48:51], v17 offset:4096
    ds_read_b128 a[52:55], v17 offset:5120
    ds_read_b128 a[56:59], v17 offset:6144
    ds_read_b128 a[60:63], v17 offset:7168
    ds_read_b128 a[64:67], v17 offset:8192
    ds_read_b128 a[68:71], v17 offset:9216
    ds_read_b128 a[72:75], v17 offset:10240
    ds_read_b128 a[76:79], v17 offset:11264
    ds_read_b128 a[80:83], v17 offset:12288
    ds_read_b128 a[84:87], v17 offset:13312
    ds_read_b128 a[88:91], v17 offset:14336
    ds_read_b128 a[92:95], v17 offset:15360
    s_waitcnt lgkmcnt(12)
    v_mfma_f32_32x32x16_bf16 v[96:111], a[32:35], a[0:3], 0
    v_mov_b32 v176, 0
    v_mov_b32 v177, 0
    v_mov_b32 v178, 0
    v_mfma_f32_32x32x16_bf16 v[96:111], a[36:39], a[4:7], v[96:111]
    v_mov_b32 v179, 0
    v_mov_b32 v180, 0
    v_mov_b32 v181, 0
    v_mfma_f32_32x32x16_bf16 v[96:111], a[40:43], a[8:11], v[96:111]
    v_mov_b32 v182, 0
    v_mov_b32 v183, 0
    v_mov_b32 v184, 0
    v_mfma_f32_32x32x16_bf16 v[96:111], a[44:47], a[12:15], v[96:111]
    v_mov_b32 v185, 0
    v_mov_b32 v186, 0
    v_mov_b32 v187, 0
    s_waitcnt lgkmcnt(8)
    v_mfma_f32_32x32x16_bf16 v[96:111], a[48:51], a[16:19], v[96:111]
    v_mov_b32 v188, 0
    v_mov_b32 v189, 0
    v_mov_b32 v190, 0
    ds_read_b128 a[32:35], v18 offset:0
    v_mfma_f32_32x32x16_bf16 v[96:111], a[52:55], a[20:23], v[96:111]
    v_mov_b32 v191, 0
    v_mov_b32 v192, 0
    v_mov_b32 v193, 0
    ds_read_b128 a[36:39], v18 offset:1024
    v_mfma_f32_32x32x16_bf16 v[96:111], a[56:59], a[24:27], v[96:111]
    v_mov_b32 v194, 0
    v_mov_b32 v195, 0
    v_mov_b32 v196, 0
    ds_read_b128 a[40:43], v18 offset:2048
    v_mfma_f32_32x32x16_bf16 v[96:111], a[60:63], a[28:31], v[96:111]
    v_mov_b32 v197, 0
    v_mov_b32 v198, 0
    v_mov_b32 v199, 0
    ds_read_b128 a[44:47], v18 offset:3072
    s_waitcnt lgkmcnt(8)
    v_mfma_f32_32x32x16_bf16 v[112:127], a[64:67], a[0:3], 0
    v_mov_b32 v200, 0
    v_mov_b32 v201, 0
    v_mov_b32 v202, 0
    ds_read_b128 a[48:51], v18 offset:4096
    v_mfma_f32_32x32x16_bf16 v[112:127], a[68:71], a[4:7], v[112:127]
    v_mov_b32 v203, 0
    v_mov_b32 v204, 0
    v_mov_b32 v205, 0
    ds_read_b128 a[52:55], v18 offset:5120
    v_mfma_f32_32x32x16_bf16 v[112:127], a[72:75], a[8:11], v[112:127]
    v_mov_b32 v206, 0
    v_mov_b32 v207, 0
    v_mov_b32 v208, 0
    ds_read_b128 a[56:59], v18 offset:6144
    v_mfma_f32_32x32x16_bf16 v[112:127], a[76:79], a[12:15], v[112:127]
    v_mov_b32 v209, 0
    v_mov_b32 v210, 0
    v_mov_b32 v211, 0
    ds_read_b128 a[60:63], v18 offset:7168
    s_waitcnt lgkmcnt(8)
    v_mfma_f32_32x32x16_bf16 v[112:127], a[80:83], a[16:19], v[112:127]
    v_mov_b32 v212, 0
    v_mov_b32 v213, 0
    v_mov_b32 v214, 0
    ds_read_b128 a[64:67], v18 offset:8192
    v_mfma_f32_32x32x16_bf16 v[112:127], a[84:87], a[20:23], v[112:127]
    v_mov_b32 v215, 0
    v_mov_b32 v216, 0
    v_mov_b32 v217, 0
    ds_read_b128 a[68:71], v18 offset:9216
    v_mfma_f32_32x32x16_bf16 v[112:127], a[88:91], a[24:27], v[112:127]
    v_mov_b32 v218, 0
    v_mov_b32 v219, 0
    v_mov_b32 v220, 0
    ds_read_b128 a[72:75], v18 offset:10240
    v_mfma_f32_32x32x16_bf16 v[112:127], a[92:95], a[28:31], v[112:127]
    v_mov_b32 v221, 0
    v_mov_b32 v222, 0
    v_mov_b32 v223, 0
    ds_read_b128 a[76:79], v18 offset:11264
    s_cmp_eq_u32 s48, 2
    s_cbranch_scc0 K2_nomask
    s_nop 7
    v_add_f32 v20, 0x0, v11
    v_min_f32 v96, v96, v20
    v_add_f32 v21, 0xf1800000, v11
    v_min_f32 v97, v97, v21
    v_add_f32 v22, 0xf2000000, v11
    v_min_f32 v98, v98, v22
    v_add_f32 v23, 0xf2400000, v11
    v_min_f32 v99, v99, v23
    v_add_f32 v20, 0xf3000000, v11
    v_min_f32 v100, v100, v20
    v_add_f32 v21, 0xf3100000, v11
    v_min_f32 v101, v101, v21
    v_add_f32 v22, 0xf3200000, v11
    v_min_f32 v102, v102, v22
    v_add_f32 v23, 0xf3300000, v11
    v_min_f32 v103, v103, v23
    v_add_f32 v20, 0xf3800000, v11
    v_min_f32 v104, v104, v20
    v_add_f32 v21, 0xf3880000, v11
    v_min_f32 v105, v105, v21
    v_add_f32 v22, 0xf3900000, v11
    v_min_f32 v106, v106, v22
    v_add_f32 v23, 0xf3980000, v11
    v_min_f32 v107, v107, v23
    v_add_f32 v20, 0xf3c00000, v11
    v_min_f32 v108, v108, v20
    v_add_f32 v21, 0xf3c80000, v11
    v_min_f32 v109, v109, v21
    v_add_f32 v22, 0xf3d00000, v11
    v_min_f32 v110, v110, v22
    v_add_f32 v23, 0xf3d80000, v11
    v_min_f32 v111, v111, v23
    v_add_f32 v20, 0xf4000000, v11
    v_min_f32 v112, v112, v20
    v_add_f32 v21, 0xf4040000, v11
    v_min_f32 v113, v113, v21
    v_add_f32 v22, 0xf4080000, v11
    v_min_f32 v114, v114, v22
    v_add_f32 v23, 0xf40c0000, v11
    v_min_f32 v115, v115, v23
    v_add_f32 v20, 0xf4200000, v11
    v_min_f32 v116, v116, v20
    v_add_f32 v21, 0xf4240000, v11
    v_min_f32 v117, v117, v21
    v_add_f32 v22, 0xf4280000, v11
    v_min_f32 v118, v118, v22
    v_add_f32 v23, 0xf42c0000, v11
    v_min_f32 v119, v119, v23
    v_add_f32 v20, 0xf4400000, v11
    v_min_f32 v120, v120, v20
    v_add_f32 v21, 0xf4440000, v11
    v_min_f32 v121, v121, v21
    v_add_f32 v22, 0xf4480000, v11
    v_min_f32 v122, v122, v22
    v_add_f32 v23, 0xf44c0000, v11
    v_min_f32 v123, v123, v23
    v_add_f32 v20, 0xf4600000, v11
    v_min_f32 v124, v124, v20
    v_add_f32 v21, 0xf4640000, v11
    v_min_f32 v125, v125, v21
    v_add_f32 v22, 0xf4680000, v11
    v_min_f32 v126, v126, v22
    v_add_f32 v23, 0xf46c0000, v11
    v_min_f32 v127, v127, v23
K2_nomask:
    s_nop 4
    v_max3_f32 v4, v96, v97, v98
    v_max3_f32 v4, v4, v99, v100
    v_max3_f32 v4, v4, v101, v102
    v_max3_f32 v4, v4, v103, v104
    v_max3_f32 v4, v4, v105, v106
    v_max3_f32 v4, v4, v107, v108
    v_max3_f32 v4, v4, v109, v110
    s_nop 3
    v_max_f32 v4, v4, v111
    v_max3_f32 v4, v4, v112, v113
    v_max3_f32 v4, v4, v114, v115
    v_max3_f32 v4, v4, v116, v117
    v_max3_f32 v4, v4, v118, v119
    v_max3_f32 v4, v4, v120, v121
    v_max3_f32 v4, v4, v122, v123
    v_max3_f32 v4, v4, v124, v125
    v_max3_f32 v4, v4, v126, v127
    v_mov_b32 v5, v4
    s_nop 1
    v_permlane32_swap_b32 v4, v5
    v_max_f32 v4, v4, v5
    v_sub_f32 v144, 0, v4
    v_sub_f32 v145, 0, v4
    v_sub_f32 v146, 0, v4
    v_sub_f32 v147, 0, v4
    v_sub_f32 v148, 0, v4
    v_sub_f32 v149, 0, v4
    v_sub_f32 v150, 0, v4
    v_sub_f32 v151, 0, v4
    v_sub_f32 v152, 0, v4
    v_sub_f32 v153, 0, v4
    v_sub_f32 v154, 0, v4
    v_sub_f32 v155, 0, v4
    v_sub_f32 v156, 0, v4
    v_sub_f32 v157, 0, v4
    v_sub_f32 v158, 0, v4
    v_sub_f32 v159, 0, v4
    v_sub_f32 v96, v96, v4
    v_sub_f32 v97, v97, v4
    v_sub_f32 v98, v98, v4
    v_sub_f32 v99, v99, v4
    v_sub_f32 v100, v100, v4
    v_sub_f32 v101, v101, v4
    v_sub_f32 v102, v102, v4
    v_sub_f32 v103, v103, v4
    v_sub_f32 v104, v104, v4
    v_sub_f32 v105, v105, v4
    v_sub_f32 v106, v106, v4
    v_sub_f32 v107, v107, v4
    v_sub_f32 v108, v108, v4
    v_sub_f32 v109, v109, v4
    v_sub_f32 v110, v110, v4
    v_sub_f32 v111, v111, v4
    v_sub_f32 v112, v112, v4
    v_sub_f32 v113, v113, v4
    v_sub_f32 v114, v114, v4
    v_sub_f32 v115, v115, v4
    v_sub_f32 v116, v116, v4
    v_sub_f32 v117, v117, v4
    v_sub_f32 v118, v118, v4
    v_sub_f32 v119, v119, v4
    v_sub_f32 v120, v120, v4
    v_sub_f32 v121, v121, v4
    v_sub_f32 v122, v122, v4
    v_sub_f32 v123, v123, v4
    v_sub_f32 v124, v124, v4
    v_sub_f32 v125, v125, v4
    v_sub_f32 v126, v126, v4
    v_sub_f32 v127, v127, v4
    s_cmp_eq_u32 s48, 2
    s_cbranch_scc1 K2_M2
    s_cmp_eq_u32 s53, 1
    s_cbranch_scc1 K2_L1
    s_branch K2_L3
.p2align 6
K2_L0:
    s_waitcnt lgkmcnt(8)
    v_mfma_f32_32x32x16_bf16 v[96:111], a[32:35], a[0:3], v[144:159]
    ds_read_b128 a[80:83], v1 offset:16384
    s_add_u32 m0, s51, 81920
    v_exp_f32 v64, v64
    v_exp_f32 v65, v65
    v_mfma_f32_32x32x16_bf16 v[96:111], a[36:39], a[4:7], v[96:111]
    ds_read_b128 a[84:87], v1 offset:17408
    v_exp_f32 v66, v66
    v_exp_f32 v67, v67
    v_cvt_pk_bf16_f32 v128, v64, v65
    v_mfma_f32_32x32x16_bf16 v[96:111], a[40:43], a[8:11], v[96:111]
    ds_read_b128 a[88:91], v1 offset:18432
    buffer_load_dwordx4 v1, s[8:11], s50 offen lds
    v_exp_f32 v68, v68
    v_cvt_pk_bf16_f32 v129, v66, v67
    v_mfma_f32_32x32x16_bf16 v[96:111], a[44:47], a[12:15], v[96:111]
    ds_read_b128 a[92:95], v1 offset:19456
    v_exp_f32 v69, v69
    v_exp_f32 v70, v70
    v_add_f32 v6, v6, v64
    s_waitcnt lgkmcnt(8)
    v_mfma_f32_32x32x16_bf16 v[96:111], a[48:51], a[16:19], v[96:111]
    ds_read_b128 a[32:35], v1 offset:45056
    v_exp_f32 v71, v71
    v_cvt_pk_bf16_f32 v130, v68, v69
    v_exp_f32 v72, v72
    v_mfma_f32_32x32x16_bf16 v[96:111], a[52:55], a[20:23], v[96:111]
    ds_read_b128 a[36:39], v1 offset:46080
    v_cvt_pk_bf16_f32 v131, v70, v71
    v_exp_f32 v73, v73
    v_exp_f32 v74, v74
    v_mfma_f32_32x32x16_bf16 v[96:111], a[56:59], a[24:27], v[96:111]
    ds_read_b128 a[40:43], v1 offset:47104
    buffer_load_dwordx4 v1, s[8:11], s50 offen offset:1024 lds
    v_exp_f32 v75, v75
    v_cvt_pk_bf16_f32 v132, v72, v73
    v_mfma_f32_32x32x16_bf16 v[96:111], a[60:63], a[28:31], v[96:111]
    ds_read_b128 a[44:47], v1 offset:48128
    v_exp_f32 v76, v76
    v_exp_f32 v77, v77
    v_cvt_pk_bf16_f32 v133, v74, v75
    s_waitcnt lgkmcnt(8)
    v_mfma_f32_32x32x16_bf16 v[112:127], a[64:67], a[0:3], v[144:159]
    ds_read_b128 a[48:51], v1 offset:20480
    v_exp_f32 v78, v78
    v_exp_f32 v79, v79
    v_cvt_pk_bf16_f32 v134, v76, v77
    v_mfma_f32_32x32x16_bf16 v[112:127], a[68:71], a[4:7], v[112:127]
    ds_read_b128 a[52:55], v1 offset:21504
    v_cvt_pk_bf16_f32 v135, v78, v79
    v_exp_f32 v80, v80
    v_exp_f32 v81, v81
    v_mfma_f32_32x32x16_bf16 v[112:127], a[72:75], a[8:11], v[112:127]
    ds_read_b128 a[56:59], v1 offset:22528
    buffer_load_dwordx4 v1, s[8:11], s50 offen offset:2048 lds
    v_exp_f32 v82, v82
    v_cvt_pk_bf16_f32 v136, v80, v81
    v_mfma_f32_32x32x16_bf16 v[112:127], a[76:79], a[12:15], v[112:127]
    ds_read_b128 a[60:63], v1 offset:23552
    v_exp_f32 v83, v83
    v_exp_f32 v84, v84
    v_add_f32 v7, v7, v65
    s_waitcnt lgkmcnt(8)
    v_mfma_f32_32x32x16_bf16 v[160:175], a[80:83], v[128:131], v[160:175]
    ds_read_b128 a[64:67], v1 offset:24576
    v_exp_f32 v85, v85
    v_exp_f32 v86, v86
    v_cvt_pk_bf16_f32 v137, v82, v83
    v_mfma_f32_32x32x16_bf16 v[176:191], a[84:87], v[128:131], v[176:191]
    ds_read_b128 a[68:71], v1 offset:25600
    v_exp_f32 v87, v87
    v_cvt_pk_bf16_f32 v138, v84, v85
    v_exp_f32 v88, v88
    v_mfma_f32_32x32x16_bf16 v[192:207], a[88:91], v[128:131], v[192:207]
    ds_read_b128 a[72:75], v1 offset:26624
    buffer_load_dwordx4 v1, s[8:11], s50 offen offset:3072 lds
    s_add_u32 s50, s50, 32768
    v_cvt_pk_bf16_f32 v139, v86, v87
    v_exp_f32 v89, v89
    v_mfma_f32_32x32x16_bf16 v[208:223], a[92:95], v[128:131], v[208:223]
    ds_read_b128 a[76:79], v1 offset:27648
    v_exp_f32 v90, v90
    v_exp_f32 v91, v91
    v_cvt_pk_bf16_f32 v140, v88, v89
    s_waitcnt lgkmcnt(8)
    v_mfma_f32_32x32x16_bf16 v[112:127], a[32:35], a[16:19], v[112:127]
    ds_read_b128 a[80:83], v1 offset:28672
    v_exp_f32 v92, v92
    v_exp_f32 v93, v93
    v_cvt_pk_bf16_f32 v141, v90, v91
    v_mfma_f32_32x32x16_bf16 v[112:127], a[36:39], a[20:23], v[112:127]
    ds_read_b128 a[84:87], v1 offset:29696
    v_exp_f32 v94, v94
    v_exp_f32 v95, v95
    v_cvt_pk_bf16_f32 v142, v92, v93
    v_mfma_f32_32x32x16_bf16 v[112:127], a[40:43], a[24:27], v[112:127]
    ds_read_b128 a[88:91], v1 offset:30720
    v_cvt_pk_bf16_f32 v143, v94, v95
    v_add_f32 v8, v8, v66
    v_add_f32 v9, v9, v67
    v_add_f32 v6, v6, v68
    v_add_f32 v7, v7, v69
    v_mfma_f32_32x32x16_bf16 v[112:127], a[44:47], a[28:31], v[112:127]
    s_waitcnt vmcnt(8)
    s_barrier
    ds_read_b128 a[92:95], v1 offset:31744
    v_add_f32 v8, v8, v70
    v_add_f32 v9, v9, v71
    v_add_f32 v6, v6, v72
    s_waitcnt lgkmcnt(8)
    v_mfma_f32_32x32x16_bf16 v[160:175], a[48:51], v[132:135], v[160:175]
    s_add_u32 m0, s51, 0
    ds_read_b128 a[32:35], v2 offset:0
    v_add_f32 v7, v7, v73
    v_add_f32 v8, v8, v74
    v_add_f32 v9, v9, v75
    v_add_f32 v6, v6, v76
    v_mfma_f32_32x32x16_bf16 v[176:191], a[52:55], v[132:135], v[176:191]
    buffer_load_dwordx4 v1, s[8:11], s49 offen lds
    ds_read_b128 a[36:39], v2 offset:1024
    v_add_f32 v7, v7, v77
    v_add_f32 v8, v8, v78
    v_add_f32 v9, v9, v79
    v_mfma_f32_32x32x16_bf16 v[192:207], a[56:59], v[132:135], v[192:207]
    ds_read_b128 a[40:43], v2 offset:2048
    v_add_f32 v6, v6, v80
    v_add_f32 v7, v7, v81
    v_add_f32 v8, v8, v82
    v_add_f32 v9, v9, v83
    v_add_f32 v6, v6, v84
    v_mfma_f32_32x32x16_bf16 v[208:223], a[60:63], v[132:135], v[208:223]
    buffer_load_dwordx4 v1, s[8:11], s49 offen offset:1024 lds
    ds_read_b128 a[44:47], v2 offset:3072
    v_add_f32 v7, v7, v85
    v_add_f32 v8, v8, v86
    v_add_f32 v9, v9, v87
    s_waitcnt lgkmcnt(8)
    v_mfma_f32_32x32x16_bf16 v[160:175], a[64:67], v[136:139], v[160:175]
    ds_read_b128 a[48:51], v2 offset:4096
    v_add_f32 v6, v6, v88
    v_add_f32 v7, v7, v89
    v_add_f32 v8, v8, v90
    v_add_f32 v9, v9, v91
    v_add_f32 v6, v6, v92
    v_mfma_f32_32x32x16_bf16 v[176:191], a[68:71], v[136:139], v[176:191]
    buffer_load_dwordx4 v1, s[8:11], s49 offen offset:2048 lds
    ds_read_b128 a[52:55], v2 offset:5120
    v_add_f32 v7, v7, v93
    v_add_f32 v8, v8, v94
    v_add_f32 v9, v9, v95
    v_mfma_f32_32x32x16_bf16 v[192:207], a[72:75], v[136:139], v[192:207]
    ds_read_b128 a[56:59], v2 offset:6144
    v_max3_f32 v4, v96, v97, v98
    v_max3_f32 v4, v4, v99, v100
    v_max3_f32 v4, v4, v101, v102
    v_max_f32 v4, v4, v103
    v_max3_f32 v5, v104, v105, v106
    v_mfma_f32_32x32x16_bf16 v[208:223], a[76:79], v[136:139], v[208:223]
    buffer_load_dwordx4 v1, s[8:11], s49 offen offset:3072 lds
    s_add_u32 s49, s49, 32768
    ds_read_b128 a[60:63], v2 offset:7168
    v_max3_f32 v5, v5, v107, v108
    v_max3_f32 v5, v5, v109, v110
    v_max_f32 v5, v5, v111
    s_waitcnt lgkmcnt(8)
    v_mfma_f32_32x32x16_bf16 v[160:175], a[80:83], v[140:143], v[160:175]
    ds_read_b128 a[64:67], v2 offset:8192
    v_max3_f32 v4, v4, v112, v113
    v_max3_f32 v4, v4, v114, v115
    v_max3_f32 v4, v4, v116, v117
    v_max3_f32 v4, v4, v118, v119
    v_max3_f32 v5, v5, v120, v121
    v_mfma_f32_32x32x16_bf16 v[176:191], a[84:87], v[140:143], v[176:191]
    ds_read_b128 a[68:71], v2 offset:9216
    v_max3_f32 v5, v5, v122, v123
    v_max3_f32 v5, v5, v124, v125
    v_max3_f32 v5, v5, v126, v127
    v_max_f32 v4, v4, v5
    v_cmp_lt_f32 vcc, s58, v4
    v_mfma_f32_32x32x16_bf16 v[192:207], a[88:91], v[140:143], v[192:207]
    ds_read_b128 a[72:75], v2 offset:10240
    v_mfma_f32_32x32x16_bf16 v[208:223], a[92:95], v[140:143], v[208:223]
    ds_read_b128 a[76:79], v2 offset:11264
    s_cbranch_vccnz K2_resc_L0
K2_ret_L0:
K2_L1:
    s_waitcnt lgkmcnt(8)
    v_mfma_f32_32x32x16_bf16 v[64:79], a[32:35], a[0:3], v[144:159]
    ds_read_b128 a[80:83], v1 offset:49152
    s_add_u32 m0, s51, 114688
    v_exp_f32 v96, v96
    v_exp_f32 v97, v97
    v_mfma_f32_32x32x16_bf16 v[64:79], a[36:39], a[4:7], v[64:79]
    ds_read_b128 a[84:87], v1 offset:50176
    v_exp_f32 v98, v98
    v_exp_f32 v99, v99
    v_cvt_pk_bf16_f32 v128, v96, v97
    v_mfma_f32_32x32x16_bf16 v[64:79], a[40:43], a[8:11], v[64:79]
    ds_read_b128 a[88:91], v1 offset:51200
    buffer_load_dwordx4 v1, s[8:11], s50 offen lds
    v_exp_f32 v100, v100
    v_cvt_pk_bf16_f32 v129, v98, v99
    v_mfma_f32_32x32x16_bf16 v[64:79], a[44:47], a[12:15], v[64:79]
    ds_read_b128 a[92:95], v1 offset:52224
    v_exp_f32 v101, v101
    v_exp_f32 v102, v102
    v_add_f32 v6, v6, v96
    s_waitcnt lgkmcnt(8)
    v_mfma_f32_32x32x16_bf16 v[64:79], a[48:51], a[16:19], v[64:79]
    ds_read_b128 a[32:35], v2 offset:12288
    v_exp_f32 v103, v103
    v_cvt_pk_bf16_f32 v130, v100, v101
    v_exp_f32 v104, v104
    v_mfma_f32_32x32x16_bf16 v[64:79], a[52:55], a[20:23], v[64:79]
    ds_read_b128 a[36:39], v2 offset:13312
    v_cvt_pk_bf16_f32 v131, v102, v103
    v_exp_f32 v105, v105
    v_exp_f32 v106, v106
    v_mfma_f32_32x32x16_bf16 v[64:79], a[56:59], a[24:27], v[64:79]
    ds_read_b128 a[40:43], v2 offset:14336
    buffer_load_dwordx4 v1, s[8:11], s50 offen offset:1024 lds
    v_exp_f32 v107, v107
    v_cvt_pk_bf16_f32 v132, v104, v105
    v_mfma_f32_32x32x16_bf16 v[64:79], a[60:63], a[28:31], v[64:79]
    ds_read_b128 a[44:47], v2 offset:15360
    v_exp_f32 v108, v108
    v_exp_f32 v109, v109
    v_cvt_pk_bf16_f32 v133, v106, v107
    s_waitcnt lgkmcnt(8)
    v_mfma_f32_32x32x16_bf16 v[80:95], a[64:67], a[0:3], v[144:159]
    ds_read_b128 a[48:51], v1 offset:53248
    v_exp_f32 v110, v110
    v_exp_f32 v111, v111
    v_cvt_pk_bf16_f32 v134, v108, v109
    v_mfma_f32_32x32x16_bf16 v[80:95], a[68:71], a[4:7], v[80:95]
    ds_read_b128 a[52:55], v1 offset:54272
    v_cvt_pk_bf16_f32 v135, v110, v111
    v_exp_f32 v112, v112
    v_exp_f32 v113, v113
    v_mfma_f32_32x32x16_bf16 v[80:95], a[72:75], a[8:11], v[80:95]
    ds_read_b128 a[56:59], v1 offset:55296
    buffer_load_dwordx4 v1, s[8:11], s50 offen offset:2048 lds
    v_exp_f32 v114, v114
    v_cvt_pk_bf16_f32 v136, v112, v113
    v_mfma_f32_32x32x16_bf16 v[80:95], a[76:79], a[12:15], v[80:95]
    ds_read_b128 a[60:63], v1 offset:56320
    v_exp_f32 v115, v115
    v_exp_f32 v116, v116
    v_add_f32 v7, v7, v97
    s_waitcnt lgkmcnt(8)
    v_mfma_f32_32x32x16_bf16 v[160:175], a[80:83], v[128:131], v[160:175]
    ds_read_b128 a[64:67], v1 offset:57344
    v_exp_f32 v117, v117
    v_exp_f32 v118, v118
    v_cvt_pk_bf16_f32 v137, v114, v115
    v_mfma_f32_32x32x16_bf16 v[176:191], a[84:87], v[128:131], v[176:191]
    ds_read_b128 a[68:71], v1 offset:58368
    v_exp_f32 v119, v119
    v_cvt_pk_bf16_f32 v138, v116, v117
    v_exp_f32 v120, v120
    v_mfma_f32_32x32x16_bf16 v[192:207], a[88:91], v[128:131], v[192:207]
    ds_read_b128 a[72:75], v1 offset:59392
    buffer_load_dwordx4 v1, s[8:11], s50 offen offset:3072 lds
    s_add_u32 s50, s50, 32768
    v_cvt_pk_bf16_f32 v139, v118, v119
    v_exp_f32 v121, v121
    v_mfma_f32_32x32x16_bf16 v[208:223], a[92:95], v[128:131], v[208:223]
    ds_read_b128 a[76:79], v1 offset:60416
    v_exp_f32 v122, v122
    v_exp_f32 v123, v123
    v_cvt_pk_bf16_f32 v140, v120, v121
    s_waitcnt lgkmcnt(8)
    v_mfma_f32_32x32x16_bf16 v[80:95], a[32:35], a[16:19], v[80:95]
    ds_read_b128 a[80:83], v1 offset:61440
    v_exp_f32 v124, v124
    v_exp_f32 v125, v125
    v_cvt_pk_bf16_f32 v141, v122, v123
    v_mfma_f32_32x32x16_bf16 v[80:95], a[36:39], a[20:23], v[80:95]
    ds_read_b128 a[84:87], v1 offset:62464
    v_exp_f32 v126, v126
    v_exp_f32 v127, v127
    v_cvt_pk_bf16_f32 v142, v124, v125
    v_mfma_f32_32x32x16_bf16 v[80:95], a[40:43], a[24:27], v[80:95]
    ds_read_b128 a[88:91], v1 offset:63488
    v_cvt_pk_bf16_f32 v143, v126, v127
    v_add_f32 v8, v8, v98
    v_add_f32 v9, v9, v99
    v_add_f32 v6, v6, v100
    v_add_f32 v7, v7, v101
    v_mfma_f32_32x32x16_bf16 v[80:95], a[44:47], a[28:31], v[80:95]
    s_waitcnt vmcnt(8)
    s_barrier
    ds_read_b128 a[92:95], v1 offset:64512
    v_add_f32 v8, v8, v102
    v_add_f32 v9, v9, v103
    v_add_f32 v6, v6, v104
    s_waitcnt lgkmcnt(8)
    v_mfma_f32_32x32x16_bf16 v[160:175], a[48:51], v[132:135], v[160:175]
    s_add_u32 m0, s51, 32768
    ds_read_b128 a[32:35], v2 offset:32768
    v_add_f32 v7, v7, v105
    v_add_f32 v8, v8, v106
    v_add_f32 v9, v9, v107
    v_add_f32 v6, v6, v108
    v_mfma_f32_32x32x16_bf16 v[176:191], a[52:55], v[132:135], v[176:191]
    buffer_load_dwordx4 v1, s[8:11], s49 offen lds
    ds_read_b128 a[36:39], v2 offset:33792
    v_add_f32 v7, v7, v109
    v_add_f32 v8, v8, v110
    v_add_f32 v9, v9, v111
    v_mfma_f32_32x32x16_bf16 v[192:207], a[56:59], v[132:135], v[192:207]
    ds_read_b128 a[40:43], v2 offset:34816
    v_add_f32 v6, v6, v112
    v_add_f32 v7, v7, v113
    v_add_f32 v8, v8, v114
    v_add_f32 v9, v9, v115
    v_add_f32 v6, v6, v116
    v_mfma_f32_32x32x16_bf16 v[208:223], a[60:63], v[132:135], v[208:223]
    buffer_load_dwordx4 v1, s[8:11], s49 offen offset:1024 lds
    ds_read_b128 a[44:47], v2 offset:35840
    v_add_f32 v7, v7, v117
    v_add_f32 v8, v8, v118
    v_add_f32 v9, v9, v119
    s_waitcnt lgkmcnt(8)
    v_mfma_f32_32x32x16_bf16 v[160:175], a[64:67], v[136:139], v[160:175]
    ds_read_b128 a[48:51], v2 offset:36864
    v_add_f32 v6, v6, v120
    v_add_f32 v7, v7, v121
    v_add_f32 v8, v8, v122
    v_add_f32 v9, v9, v123
    v_add_f32 v6, v6, v124
    v_mfma_f32_32x32x16_bf16 v[176:191], a[68:71], v[136:139], v[176:191]
    buffer_load_dwordx4 v1, s[8:11], s49 offen offset:2048 lds
    ds_read_b128 a[52:55], v2 offset:37888
    v_add_f32 v7, v7, v125
    v_add_f32 v8, v8, v126
    v_add_f32 v9, v9, v127
    v_mfma_f32_32x32x16_bf16 v[192:207], a[72:75], v[136:139], v[192:207]
    ds_read_b128 a[56:59], v2 offset:38912
    v_max3_f32 v4, v64, v65, v66
    v_max3_f32 v4, v4, v67, v68
    v_max3_f32 v4, v4, v69, v70
    v_max_f32 v4, v4, v71
    v_max3_f32 v5, v72, v73, v74
    v_mfma_f32_32x32x16_bf16 v[208:223], a[76:79], v[136:139], v[208:223]
    buffer_load_dwordx4 v1, s[8:11], s49 offen offset:3072 lds
    s_add_u32 s49, s49, 32768
    ds_read_b128 a[60:63], v2 offset:39936
    v_max3_f32 v5, v5, v75, v76
    v_max3_f32 v5, v5, v77, v78
    v_max_f32 v5, v5, v79
    s_waitcnt lgkmcnt(8)
    v_mfma_f32_32x32x16_bf16 v[160:175], a[80:83], v[140:143], v[160:175]
    ds_read_b128 a[64:67], v2 offset:40960
    v_max3_f32 v4, v4, v80, v81
    v_max3_f32 v4, v4, v82, v83
    v_max3_f32 v4, v4, v84, v85
    v_max3_f32 v4, v4, v86, v87
    v_max3_f32 v5, v5, v88, v89
    v_mfma_f32_32x32x16_bf16 v[176:191], a[84:87], v[140:143], v[176:191]
    ds_read_b128 a[68:71], v2 offset:41984
    v_max3_f32 v5, v5, v90, v91
    v_max3_f32 v5, v5, v92, v93
    v_max3_f32 v5, v5, v94, v95
    v_max_f32 v4, v4, v5
    v_cmp_lt_f32 vcc, s58, v4
    v_mfma_f32_32x32x16_bf16 v[192:207], a[88:91], v[140:143], v[192:207]
    ds_read_b128 a[72:75], v2 offset:43008
    v_mfma_f32_32x32x16_bf16 v[208:223], a[92:95], v[140:143], v[208:223]
    ds_read_b128 a[76:79], v2 offset:44032
    s_cbranch_vccnz K2_resc_L1
K2_ret_L1:
K2_L2:
    s_waitcnt lgkmcnt(8)
    v_mfma_f32_32x32x16_bf16 v[96:111], a[32:35], a[0:3], v[144:159]
    ds_read_b128 a[80:83], v2 offset:16384
    s_add_u32 m0, s51, 16384
    v_exp_f32 v64, v64
    v_exp_f32 v65, v65
    v_mfma_f32_32x32x16_bf16 v[96:111], a[36:39], a[4:7], v[96:111]
    ds_read_b128 a[84:87], v2 offset:17408
    v_exp_f32 v66, v66
    v_exp_f32 v67, v67
    v_cvt_pk_bf16_f32 v128, v64, v65
    v_mfma_f32_32x32x16_bf16 v[96:111], a[40:43], a[8:11], v[96:111]
    ds_read_b128 a[88:91], v2 offset:18432
    buffer_load_dwordx4 v1, s[8:11], s50 offen lds
    v_exp_f32 v68, v68
    v_cvt_pk_bf16_f32 v129, v66, v67
    v_mfma_f32_32x32x16_bf16 v[96:111], a[44:47], a[12:15], v[96:111]
    ds_read_b128 a[92:95], v2 offset:19456
    v_exp_f32 v69, v69
    v_exp_f32 v70, v70
    v_add_f32 v6, v6, v64
    s_waitcnt lgkmcnt(8)
    v_mfma_f32_32x32x16_bf16 v[96:111], a[48:51], a[16:19], v[96:111]
    ds_read_b128 a[32:35], v2 offset:45056
    v_exp_f32 v71, v71
    v_cvt_pk_bf16_f32 v130, v68, v69
    v_exp_f32 v72, v72
    v_mfma_f32_32x32x16_bf16 v[96:111], a[52:55], a[20:23], v[96:111]
    ds_read_b128 a[36:39], v2 offset:46080
    v_cvt_pk_bf16_f32 v131, v70, v71
    v_exp_f32 v73, v73
    v_exp_f32 v74, v74
    v_mfma_f32_32x32x16_bf16 v[96:111], a[56:59], a[24:27], v[96:111]
    ds_read_b128 a[40:43], v2 offset:47104
    buffer_load_dwordx4 v1, s[8:11], s50 offen offset:1024 lds
    v_exp_f32 v75, v75
    v_cvt_pk_bf16_f32 v132, v72, v73
    v_mfma_f32_32x32x16_bf16 v[96:111], a[60:63], a[28:31], v[96:111]
    ds_read_b128 a[44:47], v2 offset:48128
    v_exp_f32 v76, v76
    v_exp_f32 v77, v77
    v_cvt_pk_bf16_f32 v133, v74, v75
    s_waitcnt lgkmcnt(8)
    v_mfma_f32_32x32x16_bf16 v[112:127], a[64:67], a[0:3], v[144:159]
    ds_read_b128 a[48:51], v2 offset:20480
    v_exp_f32 v78, v78
    v_exp_f32 v79, v79
    v_cvt_pk_bf16_f32 v134, v76, v77
    v_mfma_f32_32x32x16_bf16 v[112:127], a[68:71], a[4:7], v[112:127]
    ds_read_b128 a[52:55], v2 offset:21504
    v_cvt_pk_bf16_f32 v135, v78, v79
    v_exp_f32 v80, v80
    v_exp_f32 v81, v81
    v_mfma_f32_32x32x16_bf16 v[112:127], a[72:75], a[8:11], v[112:127]
    ds_read_b128 a[56:59], v2 offset:22528
    buffer_load_dwordx4 v1, s[8:11], s50 offen offset:2048 lds
    v_exp_f32 v82, v82
    v_cvt_pk_bf16_f32 v136, v80, v81
    v_mfma_f32_32x32x16_bf16 v[112:127], a[76:79], a[12:15], v[112:127]
    ds_read_b128 a[60:63], v2 offset:23552
    v_exp_f32 v83, v83
    v_exp_f32 v84, v84
    v_add_f32 v7, v7, v65
    s_waitcnt lgkmcnt(8)
    v_mfma_f32_32x32x16_bf16 v[160:175], a[80:83], v[128:131], v[160:175]
    ds_read_b128 a[64:67], v2 offset:24576
    v_exp_f32 v85, v85
    v_exp_f32 v86, v86
    v_cvt_pk_bf16_f32 v137, v82, v83
    v_mfma_f32_32x32x16_bf16 v[176:191], a[84:87], v[128:131], v[176:191]
    ds_read_b128 a[68:71], v2 offset:25600
    v_exp_f32 v87, v87
    v_cvt_pk_bf16_f32 v138, v84, v85
    v_exp_f32 v88, v88
    v_mfma_f32_32x32x16_bf16 v[192:207], a[88:91], v[128:131], v[192:207]
    ds_read_b128 a[72:75], v2 offset:26624
    buffer_load_dwordx4 v1, s[8:11], s50 offen offset:3072 lds
    s_add_u32 s50, s50, 32768
    v_cvt_pk_bf16_f32 v139, v86, v87
    v_exp_f32 v89, v89
    v_mfma_f32_32x32x16_bf16 v[208:223], a[92:95], v[128:131], v[208:223]
    ds_read_b128 a[76:79], v2 offset:27648
    v_exp_f32 v90, v90
    v_exp_f32 v91, v91
    v_cvt_pk_bf16_f32 v140, v88, v89
    s_waitcnt lgkmcnt(8)
    v_mfma_f32_32x32x16_bf16 v[112:127], a[32:35], a[16:19], v[112:127]
    ds_read_b128 a[80:83], v2 offset:28672
    v_exp_f32 v92, v92
    v_exp_f32 v93, v93
    v_cvt_pk_bf16_f32 v141, v90, v91
    v_mfma_f32_32x32x16_bf16 v[112:127], a[36:39], a[20:23], v[112:127]
    ds_read_b128 a[84:87], v2 offset:29696
    v_exp_f32 v94, v94
    v_exp_f32 v95, v95
    v_cvt_pk_bf16_f32 v142, v92, v93
    v_mfma_f32_32x32x16_bf16 v[112:127], a[40:43], a[24:27], v[112:127]
    ds_read_b128 a[88:91], v2 offset:30720
    v_cvt_pk_bf16_f32 v143, v94, v95
    v_add_f32 v8, v8, v66
    v_add_f32 v9, v9, v67
    v_add_f32 v6, v6, v68
    v_add_f32 v7, v7, v69
    v_mfma_f32_32x32x16_bf16 v[112:127], a[44:47], a[28:31], v[112:127]
    s_waitcnt vmcnt(8)
    s_barrier
    ds_read_b128 a[92:95], v2 offset:31744
    v_add_f32 v8, v8, v70
    v_add_f32 v9, v9, v71
    v_add_f32 v6, v6, v72
    s_waitcnt lgkmcnt(8)
    v_mfma_f32_32x32x16_bf16 v[160:175], a[48:51], v[132:135], v[160:175]
    s_add_u32 m0, s51, 65536
    ds_read_b128 a[32:35], v1 offset:0
    v_add_f32 v7, v7, v73
    v_add_f32 v8, v8, v74
    v_add_f32 v9, v9, v75
    v_add_f32 v6, v6, v76
    v_mfma_f32_32x32x16_bf16 v[176:191], a[52:55], v[132:135], v[176:191]
    buffer_load_dwordx4 v1, s[8:11], s49 offen lds
    ds_read_b128 a[36:39], v1 offset:1024
    v_add_f32 v7, v7, v77
    v_add_f32 v8, v8, v78
    v_add_f32 v9, v9, v79
    v_mfma_f32_32x32x16_bf16 v[192:207], a[56:59], v[132:135], v[192:207]
    ds_read_b128 a[40:43], v1 offset:2048
    v_add_f32 v6, v6, v80
    v_add_f32 v7, v7, v81
    v_add_f32 v8, v8, v82
    v_add_f32 v9, v9, v83
    v_add_f32 v6, v6, v84
    v_mfma_f32_32x32x16_bf16 v[208:223], a[60:63], v[132:135], v[208:223]
    buffer_load_dwordx4 v1, s[8:11], s49 offen offset:1024 lds
    ds_read_b128 a[44:47], v1 offset:3072
    v_add_f32 v7, v7, v85
    v_add_f32 v8, v8, v86
    v_add_f32 v9, v9, v87
    s_waitcnt lgkmcnt(8)
    v_mfma_f32_32x32x16_bf16 v[160:175], a[64:67], v[136:139], v[160:175]
    ds_read_b128 a[48:51], v1 offset:4096
    v_add_f32 v6, v6, v88
    v_add_f32 v7, v7, v89
    v_add_f32 v8, v8, v90
    v_add_f32 v9, v9, v91
    v_add_f32 v6, v6, v92
    v_mfma_f32_32x32x16_bf16 v[176:191], a[68:71], v[136:139], v[176:191]
    buffer_load_dwordx4 v1, s[8:11], s49 offen offset:2048 lds
    ds_read_b128 a[52:55], v1 offset:5120
    v_add_f32 v7, v7, v93
    v_add_f32 v8, v8, v94
    v_add_f32 v9, v9, v95
    v_mfma_f32_32x32x16_bf16 v[192:207], a[72:75], v[136:139], v[192:207]
    ds_read_b128 a[56:59], v1 offset:6144
    v_max3_f32 v4, v96, v97, v98
    v_max3_f32 v4, v4, v99, v100
    v_max3_f32 v4, v4, v101, v102
    v_max_f32 v4, v4, v103
    v_max3_f32 v5, v104, v105, v106
    v_mfma_f32_32x32x16_bf16 v[208:223], a[76:79], v[136:139], v[208:223]
    buffer_load_dwordx4 v1, s[8:11], s49 offen offset:3072 lds
    s_add_u32 s49, s49, 32768
    ds_read_b128 a[60:63], v1 offset:7168
    v_max3_f32 v5, v5, v107, v108
    v_max3_f32 v5, v5, v109, v110
    v_max_f32 v5, v5, v111
    s_waitcnt lgkmcnt(8)
    v_mfma_f32_32x32x16_bf16 v[160:175], a[80:83], v[140:143], v[160:175]
    ds_read_b128 a[64:67], v1 offset:8192
    v_max3_f32 v4, v4, v112, v113
    v_max3_f32 v4, v4, v114, v115
    v_max3_f32 v4, v4, v116, v117
    v_max3_f32 v4, v4, v118, v119
    v_max3_f32 v5, v5, v120, v121
    v_mfma_f32_32x32x16_bf16 v[176:191], a[84:87], v[140:143], v[176:191]
    ds_read_b128 a[68:71], v1 offset:9216
    v_max3_f32 v5, v5, v122, v123
    v_max3_f32 v5, v5, v124, v125
    v_max3_f32 v5, v5, v126, v127
    v_max_f32 v4, v4, v5
    v_cmp_lt_f32 vcc, s58, v4
    v_mfma_f32_32x32x16_bf16 v[192:207], a[88:91], v[140:143], v[192:207]
    ds_read_b128 a[72:75], v1 offset:10240
    v_mfma_f32_32x32x16_bf16 v[208:223], a[92:95], v[140:143], v[208:223]
    ds_read_b128 a[76:79], v1 offset:11264
    s_cbranch_vccnz K2_resc_L2
K2_ret_L2:
K2_L3:
    s_waitcnt lgkmcnt(8)
    v_mfma_f32_32x32x16_bf16 v[64:79], a[32:35], a[0:3], v[144:159]
    ds_read_b128 a[80:83], v2 offset:49152
    s_add_u32 m0, s51, 49152
    v_exp_f32 v96, v96
    v_exp_f32 v97, v97
    v_mfma_f32_32x32x16_bf16 v[64:79], a[36:39], a[4:7], v[64:79]
    ds_read_b128 a[84:87], v2 offset:50176
    v_exp_f32 v98, v98
    v_exp_f32 v99, v99
    v_cvt_pk_bf16_f32 v128, v96, v97
    v_mfma_f32_32x32x16_bf16 v[64:79], a[40:43], a[8:11], v[64:79]
    ds_read_b128 a[88:91], v2 offset:51200
    buffer_load_dwordx4 v1, s[8:11], s50 offen lds
    v_exp_f32 v100, v100
    v_cvt_pk_bf16_f32 v129, v98, v99
    v_mfma_f32_32x32x16_bf16 v[64:79], a[44:47], a[12:15], v[64:79]
    ds_read_b128 a[92:95], v2 offset:52224
    v_exp_f32 v101, v101
    v_exp_f32 v102, v102
    v_add_f32 v6, v6, v96
    s_waitcnt lgkmcnt(8)
    v_mfma_f32_32x32x16_bf16 v[64:79], a[48:51], a[16:19], v[64:79]
    ds_read_b128 a[32:35], v1 offset:12288
    v_exp_f32 v103, v103
    v_cvt_pk_bf16_f32 v130, v100, v101
    v_exp_f32 v104, v104
    v_mfma_f32_32x32x16_bf16 v[64:79], a[52:55], a[20:23], v[64:79]
    ds_read_b128 a[36:39], v1 offset:13312
    v_cvt_pk_bf16_f32 v131, v102, v103
    v_exp_f32 v105, v105
    v_exp_f32 v106, v106
    v_mfma_f32_32x32x16_bf16 v[64:79], a[56:59], a[24:27], v[64:79]
    ds_read_b128 a[40:43], v1 offset:14336
    buffer_load_dwordx4 v1, s[8:11], s50 offen offset:1024 lds
    v_exp_f32 v107, v107
    v_cvt_pk_bf16_f32 v132, v104, v105
    v_mfma_f32_32x32x16_bf16 v[64:79], a[60:63], a[28:31], v[64:79]
    ds_read_b128 a[44:47], v1 offset:15360
    v_exp_f32 v108, v108
    v_exp_f32 v109, v109
    v_cvt_pk_bf16_f32 v133, v106, v107
    s_waitcnt lgkmcnt(8)
    v_mfma_f32_32x32x16_bf16 v[80:95], a[64:67], a[0:3], v[144:159]
    ds_read_b128 a[48:51], v2 offset:53248
    v_exp_f32 v110, v110
    v_exp_f32 v111, v111
    v_cvt_pk_bf16_f32 v134, v108, v109
    v_mfma_f32_32x32x16_bf16 v[80:95], a[68:71], a[4:7], v[80:95]
    ds_read_b128 a[52:55], v2 offset:54272
    v_cvt_pk_bf16_f32 v135, v110, v111
    v_exp_f32 v112, v112
    v_exp_f32 v113, v113
    v_mfma_f32_32x32x16_bf16 v[80:95], a[72:75], a[8:11], v[80:95]
    ds_read_b128 a[56:59], v2 offset:55296
    buffer_load_dwordx4 v1, s[8:11], s50 offen offset:2048 lds
    v_exp_f32 v114, v114
    v_cvt_pk_bf16_f32 v136, v112, v113
    v_mfma_f32_32x32x16_bf16 v[80:95], a[76:79], a[12:15], v[80:95]
    ds_read_b128 a[60:63], v2 offset:56320
    v_exp_f32 v115, v115
    v_exp_f32 v116, v116
    v_add_f32 v7, v7, v97
    s_waitcnt lgkmcnt(8)
    v_mfma_f32_32x32x16_bf16 v[160:175], a[80:83], v[128:131], v[160:175]
    ds_read_b128 a[64:67], v2 offset:57344
    v_exp_f32 v117, v117
    v_exp_f32 v118, v118
    v_cvt_pk_bf16_f32 v137, v114, v115
    v_mfma_f32_32x32x16_bf16 v[176:191], a[84:87], v[128:131], v[176:191]
    ds_read_b128 a[68:71], v2 offset:58368
    v_exp_f32 v119, v119
    v_cvt_pk_bf16_f32 v138, v116, v117
    v_exp_f32 v120, v120
    v_mfma_f32_32x32x16_bf16 v[192:207], a[88:91], v[128:131], v[192:207]
    ds_read_b128 a[72:75], v2 offset:59392
    buffer_load_dwordx4 v1, s[8:11], s50 offen offset:3072 lds
    s_add_u32 s50, s50, 32768
    v_cvt_pk_bf16_f32 v139, v118, v119
    v_exp_f32 v121, v121
    v_mfma_f32_32x32x16_bf16 v[208:223], a[92:95], v[128:131], v[208:223]
    ds_read_b128 a[76:79], v2 offset:60416
    v_exp_f32 v122, v122
    v_exp_f32 v123, v123
    v_cvt_pk_bf16_f32 v140, v120, v121
    s_waitcnt lgkmcnt(8)
    v_mfma_f32_32x32x16_bf16 v[80:95], a[32:35], a[16:19], v[80:95]
    ds_read_b128 a[80:83], v2 offset:61440
    v_exp_f32 v124, v124
    v_exp_f32 v125, v125
    v_cvt_pk_bf16_f32 v141, v122, v123
    v_mfma_f32_32x32x16_bf16 v[80:95], a[36:39], a[20:23], v[80:95]
    ds_read_b128 a[84:87], v2 offset:62464
    v_exp_f32 v126, v126
    v_exp_f32 v127, v127
    v_cvt_pk_bf16_f32 v142, v124, v125
    v_mfma_f32_32x32x16_bf16 v[80:95], a[40:43], a[24:27], v[80:95]
    ds_read_b128 a[88:91], v2 offset:63488
    v_cvt_pk_bf16_f32 v143, v126, v127
    v_add_f32 v8, v8, v98
    v_add_f32 v9, v9, v99
    v_add_f32 v6, v6, v100
    v_add_f32 v7, v7, v101
    v_mfma_f32_32x32x16_bf16 v[80:95], a[44:47], a[28:31], v[80:95]
    s_waitcnt vmcnt(8)
    s_barrier
    ds_read_b128 a[92:95], v2 offset:64512
    v_add_f32 v8, v8, v102
    v_add_f32 v9, v9, v103
    v_add_f32 v6, v6, v104
    s_waitcnt lgkmcnt(8)
    v_mfma_f32_32x32x16_bf16 v[160:175], a[48:51], v[132:135], v[160:175]
    s_add_u32 m0, s51, 98304
    ds_read_b128 a[32:35], v1 offset:32768
    v_add_f32 v7, v7, v105
    v_add_f32 v8, v8, v106
    v_add_f32 v9, v9, v107
    v_add_f32 v6, v6, v108
    v_mfma_f32_32x32x16_bf16 v[176:191], a[52:55], v[132:135], v[176:191]
    buffer_load_dwordx4 v1, s[8:11], s49 offen lds
    ds_read_b128 a[36:39], v1 offset:33792
    v_add_f32 v7, v7, v109
    v_add_f32 v8, v8, v110
    v_add_f32 v9, v9, v111
    v_mfma_f32_32x32x16_bf16 v[192:207], a[56:59], v[132:135], v[192:207]
    ds_read_b128 a[40:43], v1 offset:34816
    v_add_f32 v6, v6, v112
    v_add_f32 v7, v7, v113
    v_add_f32 v8, v8, v114
    v_add_f32 v9, v9, v115
    v_add_f32 v6, v6, v116
    v_mfma_f32_32x32x16_bf16 v[208:223], a[60:63], v[132:135], v[208:223]
    buffer_load_dwordx4 v1, s[8:11], s49 offen offset:1024 lds
    ds_read_b128 a[44:47], v1 offset:35840
    v_add_f32 v7, v7, v117
    v_add_f32 v8, v8, v118
    v_add_f32 v9, v9, v119
    s_waitcnt lgkmcnt(8)
    v_mfma_f32_32x32x16_bf16 v[160:175], a[64:67], v[136:139], v[160:175]
    ds_read_b128 a[48:51], v1 offset:36864
    v_add_f32 v6, v6, v120
    v_add_f32 v7, v7, v121
    v_add_f32 v8, v8, v122
    v_add_f32 v9, v9, v123
    v_add_f32 v6, v6, v124
    v_mfma_f32_32x32x16_bf16 v[176:191], a[68:71], v[136:139], v[176:191]
    buffer_load_dwordx4 v1, s[8:11], s49 offen offset:2048 lds
    ds_read_b128 a[52:55], v1 offset:37888
    v_add_f32 v7, v7, v125
    v_add_f32 v8, v8, v126
    v_add_f32 v9, v9, v127
    v_mfma_f32_32x32x16_bf16 v[192:207], a[72:75], v[136:139], v[192:207]
    ds_read_b128 a[56:59], v1 offset:38912
    v_max3_f32 v4, v64, v65, v66
    v_max3_f32 v4, v4, v67, v68
    v_max3_f32 v4, v4, v69, v70
    v_max_f32 v4, v4, v71
    v_max3_f32 v5, v72, v73, v74
    v_mfma_f32_32x32x16_bf16 v[208:223], a[76:79], v[136:139], v[208:223]
    buffer_load_dwordx4 v1, s[8:11], s49 offen offset:3072 lds
    s_add_u32 s49, s49, 32768
    ds_read_b128 a[60:63], v1 offset:39936
    v_max3_f32 v5, v5, v75, v76
    v_max3_f32 v5, v5, v77, v78
    v_max_f32 v5, v5, v79
    s_waitcnt lgkmcnt(8)
    v_mfma_f32_32x32x16_bf16 v[160:175], a[80:83], v[140:143], v[160:175]
    ds_read_b128 a[64:67], v1 offset:40960
    v_max3_f32 v4, v4, v80, v81
    v_max3_f32 v4, v4, v82, v83
    v_max3_f32 v4, v4, v84, v85
    v_max3_f32 v4, v4, v86, v87
    v_max3_f32 v5, v5, v88, v89
    v_mfma_f32_32x32x16_bf16 v[176:191], a[84:87], v[140:143], v[176:191]
    ds_read_b128 a[68:71], v1 offset:41984
    v_max3_f32 v5, v5, v90, v91
    v_max3_f32 v5, v5, v92, v93
    v_max3_f32 v5, v5, v94, v95
    v_max_f32 v4, v4, v5
    v_cmp_lt_f32 vcc, s58, v4
    v_mfma_f32_32x32x16_bf16 v[192:207], a[88:91], v[140:143], v[192:207]
    ds_read_b128 a[72:75], v1 offset:43008
    v_mfma_f32_32x32x16_bf16 v[208:223], a[92:95], v[140:143], v[208:223]
    ds_read_b128 a[76:79], v1 offset:44032
    s_cbranch_vccnz K2_resc_L3
K2_ret_L3:
    s_sub_u32 s52, s52, 1
    s_cbranch_scc0 K2_L0
K2_M1:
    s_waitcnt lgkmcnt(8)
    v_mfma_f32_32x32x16_bf16 v[96:111], a[32:35], a[0:3], v[144:159]
    ds_read_b128 a[80:83], v1 offset:16384
    s_add_u32 m0, s51, 81920
    v_exp_f32 v64, v64
    v_exp_f32 v65, v65
    v_mfma_f32_32x32x16_bf16 v[96:111], a[36:39], a[4:7], v[96:111]
    ds_read_b128 a[84:87], v1 offset:17408
    v_exp_f32 v66, v66
    v_exp_f32 v67, v67
    v_cvt_pk_bf16_f32 v128, v64, v65
    v_mfma_f32_32x32x16_bf16 v[96:111], a[40:43], a[8:11], v[96:111]
    ds_read_b128 a[88:91], v1 offset:18432
    buffer_load_dwordx4 v1, s[8:11], s50 offen lds
    v_exp_f32 v68, v68
    v_cvt_pk_bf16_f32 v129, v66, v67
    v_mfma_f32_32x32x16_bf16 v[96:111], a[44:47], a[12:15], v[96:111]
    ds_read_b128 a[92:95], v1 offset:19456
    v_exp_f32 v69, v69
    v_exp_f32 v70, v70
    v_add_f32 v6, v6, v64
    s_waitcnt lgkmcnt(8)
    v_mfma_f32_32x32x16_bf16 v[96:111], a[48:51], a[16:19], v[96:111]
    ds_read_b128 a[32:35], v1 offset:45056
    v_exp_f32 v71, v71
    v_cvt_pk_bf16_f32 v130, v68, v69
    v_exp_f32 v72, v72
    v_mfma_f32_32x32x16_bf16 v[96:111], a[52:55], a[20:23], v[96:111]
    ds_read_b128 a[36:39], v1 offset:46080
    v_cvt_pk_bf16_f32 v131, v70, v71
    v_exp_f32 v73, v73
    v_exp_f32 v74, v74
    v_mfma_f32_32x32x16_bf16 v[96:111], a[56:59], a[24:27], v[96:111]
    ds_read_b128 a[40:43], v1 offset:47104
    buffer_load_dwordx4 v1, s[8:11], s50 offen offset:1024 lds
    v_exp_f32 v75, v75
    v_cvt_pk_bf16_f32 v132, v72, v73
    v_mfma_f32_32x32x16_bf16 v[96:111], a[60:63], a[28:31], v[96:111]
    ds_read_b128 a[44:47], v1 offset:48128
    v_exp_f32 v76, v76
    v_exp_f32 v77, v77
    v_cvt_pk_bf16_f32 v133, v74, v75
    s_waitcnt lgkmcnt(8)
    v_mfma_f32_32x32x16_bf16 v[112:127], a[64:67], a[0:3], v[144:159]
    ds_read_b128 a[48:51], v1 offset:20480
    v_exp_f32 v78, v78
    v_exp_f32 v79, v79
    v_cvt_pk_bf16_f32 v134, v76, v77
    v_mfma_f32_32x32x16_bf16 v[112:127], a[68:71], a[4:7], v[112:127]
    ds_read_b128 a[52:55], v1 offset:21504
    v_cvt_pk_bf16_f32 v135, v78, v79
    v_exp_f32 v80, v80
    v_exp_f32 v81, v81
    v_mfma_f32_32x32x16_bf16 v[112:127], a[72:75], a[8:11], v[112:127]
    ds_read_b128 a[56:59], v1 offset:22528
    buffer_load_dwordx4 v1, s[8:11], s50 offen offset:2048 lds
    v_exp_f32 v82, v82
    v_cvt_pk_bf16_f32 v136, v80, v81
    v_mfma_f32_32x32x16_bf16 v[112:127], a[76:79], a[12:15], v[112:127]
    ds_read_b128 a[60:63], v1 offset:23552
    v_exp_f32 v83, v83
    v_exp_f32 v84, v84
    v_add_f32 v16, 0x0, v11
    s_waitcnt lgkmcnt(8)
    v_mfma_f32_32x32x16_bf16 v[160:175], a[80:83], v[128:131], v[160:175]
    ds_read_b128 a[64:67], v1 offset:24576
    v_exp_f32 v85, v85
    v_exp_f32 v86, v86
    v_cvt_pk_bf16_f32 v137, v82, v83
    v_mfma_f32_32x32x16_bf16 v[176:191], a[84:87], v[128:131], v[176:191]
    ds_read_b128 a[68:71], v1 offset:25600
    v_exp_f32 v87, v87
    v_cvt_pk_bf16_f32 v138, v84, v85
    v_exp_f32 v88, v88
    v_mfma_f32_32x32x16_bf16 v[192:207], a[88:91], v[128:131], v[192:207]
    ds_read_b128 a[72:75], v1 offset:26624
    buffer_load_dwordx4 v1, s[8:11], s50 offen offset:3072 lds
    s_add_u32 s50, s50, 32768
    v_cvt_pk_bf16_f32 v139, v86, v87
    v_exp_f32 v89, v89
    v_mfma_f32_32x32x16_bf16 v[208:223], a[92:95], v[128:131], v[208:223]
    ds_read_b128 a[76:79], v1 offset:27648
    v_exp_f32 v90, v90
    v_exp_f32 v91, v91
    v_cvt_pk_bf16_f32 v140, v88, v89
    s_waitcnt lgkmcnt(8)
    v_mfma_f32_32x32x16_bf16 v[112:127], a[32:35], a[16:19], v[112:127]
    ds_read_b128 a[80:83], v1 offset:28672
    v_exp_f32 v92, v92
    v_exp_f32 v93, v93
    v_cvt_pk_bf16_f32 v141, v90, v91
    v_mfma_f32_32x32x16_bf16 v[112:127], a[36:39], a[20:23], v[112:127]
    ds_read_b128 a[84:87], v1 offset:29696
    v_exp_f32 v94, v94
    v_exp_f32 v95, v95
    v_cvt_pk_bf16_f32 v142, v92, v93
    v_mfma_f32_32x32x16_bf16 v[112:127], a[40:43], a[24:27], v[112:127]
    ds_read_b128 a[88:91], v1 offset:30720
    v_cvt_pk_bf16_f32 v143, v94, v95
    v_min_f32 v96, v96, v16
    v_add_f32 v17, 0xf1800000, v11
    v_min_f32 v97, v97, v17
    v_add_f32 v18, 0xf2000000, v11
    v_mfma_f32_32x32x16_bf16 v[112:127], a[44:47], a[28:31], v[112:127]
    s_waitcnt vmcnt(8)
    s_barrier
    ds_read_b128 a[92:95], v1 offset:31744
    v_min_f32 v98, v98, v18
    v_add_f32 v19, 0xf2400000, v11
    v_min_f32 v99, v99, v19
    s_waitcnt lgkmcnt(8)
    v_mfma_f32_32x32x16_bf16 v[160:175], a[48:51], v[132:135], v[160:175]
    v_add_f32 v16, 0xf3000000, v11
    v_min_f32 v100, v100, v16
    v_add_f32 v17, 0xf3100000, v11
    v_min_f32 v101, v101, v17
    v_add_f32 v18, 0xf3200000, v11
    v_min_f32 v102, v102, v18
    v_mfma_f32_32x32x16_bf16 v[176:191], a[52:55], v[132:135], v[176:191]
    v_add_f32 v19, 0xf3300000, v11
    v_min_f32 v103, v103, v19
    v_add_f32 v16, 0xf3800000, v11
    v_min_f32 v104, v104, v16
    v_add_f32 v17, 0xf3880000, v11
    v_min_f32 v105, v105, v17
    v_mfma_f32_32x32x16_bf16 v[192:207], a[56:59], v[132:135], v[192:207]
    v_add_f32 v18, 0xf3900000, v11
    v_min_f32 v106, v106, v18
    v_add_f32 v19, 0xf3980000, v11
    v_min_f32 v107, v107, v19
    v_add_f32 v16, 0xf3c00000, v11
    v_min_f32 v108, v108, v16
    v_mfma_f32_32x32x16_bf16 v[208:223], a[60:63], v[132:135], v[208:223]
    v_add_f32 v17, 0xf3c80000, v11
    v_min_f32 v109, v109, v17
    v_add_f32 v18, 0xf3d00000, v11
    v_min_f32 v110, v110, v18
    v_add_f32 v19, 0xf3d80000, v11
    v_min_f32 v111, v111, v19
    s_waitcnt lgkmcnt(4)
    v_mfma_f32_32x32x16_bf16 v[160:175], a[64:67], v[136:139], v[160:175]
    v_add_f32 v16, 0xf4000000, v11
    v_min_f32 v112, v112, v16
    v_add_f32 v17, 0xf4040000, v11
    v_min_f32 v113, v113, v17
    v_add_f32 v18, 0xf4080000, v11
    v_min_f32 v114, v114, v18
    v_mfma_f32_32x32x16_bf16 v[176:191], a[68:71], v[136:139], v[176:191]
    v_add_f32 v19, 0xf40c0000, v11
    v_min_f32 v115, v115, v19
    v_add_f32 v16, 0xf4200000, v11
    v_min_f32 v116, v116, v16
    v_add_f32 v17, 0xf4240000, v11
    v_min_f32 v117, v117, v17
    v_mfma_f32_32x32x16_bf16 v[192:207], a[72:75], v[136:139], v[192:207]
    v_add_f32 v18, 0xf4280000, v11
    v_min_f32 v118, v118, v18
    v_add_f32 v19, 0xf42c0000, v11
    v_min_f32 v119, v119, v19
    v_add_f32 v16, 0xf4400000, v11
    v_min_f32 v120, v120, v16
    v_mfma_f32_32x32x16_bf16 v[208:223], a[76:79], v[136:139], v[208:223]
    v_add_f32 v17, 0xf4440000, v11
    v_min_f32 v121, v121, v17
    v_add_f32 v18, 0xf4480000, v11
    v_min_f32 v122, v122, v18
    v_add_f32 v19, 0xf44c0000, v11
    v_min_f32 v123, v123, v19
    s_waitcnt lgkmcnt(0)
    v_mfma_f32_32x32x16_bf16 v[160:175], a[80:83], v[140:143], v[160:175]
    v_add_f32 v16, 0xf4600000, v11
    v_min_f32 v124, v124, v16
    v_add_f32 v17, 0xf4640000, v11
    v_min_f32 v125, v125, v17
    v_add_f32 v18, 0xf4680000, v11
    v_min_f32 v126, v126, v18
    v_mfma_f32_32x32x16_bf16 v[176:191], a[84:87], v[140:143], v[176:191]
    v_add_f32 v19, 0xf46c0000, v11
    v_min_f32 v127, v127, v19
    ds_read_b128 a[32:35], v2 offset:0
    ds_read_b128 a[36:39], v2 offset:1024
    ds_read_b128 a[40:43], v2 offset:2048
    ds_read_b128 a[44:47], v2 offset:3072
    v_mfma_f32_32x32x16_bf16 v[192:207], a[88:91], v[140:143], v[192:207]
    ds_read_b128 a[48:51], v2 offset:4096
    ds_read_b128 a[52:55], v2 offset:5120
    ds_read_b128 a[56:59], v2 offset:6144
    ds_read_b128 a[60:63], v2 offset:7168
    ds_read_b128 a[64:67], v2 offset:8192
    ds_read_b128 a[68:71], v2 offset:9216
    v_mfma_f32_32x32x16_bf16 v[208:223], a[92:95], v[140:143], v[208:223]
    ds_read_b128 a[72:75], v2 offset:10240
    ds_read_b128 a[76:79], v2 offset:11264
    v_add_f32 v7, v7, v65
    v_add_f32 v8, v8, v66
    v_add_f32 v9, v9, v67
    v_add_f32 v6, v6, v68
    v_add_f32 v7, v7, v69
    v_add_f32 v8, v8, v70
    v_add_f32 v9, v9, v71
    v_add_f32 v6, v6, v72
    v_add_f32 v7, v7, v73
    v_add_f32 v8, v8, v74
    v_add_f32 v9, v9, v75
    v_add_f32 v6, v6, v76
    v_add_f32 v7, v7, v77
    v_add_f32 v8, v8, v78
    v_add_f32 v9, v9, v79
    v_add_f32 v6, v6, v80
    v_add_f32 v7, v7, v81
    v_add_f32 v8, v8, v82
    v_add_f32 v9, v9, v83
    v_add_f32 v6, v6, v84
    v_add_f32 v7, v7, v85
    v_add_f32 v8, v8, v86
    v_add_f32 v9, v9, v87
    v_add_f32 v6, v6, v88
    v_add_f32 v7, v7, v89
    v_add_f32 v8, v8, v90
    v_add_f32 v9, v9, v91
    v_add_f32 v6, v6, v92
    v_add_f32 v7, v7, v93
    v_add_f32 v8, v8, v94
    v_add_f32 v9, v9, v95
    v_max3_f32 v4, v96, v97, v98
    v_max3_f32 v4, v4, v99, v100
    v_max3_f32 v4, v4, v101, v102
    v_max_f32 v4, v4, v103
    v_max3_f32 v5, v104, v105, v106
    v_max3_f32 v5, v5, v107, v108
    v_max3_f32 v5, v5, v109, v110
    v_max_f32 v5, v5, v111
    v_max3_f32 v4, v4, v112, v113
    v_max3_f32 v4, v4, v114, v115
    v_max3_f32 v4, v4, v116, v117
    v_max3_f32 v4, v4, v118, v119
    v_max3_f32 v5, v5, v120, v121
    v_max3_f32 v5, v5, v122, v123
    v_max3_f32 v5, v5, v124, v125
    v_max3_f32 v5, v5, v126, v127
    v_max_f32 v4, v4, v5
    v_cmp_lt_f32 vcc, s58, v4
    s_cbranch_vccnz K2_resc_M1
K2_ret_M1:
K2_M2:
    s_cmp_eq_u32 s60, 1
    s_cselect_b32 s10, 0x100000, 0
    s_waitcnt lgkmcnt(8)
    v_mfma_f32_32x32x16_bf16 v[64:79], a[32:35], a[0:3], v[144:159]
    ds_read_b128 a[80:83], v1 offset:49152
    v_exp_f32 v96, v96
    v_exp_f32 v97, v97
    v_mfma_f32_32x32x16_bf16 v[64:79], a[36:39], a[4:7], v[64:79]
    ds_read_b128 a[84:87], v1 offset:50176
    v_exp_f32 v98, v98
    v_exp_f32 v99, v99
    v_cvt_pk_bf16_f32 v128, v96, v97
    v_mfma_f32_32x32x16_bf16 v[64:79], a[40:43], a[8:11], v[64:79]
    ds_read_b128 a[88:91], v1 offset:51200
    v_exp_f32 v100, v100
    v_exp_f32 v101, v101
    v_cvt_pk_bf16_f32 v129, v98, v99
    v_mfma_f32_32x32x16_bf16 v[64:79], a[44:47], a[12:15], v[64:79]
    ds_read_b128 a[92:95], v1 offset:52224
    v_exp_f32 v102, v102
    v_exp_f32 v103, v103
    v_cvt_pk_bf16_f32 v130, v100, v101
    s_waitcnt lgkmcnt(8)
    v_mfma_f32_32x32x16_bf16 v[64:79], a[48:51], a[16:19], v[64:79]
    ds_read_b128 a[32:35], v2 offset:12288
    v_cvt_pk_bf16_f32 v131, v102, v103
    v_exp_f32 v104, v104
    v_exp_f32 v105, v105
    v_mfma_f32_32x32x16_bf16 v[64:79], a[52:55], a[20:23], v[64:79]
    ds_read_b128 a[36:39], v2 offset:13312
    v_exp_f32 v106, v106
    v_exp_f32 v107, v107
    v_cvt_pk_bf16_f32 v132, v104, v105
    v_mfma_f32_32x32x16_bf16 v[64:79], a[56:59], a[24:27], v[64:79]
    ds_read_b128 a[40:43], v2 offset:14336
    v_exp_f32 v108, v108
    v_exp_f32 v109, v109
    v_cvt_pk_bf16_f32 v133, v106, v107
    v_mfma_f32_32x32x16_bf16 v[64:79], a[60:63], a[28:31], v[64:79]
    ds_read_b128 a[44:47], v2 offset:15360
    v_exp_f32 v110, v110
    v_exp_f32 v111, v111
    v_cvt_pk_bf16_f32 v134, v108, v109
    s_waitcnt lgkmcnt(8)
    v_mfma_f32_32x32x16_bf16 v[80:95], a[64:67], a[0:3], v[144:159]
    ds_read_b128 a[48:51], v1 offset:53248
    v_cvt_pk_bf16_f32 v135, v110, v111
    v_exp_f32 v112, v112
    v_exp_f32 v113, v113
    v_mfma_f32_32x32x16_bf16 v[80:95], a[68:71], a[4:7], v[80:95]
    ds_read_b128 a[52:55], v1 offset:54272
    v_exp_f32 v114, v114
    v_exp_f32 v115, v115
    v_cvt_pk_bf16_f32 v136, v112, v113
    v_mfma_f32_32x32x16_bf16 v[80:95], a[72:75], a[8:11], v[80:95]
    ds_read_b128 a[56:59], v1 offset:55296
    v_exp_f32 v116, v116
    v_exp_f32 v117, v117
    v_cvt_pk_bf16_f32 v137, v114, v115
    v_mfma_f32_32x32x16_bf16 v[80:95], a[76:79], a[12:15], v[80:95]
    ds_read_b128 a[60:63], v1 offset:56320
    v_exp_f32 v118, v118
    v_exp_f32 v119, v119
    v_cvt_pk_bf16_f32 v138, v116, v117
    s_waitcnt lgkmcnt(8)
    v_mfma_f32_32x32x16_bf16 v[160:175], a[80:83], v[128:131], v[160:175]
    ds_read_b128 a[64:67], v1 offset:57344
    v_cvt_pk_bf16_f32 v139, v118, v119
    v_exp_f32 v120, v120
    v_exp_f32 v121, v121
    v_mfma_f32_32x32x16_bf16 v[176:191], a[84:87], v[128:131], v[176:191]
    ds_read_b128 a[68:71], v1 offset:58368
    v_exp_f32 v122, v122
    v_exp_f32 v123, v123
    v_cvt_pk_bf16_f32 v140, v120, v121
    v_mfma_f32_32x32x16_bf16 v[192:207], a[88:91], v[128:131], v[192:207]
    ds_read_b128 a[72:75], v1 offset:59392
    v_exp_f32 v124, v124
    v_exp_f32 v125, v125
    v_cvt_pk_bf16_f32 v141, v122, v123
    v_mfma_f32_32x32x16_bf16 v[208:223], a[92:95], v[128:131], v[208:223]
    ds_read_b128 a[76:79], v1 offset:60416
    v_exp_f32 v126, v126
    v_exp_f32 v127, v127
    v_cvt_pk_bf16_f32 v142, v124, v125
    s_waitcnt lgkmcnt(8)
    v_mfma_f32_32x32x16_bf16 v[80:95], a[32:35], a[16:19], v[80:95]
    ds_read_b128 a[80:83], v1 offset:61440
    v_cvt_pk_bf16_f32 v143, v126, v127
    v_add_f32 v16, 0xf4800000, v11
    v_min_f32 v64, v64, v16
    v_add_f32 v17, 0xf4820000, v11
    v_min_f32 v65, v65, v17
    v_mfma_f32_32x32x16_bf16 v[80:95], a[36:39], a[20:23], v[80:95]
    ds_read_b128 a[84:87], v1 offset:62464
    v_add_f32 v18, 0xf4840000, v11
    v_min_f32 v66, v66, v18
    v_add_f32 v19, 0xf4860000, v11
    v_min_f32 v67, v67, v19
    v_add_f32 v16, 0xf4900000, v11
    v_mfma_f32_32x32x16_bf16 v[80:95], a[40:43], a[24:27], v[80:95]
    ds_read_b128 a[88:91], v1 offset:63488
    v_min_f32 v68, v68, v16
    v_add_f32 v17, 0xf4920000, v11
    v_min_f32 v69, v69, v17
    v_add_f32 v18, 0xf4940000, v11
    v_min_f32 v70, v70, v18
    v_mfma_f32_32x32x16_bf16 v[80:95], a[44:47], a[28:31], v[80:95]
    s_waitcnt vmcnt(0)
    s_barrier
    ds_read_b128 a[92:95], v1 offset:64512
    v_add_f32 v19, 0xf4960000, v11
    v_min_f32 v71, v71, v19
    v_add_f32 v16, 0xf4a00000, v11
    s_waitcnt lgkmcnt(8)
    v_mfma_f32_32x32x16_bf16 v[160:175], a[48:51], v[132:135], v[160:175]
    s_mov_b32 m0, s63
    v_min_f32 v72, v72, v16
    v_add_f32 v17, 0xf4a20000, v11
    v_min_f32 v73, v73, v17
    v_add_f32 v18, 0xf4a40000, v11
    v_min_f32 v74, v74, v18
    v_mfma_f32_32x32x16_bf16 v[176:191], a[52:55], v[132:135], v[176:191]
    buffer_load_dwordx4 v1, s[8:11], s51 offen lds
    v_add_f32 v19, 0xf4a60000, v11
    v_min_f32 v75, v75, v19
    v_add_f32 v16, 0xf4b00000, v11
    v_min_f32 v76, v76, v16
    v_mfma_f32_32x32x16_bf16 v[192:207], a[56:59], v[132:135], v[192:207]
    buffer_load_dwordx4 v1, s[8:11], s51 offen offset:1024 lds
    v_add_f32 v17, 0xf4b20000, v11
    v_min_f32 v77, v77, v17
    v_add_f32 v18, 0xf4b40000, v11
    v_min_f32 v78, v78, v18
    v_mfma_f32_32x32x16_bf16 v[208:223], a[60:63], v[132:135], v[208:223]
    buffer_load_dwordx4 v1, s[8:11], s51 offen offset:2048 lds
    v_add_f32 v19, 0xf4b60000, v11
    v_min_f32 v79, v79, v19
    v_add_f32 v16, 0xf4c00000, v11
    v_min_f32 v80, v80, v16
    s_waitcnt lgkmcnt(4)
    v_mfma_f32_32x32x16_bf16 v[160:175], a[64:67], v[136:139], v[160:175]
    buffer_load_dwordx4 v1, s[8:11], s51 offen offset:3072 lds
    v_add_f32 v17, 0xf4c20000, v11
    v_min_f32 v81, v81, v17
    v_add_f32 v18, 0xf4c40000, v11
    v_min_f32 v82, v82, v18
    v_mfma_f32_32x32x16_bf16 v[176:191], a[68:71], v[136:139], v[176:191]
    s_mov_b32 m0, s64
    v_add_f32 v19, 0xf4c60000, v11
    v_min_f32 v83, v83, v19
    v_add_f32 v16, 0xf4d00000, v11
    v_min_f32 v84, v84, v16
    v_add_f32 v17, 0xf4d20000, v11
    v_mfma_f32_32x32x16_bf16 v[192:207], a[72:75], v[136:139], v[192:207]
    v_min_f32 v85, v85, v17
    v_add_f32 v18, 0xf4d40000, v11
    v_min_f32 v86, v86, v18
    v_add_f32 v19, 0xf4d60000, v11
    v_min_f32 v87, v87, v19
    v_add_f32 v16, 0xf4e00000, v11
    v_mfma_f32_32x32x16_bf16 v[208:223], a[76:79], v[136:139], v[208:223]
    buffer_load_dwordx4 v1, s[8:11], s65 offen lds
    v_min_f32 v88, v88, v16
    v_add_f32 v17, 0xf4e20000, v11
    v_min_f32 v89, v89, v17
    v_add_f32 v18, 0xf4e40000, v11
    s_waitcnt lgkmcnt(0)
    v_mfma_f32_32x32x16_bf16 v[160:175], a[80:83], v[140:143], v[160:175]
    buffer_load_dwordx4 v1, s[8:11], s65 offen offset:1024 lds
    v_min_f32 v90, v90, v18
    v_add_f32 v19, 0xf4e60000, v11
    v_min_f32 v91, v91, v19
    v_add_f32 v16, 0xf4f00000, v11
    v_mfma_f32_32x32x16_bf16 v[176:191], a[84:87], v[140:143], v[176:191]
    v_min_f32 v92, v92, v16
    v_add_f32 v17, 0xf4f20000, v11
    v_min_f32 v93, v93, v17
    v_add_f32 v18, 0xf4f40000, v11
    v_min_f32 v94, v94, v18
    v_add_f32 v19, 0xf4f60000, v11
    v_mfma_f32_32x32x16_bf16 v[192:207], a[88:91], v[140:143], v[192:207]
    v_min_f32 v95, v95, v19
    buffer_load_dwordx4 v1, s[8:11], s65 offen offset:2048 lds
    v_add_f32 v6, v6, v96
    v_add_f32 v7, v7, v97
    v_add_f32 v8, v8, v98
    v_mfma_f32_32x32x16_bf16 v[208:223], a[92:95], v[140:143], v[208:223]
    v_add_f32 v9, v9, v99
    v_add_f32 v6, v6, v100
    v_add_f32 v7, v7, v101
    v_add_f32 v8, v8, v102
    v_add_f32 v9, v9, v103
    v_add_f32 v6, v6, v104
    v_add_f32 v7, v7, v105
    v_add_f32 v8, v8, v106
    v_add_f32 v9, v9, v107
    v_add_f32 v6, v6, v108
    v_add_f32 v7, v7, v109
    v_add_f32 v8, v8, v110
    v_add_f32 v9, v9, v111
    v_add_f32 v6, v6, v112
    v_add_f32 v7, v7, v113
    v_add_f32 v8, v8, v114
    v_add_f32 v9, v9, v115
    v_add_f32 v6, v6, v116
    v_add_f32 v7, v7, v117
    v_add_f32 v8, v8, v118
    v_add_f32 v9, v9, v119
    v_add_f32 v6, v6, v120
    v_add_f32 v7, v7, v121
    v_add_f32 v8, v8, v122
    v_add_f32 v9, v9, v123
    v_add_f32 v6, v6, v124
    v_add_f32 v7, v7, v125
    v_add_f32 v8, v8, v126
    v_add_f32 v9, v9, v127
    v_max3_f32 v4, v64, v65, v66
    v_max3_f32 v4, v4, v67, v68
    v_max3_f32 v4, v4, v69, v70
    v_max_f32 v4, v4, v71
    v_max3_f32 v5, v72, v73, v74
    v_max3_f32 v5, v5, v75, v76
    v_max3_f32 v5, v5, v77, v78
    v_max_f32 v5, v5, v79
    v_max3_f32 v4, v4, v80, v81
    v_max3_f32 v4, v4, v82, v83
    v_max3_f32 v4, v4, v84, v85
    v_max3_f32 v4, v4, v86, v87
    v_max3_f32 v5, v5, v88, v89
    v_max3_f32 v5, v5, v90, v91
    v_max3_f32 v5, v5, v92, v93
    v_max3_f32 v5, v5, v94, v95
    v_max_f32 v4, v4, v5
    v_cmp_lt_f32 vcc, s58, v4
    buffer_load_dwordx4 v1, s[8:11], s65 offen offset:3072 lds
    s_cbranch_vccnz K2_resc_M2
K2_ret_M2:
    s_cmp_eq_u32 s60, 1
    s_cbranch_scc0 K2_noe2
    s_add_u32 s54, s61, 2
    s_and_b32 s54, s54, 3
    s_lshl_b32 s54, s54, 15
    s_add_u32 s54, s54, s51
    s_add_u32 m0, s54, 0
    s_add_u32 s55, s51, 65536
    buffer_load_dwordx4 v1, s[8:11], s55 offen lds
    buffer_load_dwordx4 v1, s[8:11], s55 offen offset:1024 lds
    buffer_load_dwordx4 v1, s[8:11], s55 offen offset:2048 lds
    buffer_load_dwordx4 v1, s[8:11], s55 offen offset:3072 lds
    s_lshl_b32 s54, s62, 7
    s_add_u32 s54, s54, 55574528
    buffer_load_dword v12, v14, s[12:15], s54 offen sc1
    v_accvgpr_mov_b32 a0, a96
    v_accvgpr_mov_b32 a1, a97
    v_accvgpr_mov_b32 a2, a98
    v_accvgpr_mov_b32 a3, a99
    v_accvgpr_mov_b32 a4, a100
    v_accvgpr_mov_b32 a5, a101
    v_accvgpr_mov_b32 a6, a102
    v_accvgpr_mov_b32 a7, a103
    v_accvgpr_mov_b32 a8, a104
    v_accvgpr_mov_b32 a9, a105
    v_accvgpr_mov_b32 a10, a106
    v_accvgpr_mov_b32 a11, a107
    v_accvgpr_mov_b32 a12, a108
    v_accvgpr_mov_b32 a13, a109
    v_accvgpr_mov_b32 a14, a110
    v_accvgpr_mov_b32 a15, a111
    v_accvgpr_mov_b32 a16, a112
    v_accvgpr_mov_b32 a17, a113
    v_accvgpr_mov_b32 a18, a114
    v_accvgpr_mov_b32 a19, a115
    v_accvgpr_mov_b32 a20, a116
    v_accvgpr_mov_b32 a21, a117
    v_accvgpr_mov_b32 a22, a118
    v_accvgpr_mov_b32 a23, a119
    v_accvgpr_mov_b32 a24, a120
    v_accvgpr_mov_b32 a25, a121
    v_accvgpr_mov_b32 a26, a122
    v_accvgpr_mov_b32 a27, a123
    v_accvgpr_mov_b32 a28, a124
    v_accvgpr_mov_b32 a29, a125
    v_accvgpr_mov_b32 a30, a126
    v_accvgpr_mov_b32 a31, a127
    v_accvgpr_read_b32 v32, a128
    v_accvgpr_read_b32 v33, a129
    v_accvgpr_read_b32 v34, a130
    v_accvgpr_read_b32 v35, a131
    v_accvgpr_read_b32 v36, a132
    v_accvgpr_read_b32 v37, a133
    v_accvgpr_read_b32 v38, a134
    v_accvgpr_read_b32 v39, a135
K2_noe2:
    ds_read_b128 a[80:83], v2 offset:16384
    v_exp_f32 v64, v64
    v_exp_f32 v65, v65
    ds_read_b128 a[84:87], v2 offset:17408
    v_exp_f32 v66, v66
    v_exp_f32 v67, v67
    v_cvt_pk_bf16_f32 v128, v64, v65
    ds_read_b128 a[88:91], v2 offset:18432
    v_exp_f32 v68, v68
    v_exp_f32 v69, v69
    v_cvt_pk_bf16_f32 v129, v66, v67
    ds_read_b128 a[92:95], v2 offset:19456
    v_exp_f32 v70, v70
    v_exp_f32 v71, v71
    v_cvt_pk_bf16_f32 v130, v68, v69
    v_cvt_pk_bf16_f32 v131, v70, v71
    v_exp_f32 v72, v72
    v_exp_f32 v73, v73
    v_add_f32 v6, v6, v64
    v_exp_f32 v74, v74
    v_exp_f32 v75, v75
    v_exp_f32 v76, v76
    v_exp_f32 v77, v77
    v_exp_f32 v78, v78
    v_exp_f32 v79, v79
    v_cvt_pk_bf16_f32 v132, v72, v73
    v_cvt_pk_bf16_f32 v133, v74, v75
    v_cvt_pk_bf16_f32 v134, v76, v77
    v_cvt_pk_bf16_f32 v135, v78, v79
    v_exp_f32 v80, v80
    ds_read_b128 a[48:51], v2 offset:20480
    v_exp_f32 v81, v81
    v_exp_f32 v82, v82
    v_add_f32 v7, v7, v65
    ds_read_b128 a[52:55], v2 offset:21504
    v_exp_f32 v83, v83
    v_exp_f32 v84, v84
    v_cvt_pk_bf16_f32 v136, v80, v81
    ds_read_b128 a[56:59], v2 offset:22528
    v_exp_f32 v85, v85
    v_exp_f32 v86, v86
    v_cvt_pk_bf16_f32 v137, v82, v83
    ds_read_b128 a[60:63], v2 offset:23552
    v_exp_f32 v87, v87
    v_cvt_pk_bf16_f32 v138, v84, v85
    v_exp_f32 v88, v88
    s_waitcnt lgkmcnt(4)
    v_mfma_f32_32x32x16_bf16 v[160:175], a[80:83], v[128:131], v[160:175]
    ds_read_b128 a[64:67], v2 offset:24576
    v_cvt_pk_bf16_f32 v139, v86, v87
    v_exp_f32 v89, v89
    v_exp_f32 v90, v90
    v_mfma_f32_32x32x16_bf16 v[176:191], a[84:87], v[128:131], v[176:191]
    ds_read_b128 a[68:71], v2 offset:25600
    v_exp_f32 v91, v91
    v_exp_f32 v92, v92
    v_cvt_pk_bf16_f32 v140, v88, v89
    v_mfma_f32_32x32x16_bf16 v[192:207], a[88:91], v[128:131], v[192:207]
    ds_read_b128 a[72:75], v2 offset:26624
    v_exp_f32 v93, v93
    v_exp_f32 v94, v94
    v_cvt_pk_bf16_f32 v141, v90, v91
    v_mfma_f32_32x32x16_bf16 v[208:223], a[92:95], v[128:131], v[208:223]
    ds_read_b128 a[76:79], v2 offset:27648
    v_exp_f32 v95, v95
    v_cvt_pk_bf16_f32 v142, v92, v93
    v_add_f32 v8, v8, v66
    v_add_f32 v9, v9, v67
    ds_read_b128 a[80:83], v2 offset:28672
    v_cvt_pk_bf16_f32 v143, v94, v95
    v_add_f32 v6, v6, v68
    v_add_f32 v7, v7, v69
    v_add_f32 v8, v8, v70
    v_add_f32 v9, v9, v71
    ds_read_b128 a[84:87], v2 offset:29696
    v_add_f32 v6, v6, v72
    v_add_f32 v7, v7, v73
    v_add_f32 v8, v8, v74
    v_add_f32 v9, v9, v75
    v_add_f32 v6, v6, v76
    ds_read_b128 a[88:91], v2 offset:30720
    v_add_f32 v7, v7, v77
    v_add_f32 v8, v8, v78
    v_add_f32 v9, v9, v79
    v_add_f32 v6, v6, v80
    v_add_f32 v7, v7, v81
    ds_read_b128 a[92:95], v2 offset:31744
    v_add_f32 v8, v8, v82
    v_add_f32 v9, v9, v83
    v_add_f32 v6, v6, v84
    v_add_f32 v7, v7, v85
    v_add_f32 v8, v8, v86
    s_waitcnt lgkmcnt(8)
    v_mfma_f32_32x32x16_bf16 v[160:175], a[48:51], v[132:135], v[160:175]
    v_add_f32 v9, v9, v87
    v_add_f32 v6, v6, v88
    v_add_f32 v7, v7, v89
    v_add_f32 v8, v8, v90
    v_add_f32 v9, v9, v91
    v_add_f32 v6, v6, v92
    v_mfma_f32_32x32x16_bf16 v[176:191], a[52:55], v[132:135], v[176:191]
    v_add_f32 v7, v7, v93
    v_add_f32 v8, v8, v94
    v_add_f32 v9, v9, v95
    v_mfma_f32_32x32x16_bf16 v[192:207], a[56:59], v[132:135], v[192:207]
    v_mfma_f32_32x32x16_bf16 v[208:223], a[60:63], v[132:135], v[208:223]
    s_waitcnt lgkmcnt(4)
    v_mfma_f32_32x32x16_bf16 v[160:175], a[64:67], v[136:139], v[160:175]
    v_mfma_f32_32x32x16_bf16 v[176:191], a[68:71], v[136:139], v[176:191]
    v_mfma_f32_32x32x16_bf16 v[192:207], a[72:75], v[136:139], v[192:207]
    v_mfma_f32_32x32x16_bf16 v[208:223], a[76:79], v[136:139], v[208:223]
    s_waitcnt lgkmcnt(0)
    v_mfma_f32_32x32x16_bf16 v[160:175], a[80:83], v[140:143], v[160:175]
    v_mfma_f32_32x32x16_bf16 v[176:191], a[84:87], v[140:143], v[176:191]
    v_mfma_f32_32x32x16_bf16 v[192:207], a[88:91], v[140:143], v[192:207]
    v_mfma_f32_32x32x16_bf16 v[208:223], a[92:95], v[140:143], v[208:223]
    s_cmp_eq_u32 s60, 1
    s_cbranch_scc0 K2_nolate
    s_barrier
    s_add_u32 s54, s61, 0
    s_and_b32 s54, s54, 3
    s_lshl_b32 s54, s54, 15
    s_add_u32 s54, s54, s51
    s_add_u32 m0, s54, 16384
    s_add_u32 s55, s51, 16384
    buffer_load_dwordx4 v1, s[8:11], s55 offen lds
    buffer_load_dwordx4 v1, s[8:11], s55 offen offset:1024 lds
    buffer_load_dwordx4 v1, s[8:11], s55 offen offset:2048 lds
    buffer_load_dwordx4 v1, s[8:11], s55 offen offset:3072 lds
    s_add_u32 s54, s61, 1
    s_and_b32 s54, s54, 3
    s_lshl_b32 s54, s54, 15
    s_add_u32 s54, s54, s51
    s_add_u32 m0, s54, 16384
    s_add_u32 s55, s51, 49152
    buffer_load_dwordx4 v1, s[8:11], s55 offen lds
    buffer_load_dwordx4 v1, s[8:11], s55 offen offset:1024 lds
    buffer_load_dwordx4 v1, s[8:11], s55 offen offset:2048 lds
    buffer_load_dwordx4 v1, s[8:11], s55 offen offset:3072 lds
    s_add_u32 s54, s61, 3
    s_and_b32 s54, s54, 3
    s_lshl_b32 s54, s54, 15
    s_add_u32 s54, s54, s51
    s_add_u32 m0, s54, 0
    s_add_u32 s55, s51, 98304
    buffer_load_dwordx4 v1, s[8:11], s55 offen lds
    buffer_load_dwordx4 v1, s[8:11], s55 offen offset:1024 lds
    buffer_load_dwordx4 v1, s[8:11], s55 offen offset:2048 lds
    buffer_load_dwordx4 v1, s[8:11], s55 offen offset:3072 lds
K2_nolate:
    v_add_f32 v6, v6, v7
    v_add_f32 v8, v8, v9
    v_add_f32 v6, v6, v8
    v_mov_b32 v16, v6
    s_mul_i32 s54, s59, 294912
    s_add_u32 s54, s54, 56623104
    v_permlane32_swap_b32 v6, v16
    v_add_f32 v6, v6, v16
    v_rcp_f32 v6, v6
    s_lshl_b32 s55, s44, 13
    s_add_u32 s55, s55, s54
    s_add_u32 s56, s55, 4096
    v_mul_f32 v6, v6, v13
    v_mul_f32 v160, v160, v6
    v_mul_f32 v161, v161, v6
    v_mul_f32 v162, v162, v6
    v_mul_f32 v163, v163, v6
    v_mul_f32 v164, v164, v6
    v_mul_f32 v165, v165, v6
    v_mul_f32 v166, v166, v6
    v_mul_f32 v167, v167, v6
    v_mul_f32 v168, v168, v6
    v_mul_f32 v169, v169, v6
    v_mul_f32 v170, v170, v6
    v_mul_f32 v171, v171, v6
    v_mul_f32 v172, v172, v6
    v_mul_f32 v173, v173, v6
    v_mul_f32 v174, v174, v6
    v_mul_f32 v175, v175, v6
    v_cvt_pk_bf16_f32 v160, v160, v161
    v_cvt_pk_bf16_f32 v161, v162, v163
    v_cvt_pk_bf16_f32 v162, v164, v165
    v_cvt_pk_bf16_f32 v163, v166, v167
    v_cvt_pk_bf16_f32 v164, v168, v169
    v_cvt_pk_bf16_f32 v165, v170, v171
    v_cvt_pk_bf16_f32 v166, v172, v173
    v_cvt_pk_bf16_f32 v167, v174, v175
    buffer_store_dwordx4 v[160:163], v1, s[12:15], s55 offen sc1
    buffer_store_dwordx4 v[164:167], v1, s[12:15], s55 offen offset:1024 sc1
    v_mul_f32 v176, v176, v6
    v_mul_f32 v177, v177, v6
    v_mul_f32 v178, v178, v6
    v_mul_f32 v179, v179, v6
    v_mul_f32 v180, v180, v6
    v_mul_f32 v181, v181, v6
    v_mul_f32 v182, v182, v6
    v_mul_f32 v183, v183, v6
    v_mul_f32 v184, v184, v6
    v_mul_f32 v185, v185, v6
    v_mul_f32 v186, v186, v6
    v_mul_f32 v187, v187, v6
    v_mul_f32 v188, v188, v6
    v_mul_f32 v189, v189, v6
    v_mul_f32 v190, v190, v6
    v_mul_f32 v191, v191, v6
    v_cvt_pk_bf16_f32 v176, v176, v177
    v_cvt_pk_bf16_f32 v177, v178, v179
    v_cvt_pk_bf16_f32 v178, v180, v181
    v_cvt_pk_bf16_f32 v179, v182, v183
    v_cvt_pk_bf16_f32 v180, v184, v185
    v_cvt_pk_bf16_f32 v181, v186, v187
    v_cvt_pk_bf16_f32 v182, v188, v189
    v_cvt_pk_bf16_f32 v183, v190, v191
    buffer_store_dwordx4 v[176:179], v1, s[12:15], s55 offen offset:2048 sc1
    buffer_store_dwordx4 v[180:183], v1, s[12:15], s55 offen offset:3072 sc1
    v_mul_f32 v192, v192, v6
    v_mul_f32 v193, v193, v6
    v_mul_f32 v194, v194, v6
    v_mul_f32 v195, v195, v6
    v_mul_f32 v196, v196, v6
    v_mul_f32 v197, v197, v6
    v_mul_f32 v198, v198, v6
    v_mul_f32 v199, v199, v6
    v_mul_f32 v200, v200, v6
    v_mul_f32 v201, v201, v6
    v_mul_f32 v202, v202, v6
    v_mul_f32 v203, v203, v6
    v_mul_f32 v204, v204, v6
    v_mul_f32 v205, v205, v6
    v_mul_f32 v206, v206, v6
    v_mul_f32 v207, v207, v6
    v_cvt_pk_bf16_f32 v192, v192, v193
    v_cvt_pk_bf16_f32 v193, v194, v195
    v_cvt_pk_bf16_f32 v194, v196, v197
    v_cvt_pk_bf16_f32 v195, v198, v199
    v_cvt_pk_bf16_f32 v196, v200, v201
    v_cvt_pk_bf16_f32 v197, v202, v203
    v_cvt_pk_bf16_f32 v198, v204, v205
    v_cvt_pk_bf16_f32 v199, v206, v207
    buffer_store_dwordx4 v[192:195], v1, s[12:15], s56 offen sc1
    buffer_store_dwordx4 v[196:199], v1, s[12:15], s56 offen offset:1024 sc1
    v_mul_f32 v208, v208, v6
    v_mul_f32 v209, v209, v6
    v_mul_f32 v210, v210, v6
    v_mul_f32 v211, v211, v6
    v_mul_f32 v212, v212, v6
    v_mul_f32 v213, v213, v6
    v_mul_f32 v214, v214, v6
    v_mul_f32 v215, v215, v6
    v_mul_f32 v216, v216, v6
    v_mul_f32 v217, v217, v6
    v_mul_f32 v218, v218, v6
    v_mul_f32 v219, v219, v6
    v_mul_f32 v220, v220, v6
    v_mul_f32 v221, v221, v6
    v_mul_f32 v222, v222, v6
    v_mul_f32 v223, v223, v6
    v_cvt_pk_bf16_f32 v208, v208, v209
    v_cvt_pk_bf16_f32 v209, v210, v211
    v_cvt_pk_bf16_f32 v210, v212, v213
    v_cvt_pk_bf16_f32 v211, v214, v215
    v_cvt_pk_bf16_f32 v212, v216, v217
    v_cvt_pk_bf16_f32 v213, v218, v219
    v_cvt_pk_bf16_f32 v214, v220, v221
    v_cvt_pk_bf16_f32 v215, v222, v223
    buffer_store_dwordx4 v[208:211], v1, s[12:15], s56 offen offset:2048 sc1
    buffer_store_dwordx4 v[212:215], v1, s[12:15], s56 offen offset:3072 sc1
    s_cmp_eq_u32 s60, 0
    s_cbranch_scc1 K2_done
    s_mov_b32 s60, 0
    s_branch K2_block
K2_resc_L0:
    v_mov_b32 v24, v4
    s_nop 1
    v_permlane32_swap_b32 v4, v24
    v_max_f32 v25, v4, v24
    v_max_f32 v25, 0, v25
    v_exp_f32 v26, -v25
    s_nop 15
    v_sub_f32 v96, v96, v25
    v_sub_f32 v97, v97, v25
    v_sub_f32 v98, v98, v25
    v_sub_f32 v99, v99, v25
    v_sub_f32 v100, v100, v25
    v_sub_f32 v101, v101, v25
    v_sub_f32 v102, v102, v25
    v_sub_f32 v103, v103, v25
    v_sub_f32 v104, v104, v25
    v_sub_f32 v105, v105, v25
    v_sub_f32 v106, v106, v25
    v_sub_f32 v107, v107, v25
    v_sub_f32 v108, v108, v25
    v_sub_f32 v109, v109, v25
    v_sub_f32 v110, v110, v25
    v_sub_f32 v111, v111, v25
    v_sub_f32 v112, v112, v25
    v_sub_f32 v113, v113, v25
    v_sub_f32 v114, v114, v25
    v_sub_f32 v115, v115, v25
    v_sub_f32 v116, v116, v25
    v_sub_f32 v117, v117, v25
    v_sub_f32 v118, v118, v25
    v_sub_f32 v119, v119, v25
    v_sub_f32 v120, v120, v25
    v_sub_f32 v121, v121, v25
    v_sub_f32 v122, v122, v25
    v_sub_f32 v123, v123, v25
    v_sub_f32 v124, v124, v25
    v_sub_f32 v125, v125, v25
    v_sub_f32 v126, v126, v25
    v_sub_f32 v127, v127, v25
    v_sub_f32 v144, v144, v25
    v_sub_f32 v145, v145, v25
    v_sub_f32 v146, v146, v25
    v_sub_f32 v147, v147, v25
    v_sub_f32 v148, v148, v25
    v_sub_f32 v149, v149, v25
    v_sub_f32 v150, v150, v25
    v_sub_f32 v151, v151, v25
    v_sub_f32 v152, v152, v25
    v_sub_f32 v153, v153, v25
    v_sub_f32 v154, v154, v25
    v_sub_f32 v155, v155, v25
    v_sub_f32 v156, v156, v25
    v_sub_f32 v157, v157, v25
    v_sub_f32 v158, v158, v25
    v_sub_f32 v159, v159, v25
    v_mul_f32 v6, v6, v26
    v_mul_f32 v7, v7, v26
    v_mul_f32 v8, v8, v26
    v_mul_f32 v9, v9, v26
    v_mul_f32 v160, v160, v26
    v_mul_f32 v161, v161, v26
    v_mul_f32 v162, v162, v26
    v_mul_f32 v163, v163, v26
    v_mul_f32 v164, v164, v26
    v_mul_f32 v165, v165, v26
    v_mul_f32 v166, v166, v26
    v_mul_f32 v167, v167, v26
    v_mul_f32 v168, v168, v26
    v_mul_f32 v169, v169, v26
    v_mul_f32 v170, v170, v26
    v_mul_f32 v171, v171, v26
    v_mul_f32 v172, v172, v26
    v_mul_f32 v173, v173, v26
    v_mul_f32 v174, v174, v26
    v_mul_f32 v175, v175, v26
    v_mul_f32 v176, v176, v26
    v_mul_f32 v177, v177, v26
    v_mul_f32 v178, v178, v26
    v_mul_f32 v179, v179, v26
    v_mul_f32 v180, v180, v26
    v_mul_f32 v181, v181, v26
    v_mul_f32 v182, v182, v26
    v_mul_f32 v183, v183, v26
    v_mul_f32 v184, v184, v26
    v_mul_f32 v185, v185, v26
    v_mul_f32 v186, v186, v26
    v_mul_f32 v187, v187, v26
    v_mul_f32 v188, v188, v26
    v_mul_f32 v189, v189, v26
    v_mul_f32 v190, v190, v26
    v_mul_f32 v191, v191, v26
    v_mul_f32 v192, v192, v26
    v_mul_f32 v193, v193, v26
    v_mul_f32 v194, v194, v26
    v_mul_f32 v195, v195, v26
    v_mul_f32 v196, v196, v26
    v_mul_f32 v197, v197, v26
    v_mul_f32 v198, v198, v26
    v_mul_f32 v199, v199, v26
    v_mul_f32 v200, v200, v26
    v_mul_f32 v201, v201, v26
    v_mul_f32 v202, v202, v26
    v_mul_f32 v203, v203, v26
    v_mul_f32 v204, v204, v26
    v_mul_f32 v205, v205, v26
    v_mul_f32 v206, v206, v26
    v_mul_f32 v207, v207, v26
    v_mul_f32 v208, v208, v26
    v_mul_f32 v209, v209, v26
    v_mul_f32 v210, v210, v26
    v_mul_f32 v211, v211, v26
    v_mul_f32 v212, v212, v26
    v_mul_f32 v213, v213, v26
    v_mul_f32 v214, v214, v26
    v_mul_f32 v215, v215, v26
    v_mul_f32 v216, v216, v26
    v_mul_f32 v217, v217, v26
    v_mul_f32 v218, v218, v26
    v_mul_f32 v219, v219, v26
    v_mul_f32 v220, v220, v26
    v_mul_f32 v221, v221, v26
    v_mul_f32 v222, v222, v26
    v_mul_f32 v223, v223, v26
    s_nop 1
    s_branch K2_ret_L0
K2_resc_L1:
    v_mov_b32 v24, v4
    s_nop 1
    v_permlane32_swap_b32 v4, v24
    v_max_f32 v25, v4, v24
    v_max_f32 v25, 0, v25
    v_exp_f32 v26, -v25
    s_nop 15
    v_sub_f32 v64, v64, v25
    v_sub_f32 v65, v65, v25
    v_sub_f32 v66, v66, v25
    v_sub_f32 v67, v67, v25
    v_sub_f32 v68, v68, v25
    v_sub_f32 v69, v69, v25
    v_sub_f32 v70, v70, v25
    v_sub_f32 v71, v71, v25
    v_sub_f32 v72, v72, v25
    v_sub_f32 v73, v73, v25
    v_sub_f32 v74, v74, v25
    v_sub_f32 v75, v75, v25
    v_sub_f32 v76, v76, v25
    v_sub_f32 v77, v77, v25
    v_sub_f32 v78, v78, v25
    v_sub_f32 v79, v79, v25
    v_sub_f32 v80, v80, v25
    v_sub_f32 v81, v81, v25
    v_sub_f32 v82, v82, v25
    v_sub_f32 v83, v83, v25
    v_sub_f32 v84, v84, v25
    v_sub_f32 v85, v85, v25
    v_sub_f32 v86, v86, v25
    v_sub_f32 v87, v87, v25
    v_sub_f32 v88, v88, v25
    v_sub_f32 v89, v89, v25
    v_sub_f32 v90, v90, v25
    v_sub_f32 v91, v91, v25
    v_sub_f32 v92, v92, v25
    v_sub_f32 v93, v93, v25
    v_sub_f32 v94, v94, v25
    v_sub_f32 v95, v95, v25
    v_sub_f32 v144, v144, v25
    v_sub_f32 v145, v145, v25
    v_sub_f32 v146, v146, v25
    v_sub_f32 v147, v147, v25
    v_sub_f32 v148, v148, v25
    v_sub_f32 v149, v149, v25
    v_sub_f32 v150, v150, v25
    v_sub_f32 v151, v151, v25
    v_sub_f32 v152, v152, v25
    v_sub_f32 v153, v153, v25
    v_sub_f32 v154, v154, v25
    v_sub_f32 v155, v155, v25
    v_sub_f32 v156, v156, v25
    v_sub_f32 v157, v157, v25
    v_sub_f32 v158, v158, v25
    v_sub_f32 v159, v159, v25
    v_mul_f32 v6, v6, v26
    v_mul_f32 v7, v7, v26
    v_mul_f32 v8, v8, v26
    v_mul_f32 v9, v9, v26
    v_mul_f32 v160, v160, v26
    v_mul_f32 v161, v161, v26
    v_mul_f32 v162, v162, v26
    v_mul_f32 v163, v163, v26
    v_mul_f32 v164, v164, v26
    v_mul_f32 v165, v165, v26
    v_mul_f32 v166, v166, v26
    v_mul_f32 v167, v167, v26
    v_mul_f32 v168, v168, v26
    v_mul_f32 v169, v169, v26
    v_mul_f32 v170, v170, v26
    v_mul_f32 v171, v171, v26
    v_mul_f32 v172, v172, v26
    v_mul_f32 v173, v173, v26
    v_mul_f32 v174, v174, v26
    v_mul_f32 v175, v175, v26
    v_mul_f32 v176, v176, v26
    v_mul_f32 v177, v177, v26
    v_mul_f32 v178, v178, v26
    v_mul_f32 v179, v179, v26
    v_mul_f32 v180, v180, v26
    v_mul_f32 v181, v181, v26
    v_mul_f32 v182, v182, v26
    v_mul_f32 v183, v183, v26
    v_mul_f32 v184, v184, v26
    v_mul_f32 v185, v185, v26
    v_mul_f32 v186, v186, v26
    v_mul_f32 v187, v187, v26
    v_mul_f32 v188, v188, v26
    v_mul_f32 v189, v189, v26
    v_mul_f32 v190, v190, v26
    v_mul_f32 v191, v191, v26
    v_mul_f32 v192, v192, v26
    v_mul_f32 v193, v193, v26
    v_mul_f32 v194, v194, v26
    v_mul_f32 v195, v195, v26
    v_mul_f32 v196, v196, v26
    v_mul_f32 v197, v197, v26
    v_mul_f32 v198, v198, v26
    v_mul_f32 v199, v199, v26
    v_mul_f32 v200, v200, v26
    v_mul_f32 v201, v201, v26
    v_mul_f32 v202, v202, v26
    v_mul_f32 v203, v203, v26
    v_mul_f32 v204, v204, v26
    v_mul_f32 v205, v205, v26
    v_mul_f32 v206, v206, v26
    v_mul_f32 v207, v207, v26
    v_mul_f32 v208, v208, v26
    v_mul_f32 v209, v209, v26
    v_mul_f32 v210, v210, v26
    v_mul_f32 v211, v211, v26
    v_mul_f32 v212, v212, v26
    v_mul_f32 v213, v213, v26
    v_mul_f32 v214, v214, v26
    v_mul_f32 v215, v215, v26
    v_mul_f32 v216, v216, v26
    v_mul_f32 v217, v217, v26
    v_mul_f32 v218, v218, v26
    v_mul_f32 v219, v219, v26
    v_mul_f32 v220, v220, v26
    v_mul_f32 v221, v221, v26
    v_mul_f32 v222, v222, v26
    v_mul_f32 v223, v223, v26
    s_nop 1
    s_branch K2_ret_L1
K2_resc_L2:
    v_mov_b32 v24, v4
    s_nop 1
    v_permlane32_swap_b32 v4, v24
    v_max_f32 v25, v4, v24
    v_max_f32 v25, 0, v25
    v_exp_f32 v26, -v25
    s_nop 15
    v_sub_f32 v96, v96, v25
    v_sub_f32 v97, v97, v25
    v_sub_f32 v98, v98, v25
    v_sub_f32 v99, v99, v25
    v_sub_f32 v100, v100, v25
    v_sub_f32 v101, v101, v25
    v_sub_f32 v102, v102, v25
    v_sub_f32 v103, v103, v25
    v_sub_f32 v104, v104, v25
    v_sub_f32 v105, v105, v25
    v_sub_f32 v106, v106, v25
    v_sub_f32 v107, v107, v25
    v_sub_f32 v108, v108, v25
    v_sub_f32 v109, v109, v25
    v_sub_f32 v110, v110, v25
    v_sub_f32 v111, v111, v25
    v_sub_f32 v112, v112, v25
    v_sub_f32 v113, v113, v25
    v_sub_f32 v114, v114, v25
    v_sub_f32 v115, v115, v25
    v_sub_f32 v116, v116, v25
    v_sub_f32 v117, v117, v25
    v_sub_f32 v118, v118, v25
    v_sub_f32 v119, v119, v25
    v_sub_f32 v120, v120, v25
    v_sub_f32 v121, v121, v25
    v_sub_f32 v122, v122, v25
    v_sub_f32 v123, v123, v25
    v_sub_f32 v124, v124, v25
    v_sub_f32 v125, v125, v25
    v_sub_f32 v126, v126, v25
    v_sub_f32 v127, v127, v25
    v_sub_f32 v144, v144, v25
    v_sub_f32 v145, v145, v25
    v_sub_f32 v146, v146, v25
    v_sub_f32 v147, v147, v25
    v_sub_f32 v148, v148, v25
    v_sub_f32 v149, v149, v25
    v_sub_f32 v150, v150, v25
    v_sub_f32 v151, v151, v25
    v_sub_f32 v152, v152, v25
    v_sub_f32 v153, v153, v25
    v_sub_f32 v154, v154, v25
    v_sub_f32 v155, v155, v25
    v_sub_f32 v156, v156, v25
    v_sub_f32 v157, v157, v25
    v_sub_f32 v158, v158, v25
    v_sub_f32 v159, v159, v25
    v_mul_f32 v6, v6, v26
    v_mul_f32 v7, v7, v26
    v_mul_f32 v8, v8, v26
    v_mul_f32 v9, v9, v26
    v_mul_f32 v160, v160, v26
    v_mul_f32 v161, v161, v26
    v_mul_f32 v162, v162, v26
    v_mul_f32 v163, v163, v26
    v_mul_f32 v164, v164, v26
    v_mul_f32 v165, v165, v26
    v_mul_f32 v166, v166, v26
    v_mul_f32 v167, v167, v26
    v_mul_f32 v168, v168, v26
    v_mul_f32 v169, v169, v26
    v_mul_f32 v170, v170, v26
    v_mul_f32 v171, v171, v26
    v_mul_f32 v172, v172, v26
    v_mul_f32 v173, v173, v26
    v_mul_f32 v174, v174, v26
    v_mul_f32 v175, v175, v26
    v_mul_f32 v176, v176, v26
    v_mul_f32 v177, v177, v26
    v_mul_f32 v178, v178, v26
    v_mul_f32 v179, v179, v26
    v_mul_f32 v180, v180, v26
    v_mul_f32 v181, v181, v26
    v_mul_f32 v182, v182, v26
    v_mul_f32 v183, v183, v26
    v_mul_f32 v184, v184, v26
    v_mul_f32 v185, v185, v26
    v_mul_f32 v186, v186, v26
    v_mul_f32 v187, v187, v26
    v_mul_f32 v188, v188, v26
    v_mul_f32 v189, v189, v26
    v_mul_f32 v190, v190, v26
    v_mul_f32 v191, v191, v26
    v_mul_f32 v192, v192, v26
    v_mul_f32 v193, v193, v26
    v_mul_f32 v194, v194, v26
    v_mul_f32 v195, v195, v26
    v_mul_f32 v196, v196, v26
    v_mul_f32 v197, v197, v26
    v_mul_f32 v198, v198, v26
    v_mul_f32 v199, v199, v26
    v_mul_f32 v200, v200, v26
    v_mul_f32 v201, v201, v26
    v_mul_f32 v202, v202, v26
    v_mul_f32 v203, v203, v26
    v_mul_f32 v204, v204, v26
    v_mul_f32 v205, v205, v26
    v_mul_f32 v206, v206, v26
    v_mul_f32 v207, v207, v26
    v_mul_f32 v208, v208, v26
    v_mul_f32 v209, v209, v26
    v_mul_f32 v210, v210, v26
    v_mul_f32 v211, v211, v26
    v_mul_f32 v212, v212, v26
    v_mul_f32 v213, v213, v26
    v_mul_f32 v214, v214, v26
    v_mul_f32 v215, v215, v26
    v_mul_f32 v216, v216, v26
    v_mul_f32 v217, v217, v26
    v_mul_f32 v218, v218, v26
    v_mul_f32 v219, v219, v26
    v_mul_f32 v220, v220, v26
    v_mul_f32 v221, v221, v26
    v_mul_f32 v222, v222, v26
    v_mul_f32 v223, v223, v26
    s_nop 1
    s_branch K2_ret_L2
K2_resc_L3:
    v_mov_b32 v24, v4
    s_nop 1
    v_permlane32_swap_b32 v4, v24
    v_max_f32 v25, v4, v24
    v_max_f32 v25, 0, v25
    v_exp_f32 v26, -v25
    s_nop 15
    v_sub_f32 v64, v64, v25
    v_sub_f32 v65, v65, v25
    v_sub_f32 v66, v66, v25
    v_sub_f32 v67, v67, v25
    v_sub_f32 v68, v68, v25
    v_sub_f32 v69, v69, v25
    v_sub_f32 v70, v70, v25
    v_sub_f32 v71, v71, v25
    v_sub_f32 v72, v72, v25
    v_sub_f32 v73, v73, v25
    v_sub_f32 v74, v74, v25
    v_sub_f32 v75, v75, v25
    v_sub_f32 v76, v76, v25
    v_sub_f32 v77, v77, v25
    v_sub_f32 v78, v78, v25
    v_sub_f32 v79, v79, v25
    v_sub_f32 v80, v80, v25
    v_sub_f32 v81, v81, v25
    v_sub_f32 v82, v82, v25
    v_sub_f32 v83, v83, v25
    v_sub_f32 v84, v84, v25
    v_sub_f32 v85, v85, v25
    v_sub_f32 v86, v86, v25
    v_sub_f32 v87, v87, v25
    v_sub_f32 v88, v88, v25
    v_sub_f32 v89, v89, v25
    v_sub_f32 v90, v90, v25
    v_sub_f32 v91, v91, v25
    v_sub_f32 v92, v92, v25
    v_sub_f32 v93, v93, v25
    v_sub_f32 v94, v94, v25
    v_sub_f32 v95, v95, v25
    v_sub_f32 v144, v144, v25
    v_sub_f32 v145, v145, v25
    v_sub_f32 v146, v146, v25
    v_sub_f32 v147, v147, v25
    v_sub_f32 v148, v148, v25
    v_sub_f32 v149, v149, v25
    v_sub_f32 v150, v150, v25
    v_sub_f32 v151, v151, v25
    v_sub_f32 v152, v152, v25
    v_sub_f32 v153, v153, v25
    v_sub_f32 v154, v154, v25
    v_sub_f32 v155, v155, v25
    v_sub_f32 v156, v156, v25
    v_sub_f32 v157, v157, v25
    v_sub_f32 v158, v158, v25
    v_sub_f32 v159, v159, v25
    v_mul_f32 v6, v6, v26
    v_mul_f32 v7, v7, v26
    v_mul_f32 v8, v8, v26
    v_mul_f32 v9, v9, v26
    v_mul_f32 v160, v160, v26
    v_mul_f32 v161, v161, v26
    v_mul_f32 v162, v162, v26
    v_mul_f32 v163, v163, v26
    v_mul_f32 v164, v164, v26
    v_mul_f32 v165, v165, v26
    v_mul_f32 v166, v166, v26
    v_mul_f32 v167, v167, v26
    v_mul_f32 v168, v168, v26
    v_mul_f32 v169, v169, v26
    v_mul_f32 v170, v170, v26
    v_mul_f32 v171, v171, v26
    v_mul_f32 v172, v172, v26
    v_mul_f32 v173, v173, v26
    v_mul_f32 v174, v174, v26
    v_mul_f32 v175, v175, v26
    v_mul_f32 v176, v176, v26
    v_mul_f32 v177, v177, v26
    v_mul_f32 v178, v178, v26
    v_mul_f32 v179, v179, v26
    v_mul_f32 v180, v180, v26
    v_mul_f32 v181, v181, v26
    v_mul_f32 v182, v182, v26
    v_mul_f32 v183, v183, v26
    v_mul_f32 v184, v184, v26
    v_mul_f32 v185, v185, v26
    v_mul_f32 v186, v186, v26
    v_mul_f32 v187, v187, v26
    v_mul_f32 v188, v188, v26
    v_mul_f32 v189, v189, v26
    v_mul_f32 v190, v190, v26
    v_mul_f32 v191, v191, v26
    v_mul_f32 v192, v192, v26
    v_mul_f32 v193, v193, v26
    v_mul_f32 v194, v194, v26
    v_mul_f32 v195, v195, v26
    v_mul_f32 v196, v196, v26
    v_mul_f32 v197, v197, v26
    v_mul_f32 v198, v198, v26
    v_mul_f32 v199, v199, v26
    v_mul_f32 v200, v200, v26
    v_mul_f32 v201, v201, v26
    v_mul_f32 v202, v202, v26
    v_mul_f32 v203, v203, v26
    v_mul_f32 v204, v204, v26
    v_mul_f32 v205, v205, v26
    v_mul_f32 v206, v206, v26
    v_mul_f32 v207, v207, v26
    v_mul_f32 v208, v208, v26
    v_mul_f32 v209, v209, v26
    v_mul_f32 v210, v210, v26
    v_mul_f32 v211, v211, v26
    v_mul_f32 v212, v212, v26
    v_mul_f32 v213, v213, v26
    v_mul_f32 v214, v214, v26
    v_mul_f32 v215, v215, v26
    v_mul_f32 v216, v216, v26
    v_mul_f32 v217, v217, v26
    v_mul_f32 v218, v218, v26
    v_mul_f32 v219, v219, v26
    v_mul_f32 v220, v220, v26
    v_mul_f32 v221, v221, v26
    v_mul_f32 v222, v222, v26
    v_mul_f32 v223, v223, v26
    s_nop 1
    s_branch K2_ret_L3
K2_resc_M1:
    v_mov_b32 v24, v4
    s_nop 1
    v_permlane32_swap_b32 v4, v24
    v_max_f32 v25, v4, v24
    v_max_f32 v25, 0, v25
    v_exp_f32 v26, -v25
    s_nop 15
    v_sub_f32 v96, v96, v25
    v_sub_f32 v97, v97, v25
    v_sub_f32 v98, v98, v25
    v_sub_f32 v99, v99, v25
    v_sub_f32 v100, v100, v25
    v_sub_f32 v101, v101, v25
    v_sub_f32 v102, v102, v25
    v_sub_f32 v103, v103, v25
    v_sub_f32 v104, v104, v25
    v_sub_f32 v105, v105, v25
    v_sub_f32 v106, v106, v25
    v_sub_f32 v107, v107, v25
    v_sub_f32 v108, v108, v25
    v_sub_f32 v109, v109, v25
    v_sub_f32 v110, v110, v25
    v_sub_f32 v111, v111, v25
    v_sub_f32 v112, v112, v25
    v_sub_f32 v113, v113, v25
    v_sub_f32 v114, v114, v25
    v_sub_f32 v115, v115, v25
    v_sub_f32 v116, v116, v25
    v_sub_f32 v117, v117, v25
    v_sub_f32 v118, v118, v25
    v_sub_f32 v119, v119, v25
    v_sub_f32 v120, v120, v25
    v_sub_f32 v121, v121, v25
    v_sub_f32 v122, v122, v25
    v_sub_f32 v123, v123, v25
    v_sub_f32 v124, v124, v25
    v_sub_f32 v125, v125, v25
    v_sub_f32 v126, v126, v25
    v_sub_f32 v127, v127, v25
    v_sub_f32 v144, v144, v25
    v_sub_f32 v145, v145, v25
    v_sub_f32 v146, v146, v25
    v_sub_f32 v147, v147, v25
    v_sub_f32 v148, v148, v25
    v_sub_f32 v149, v149, v25
    v_sub_f32 v150, v150, v25
    v_sub_f32 v151, v151, v25
    v_sub_f32 v152, v152, v25
    v_sub_f32 v153, v153, v25
    v_sub_f32 v154, v154, v25
    v_sub_f32 v155, v155, v25
    v_sub_f32 v156, v156, v25
    v_sub_f32 v157, v157, v25
    v_sub_f32 v158, v158, v25
    v_sub_f32 v159, v159, v25
    v_mul_f32 v6, v6, v26
    v_mul_f32 v7, v7, v26
    v_mul_f32 v8, v8, v26
    v_mul_f32 v9, v9, v26
    v_mul_f32 v160, v160, v26
    v_mul_f32 v161, v161, v26
    v_mul_f32 v162, v162, v26
    v_mul_f32 v163, v163, v26
    v_mul_f32 v164, v164, v26
    v_mul_f32 v165, v165, v26
    v_mul_f32 v166, v166, v26
    v_mul_f32 v167, v167, v26
    v_mul_f32 v168, v168, v26
    v_mul_f32 v169, v169, v26
    v_mul_f32 v170, v170, v26
    v_mul_f32 v171, v171, v26
    v_mul_f32 v172, v172, v26
    v_mul_f32 v173, v173, v26
    v_mul_f32 v174, v174, v26
    v_mul_f32 v175, v175, v26
    v_mul_f32 v176, v176, v26
    v_mul_f32 v177, v177, v26
    v_mul_f32 v178, v178, v26
    v_mul_f32 v179, v179, v26
    v_mul_f32 v180, v180, v26
    v_mul_f32 v181, v181, v26
    v_mul_f32 v182, v182, v26
    v_mul_f32 v183, v183, v26
    v_mul_f32 v184, v184, v26
    v_mul_f32 v185, v185, v26
    v_mul_f32 v186, v186, v26
    v_mul_f32 v187, v187, v26
    v_mul_f32 v188, v188, v26
    v_mul_f32 v189, v189, v26
    v_mul_f32 v190, v190, v26
    v_mul_f32 v191, v191, v26
    v_mul_f32 v192, v192, v26
    v_mul_f32 v193, v193, v26
    v_mul_f32 v194, v194, v26
    v_mul_f32 v195, v195, v26
    v_mul_f32 v196, v196, v26
    v_mul_f32 v197, v197, v26
    v_mul_f32 v198, v198, v26
    v_mul_f32 v199, v199, v26
    v_mul_f32 v200, v200, v26
    v_mul_f32 v201, v201, v26
    v_mul_f32 v202, v202, v26
    v_mul_f32 v203, v203, v26
    v_mul_f32 v204, v204, v26
    v_mul_f32 v205, v205, v26
    v_mul_f32 v206, v206, v26
    v_mul_f32 v207, v207, v26
    v_mul_f32 v208, v208, v26
    v_mul_f32 v209, v209, v26
    v_mul_f32 v210, v210, v26
    v_mul_f32 v211, v211, v26
    v_mul_f32 v212, v212, v26
    v_mul_f32 v213, v213, v26
    v_mul_f32 v214, v214, v26
    v_mul_f32 v215, v215, v26
    v_mul_f32 v216, v216, v26
    v_mul_f32 v217, v217, v26
    v_mul_f32 v218, v218, v26
    v_mul_f32 v219, v219, v26
    v_mul_f32 v220, v220, v26
    v_mul_f32 v221, v221, v26
    v_mul_f32 v222, v222, v26
    v_mul_f32 v223, v223, v26
    s_nop 1
    s_branch K2_ret_M1
K2_resc_M2:
    v_mov_b32 v24, v4
    s_nop 1
    v_permlane32_swap_b32 v4, v24
    v_max_f32 v25, v4, v24
    v_max_f32 v25, 0, v25
    v_exp_f32 v26, -v25
    s_nop 15
    v_sub_f32 v64, v64, v25
    v_sub_f32 v65, v65, v25
    v_sub_f32 v66, v66, v25
    v_sub_f32 v67, v67, v25
    v_sub_f32 v68, v68, v25
    v_sub_f32 v69, v69, v25
    v_sub_f32 v70, v70, v25
    v_sub_f32 v71, v71, v25
    v_sub_f32 v72, v72, v25
    v_sub_f32 v73, v73, v25
    v_sub_f32 v74, v74, v25
    v_sub_f32 v75, v75, v25
    v_sub_f32 v76, v76, v25
    v_sub_f32 v77, v77, v25
    v_sub_f32 v78, v78, v25
    v_sub_f32 v79, v79, v25
    v_sub_f32 v80, v80, v25
    v_sub_f32 v81, v81, v25
    v_sub_f32 v82, v82, v25
    v_sub_f32 v83, v83, v25
    v_sub_f32 v84, v84, v25
    v_sub_f32 v85, v85, v25
    v_sub_f32 v86, v86, v25
    v_sub_f32 v87, v87, v25
    v_sub_f32 v88, v88, v25
    v_sub_f32 v89, v89, v25
    v_sub_f32 v90, v90, v25
    v_sub_f32 v91, v91, v25
    v_sub_f32 v92, v92, v25
    v_sub_f32 v93, v93, v25
    v_sub_f32 v94, v94, v25
    v_sub_f32 v95, v95, v25
    v_sub_f32 v144, v144, v25
    v_sub_f32 v145, v145, v25
    v_sub_f32 v146, v146, v25
    v_sub_f32 v147, v147, v25
    v_sub_f32 v148, v148, v25
    v_sub_f32 v149, v149, v25
    v_sub_f32 v150, v150, v25
    v_sub_f32 v151, v151, v25
    v_sub_f32 v152, v152, v25
    v_sub_f32 v153, v153, v25
    v_sub_f32 v154, v154, v25
    v_sub_f32 v155, v155, v25
    v_sub_f32 v156, v156, v25
    v_sub_f32 v157, v157, v25
    v_sub_f32 v158, v158, v25
    v_sub_f32 v159, v159, v25
    v_mul_f32 v6, v6, v26
    v_mul_f32 v7, v7, v26
    v_mul_f32 v8, v8, v26
    v_mul_f32 v9, v9, v26
    v_mul_f32 v160, v160, v26
    v_mul_f32 v161, v161, v26
    v_mul_f32 v162, v162, v26
    v_mul_f32 v163, v163, v26
    v_mul_f32 v164, v164, v26
    v_mul_f32 v165, v165, v26
    v_mul_f32 v166, v166, v26
    v_mul_f32 v167, v167, v26
    v_mul_f32 v168, v168, v26
    v_mul_f32 v169, v169, v26
    v_mul_f32 v170, v170, v26
    v_mul_f32 v171, v171, v26
    v_mul_f32 v172, v172, v26
    v_mul_f32 v173, v173, v26
    v_mul_f32 v174, v174, v26
    v_mul_f32 v175, v175, v26
    v_mul_f32 v176, v176, v26
    v_mul_f32 v177, v177, v26
    v_mul_f32 v178, v178, v26
    v_mul_f32 v179, v179, v26
    v_mul_f32 v180, v180, v26
    v_mul_f32 v181, v181, v26
    v_mul_f32 v182, v182, v26
    v_mul_f32 v183, v183, v26
    v_mul_f32 v184, v184, v26
    v_mul_f32 v185, v185, v26
    v_mul_f32 v186, v186, v26
    v_mul_f32 v187, v187, v26
    v_mul_f32 v188, v188, v26
    v_mul_f32 v189, v189, v26
    v_mul_f32 v190, v190, v26
    v_mul_f32 v191, v191, v26
    v_mul_f32 v192, v192, v26
    v_mul_f32 v193, v193, v26
    v_mul_f32 v194, v194, v26
    v_mul_f32 v195, v195, v26
    v_mul_f32 v196, v196, v26
    v_mul_f32 v197, v197, v26
    v_mul_f32 v198, v198, v26
    v_mul_f32 v199, v199, v26
    v_mul_f32 v200, v200, v26
    v_mul_f32 v201, v201, v26
    v_mul_f32 v202, v202, v26
    v_mul_f32 v203, v203, v26
    v_mul_f32 v204, v204, v26
    v_mul_f32 v205, v205, v26
    v_mul_f32 v206, v206, v26
    v_mul_f32 v207, v207, v26
    v_mul_f32 v208, v208, v26
    v_mul_f32 v209, v209, v26
    v_mul_f32 v210, v210, v26
    v_mul_f32 v211, v211, v26
    v_mul_f32 v212, v212, v26
    v_mul_f32 v213, v213, v26
    v_mul_f32 v214, v214, v26
    v_mul_f32 v215, v215, v26
    v_mul_f32 v216, v216, v26
    v_mul_f32 v217, v217, v26
    v_mul_f32 v218, v218, v26
    v_mul_f32 v219, v219, v26
    v_mul_f32 v220, v220, v26
    v_mul_f32 v221, v221, v26
    v_mul_f32 v222, v222, v26
    v_mul_f32 v223, v223, v26
    s_nop 1
    s_branch K2_ret_M2
K2_done:
    s_waitcnt vmcnt(0)
    s_waitcnt lgkmcnt(0)
K2_end:
    s_endpgm
.text
.globl k3b_kernel
.p2align 8
.type k3b_kernel,@function
k3b_kernel:
    s_cmp_ge_u32 s2, 256
    s_cbranch_scc1 K3_end
    s_load_dwordx2 s[64:65], s[0:1], 24
    s_load_dwordx2 s[66:67], s[0:1], 72
    s_load_dwordx2 s[68:69], s[0:1], 88
    s_load_dwordx2 s[70:71], s[0:1], 104
    v_lshrrev_b32 v10, 6, v0
    v_and_b32 v0, 63, v0
    s_and_b32 s47, s2, 3
    s_lshr_b32 s57, s2, 2
    v_readfirstlane_b32 s46, v10
    s_and_b32 s48, s57, 1
    s_lshl_b32 s48, s48, 3
    s_bfe_u32 s55, s57, 0x30001
    s_add_u32 s48, s48, s55
    s_lshr_b32 s49, s57, 4
    v_lshlrev_b32 v1, 4, v0
    s_lshl_b32 s55, s48, 2
    s_add_u32 s55, s55, s46
    s_mul_i32 s55, s55, 294912
    s_lshl_b32 s56, s47, 16
    s_add_u32 s50, s55, s56
    s_add_u32 s50, s50, 56623104
    s_lshl_b32 s51, s47, 20
    s_lshl_b32 s55, s46, 14
    s_add_u32 s51, s51, s55
    s_lshl_b32 s55, s49, 8
    s_add_u32 s51, s51, s55
    s_add_u32 s52, s51, 128
    s_lshl_b32 s53, s46, 12
    s_add_u32 s58, s53, 16384
    v_bfe_u32 v10, v0, 4, 1
    v_lshlrev_b32 v10, 2, v10
    v_and_b32 v11, 7, v0
    v_xor_b32 v10, v10, v11
    v_lshlrev_b32 v10, 4, v10
    v_lshrrev_b32 v11, 3, v0
    v_lshl_add_u32 v2, v11, 10, v10
    v_add_u32 v3, 7168, v2
    s_waitcnt lgkmcnt(0)
    s_mov_b32 s8, s70
    s_and_b32 s9, s71, 0xffff
    s_mov_b32 s10, 0x10000000
    s_mov_b32 s11, 0x20000
    s_mov_b32 s12, s66
    s_and_b32 s13, s67, 0xffff
    s_mov_b32 s14, 0x400000
    s_mov_b32 s15, 0x20000
    s_mov_b32 s16, s64
    s_and_b32 s17, s65, 0xffff
    s_mov_b32 s18, 0x80000
    s_mov_b32 s19, 0x20000
    s_mov_b32 s20, s68
    s_and_b32 s21, s69, 0xffff
    s_mov_b32 s22, 0x200000
    s_mov_b32 s23, 0x20000
    s_cmp_eq_u32 s46, 4
    s_cbranch_scc1 K3_helper
    s_add_u32 m0, s53, 0
    s_nop 0
    buffer_load_dwordx4 v1, s[8:11], s50 offen lds
    buffer_load_dwordx4 v1, s[8:11], s50 offen offset:1024 lds
    buffer_load_dwordx4 v1, s[8:11], s50 offen offset:2048 lds
    buffer_load_dwordx4 v1, s[8:11], s50 offen offset:3072 lds
    s_add_u32 s50, s50, 4096
    s_add_u32 m0, s58, 0
    s_nop 0
    buffer_load_dwordx4 v2, s[12:15], s51 offen lds
    buffer_load_dwordx4 v3, s[12:15], s51 offen offset:1024 lds
    s_add_u32 m0, s58, 2048
    s_nop 0
    buffer_load_dwordx4 v2, s[12:15], s52 offen lds
    buffer_load_dwordx4 v3, s[12:15], s52 offen offset:1024 lds
    s_add_u32 s51, s51, 65536
    s_add_u32 s52, s52, 65536
    s_add_u32 m0, s53, 32768
    s_nop 0
    buffer_load_dwordx4 v1, s[8:11], s50 offen lds
    buffer_load_dwordx4 v1, s[8:11], s50 offen offset:1024 lds
    buffer_load_dwordx4 v1, s[8:11], s50 offen offset:2048 lds
    buffer_load_dwordx4 v1, s[8:11], s50 offen offset:3072 lds
    s_add_u32 s50, s50, 4096
    s_add_u32 m0, s58, 32768
    s_nop 0
    buffer_load_dwordx4 v2, s[12:15], s51 offen lds
    buffer_load_dwordx4 v3, s[12:15], s51 offen offset:1024 lds
    s_add_u32 m0, s58, 34816
    s_nop 0
    buffer_load_dwordx4 v2, s[12:15], s52 offen lds
    buffer_load_dwordx4 v3, s[12:15], s52 offen offset:1024 lds
    s_add_u32 s51, s51, 65536
    s_add_u32 s52, s52, 65536
    s_add_u32 m0, s53, 65536
    s_nop 0
    buffer_load_dwordx4 v1, s[8:11], s50 offen lds
    buffer_load_dwordx4 v1, s[8:11], s50 offen offset:1024 lds
    buffer_load_dwordx4 v1, s[8:11], s50 offen offset:2048 lds
    buffer_load_dwordx4 v1, s[8:11], s50 offen offset:3072 lds
    s_add_u32 s50, s50, 4096
    s_add_u32 m0, s58, 65536
    s_nop 0
    buffer_load_dwordx4 v2, s[12:15], s51 offen lds
    buffer_load_dwordx4 v3, s[12:15], s51 offen offset:1024 lds
    s_add_u32 m0, s58, 67584
    s_nop 0
    buffer_load_dwordx4 v2, s[12:15], s52 offen lds
    buffer_load_dwordx4 v3, s[12:15], s52 offen offset:1024 lds
    s_add_u32 s51, s51, 65536
    s_add_u32 s52, s52, 65536
    s_add_u32 m0, s53, 98304
    s_nop 0
    buffer_load_dwordx4 v1, s[8:11], s50 offen lds
    buffer_load_dwordx4 v1, s[8:11], s50 offen offset:1024 lds
    buffer_load_dwordx4 v1, s[8:11], s50 offen offset:2048 lds
    buffer_load_dwordx4 v1, s[8:11], s50 offen offset:3072 lds
    s_add_u32 s50, s50, 4096
    s_lshr_b32 s55, s46, 1
    s_lshl_b32 s55, s55, 13
    v_add_u32 v4, s55, v1
    v_add_u32 v5, 0x10000, v4
    v_lshrrev_b32 v10, 5, v0
    v_lshlrev_b32 v10, 2, v10
    v_bfe_u32 v11, v0, 2, 2
    v_add_u32 v10, v10, v11
    v_lshlrev_b32 v10, 7, v10
    v_bfe_u32 v11, v0, 4, 1
    v_lshl_add_u32 v10, v11, 5, v10
    v_bfe_u32 v11, v0, 1, 1
    v_lshl_add_u32 v10, v11, 4, v10
    v_and_b32 v11, 1, v0
    v_lshl_add_u32 v10, v11, 3, v10
    s_and_b32 s55, s46, 1
    s_lshl_b32 s55, s55, 11
    s_add_u32 s55, s55, 16384
    v_add_u32 v10, s55, v10
    v_bfe_u32 v11, v0, 3, 1
    v_lshl_add_u32 v6, v11, 6, v10
    v_xor_b32 v11, 1, v11
    v_lshl_add_u32 v8, v11, 6, v10
    v_add_u32 v7, 0x10000, v6
    v_add_u32 v9, 0x10000, v8
    v_mov_b32 v16, 0
    v_mov_b32 v17, 0
    v_mov_b32 v18, 0
    v_mov_b32 v19, 0
    v_mov_b32 v20, 0
    v_mov_b32 v21, 0
    v_mov_b32 v22, 0
    v_mov_b32 v23, 0
    v_mov_b32 v24, 0
    v_mov_b32 v25, 0
    v_mov_b32 v26, 0
    v_mov_b32 v27, 0
    v_mov_b32 v28, 0
    v_mov_b32 v29, 0
    v_mov_b32 v30, 0
    v_mov_b32 v31, 0
    v_mov_b32 v32, 0
    v_mov_b32 v33, 0
    v_mov_b32 v34, 0
    v_mov_b32 v35, 0
    v_mov_b32 v36, 0
    v_mov_b32 v37, 0
    v_mov_b32 v38, 0
    v_mov_b32 v39, 0
    v_mov_b32 v40, 0
    v_mov_b32 v41, 0
    v_mov_b32 v42, 0
    v_mov_b32 v43, 0
    v_mov_b32 v44, 0
    v_mov_b32 v45, 0
    v_mov_b32 v46, 0
    v_mov_b32 v47, 0
    v_mov_b32 v48, 0
    v_mov_b32 v49, 0
    v_mov_b32 v50, 0
    v_mov_b32 v51, 0
    v_mov_b32 v52, 0
    v_mov_b32 v53, 0
    v_mov_b32 v54, 0
    v_mov_b32 v55, 0
    v_mov_b32 v56, 0
    v_mov_b32 v57, 0
    v_mov_b32 v58, 0
    v_mov_b32 v59, 0
    v_mov_b32 v60, 0
    v_mov_b32 v61, 0
    v_mov_b32 v62, 0
    v_mov_b32 v63, 0
    v_mov_b32 v64, 0
    v_mov_b32 v65, 0
    v_mov_b32 v66, 0
    v_mov_b32 v67, 0
    v_mov_b32 v68, 0
    v_mov_b32 v69, 0
    v_mov_b32 v70, 0
    v_mov_b32 v71, 0
    v_mov_b32 v72, 0
    v_mov_b32 v73, 0
    v_mov_b32 v74, 0
    v_mov_b32 v75, 0
    v_mov_b32 v76, 0
    v_mov_b32 v77, 0
    v_mov_b32 v78, 0
    v_mov_b32 v79, 0
    s_waitcnt vmcnt(20)
    s_barrier
    ds_read_b128 v[80:83], v4 offset:0
    ds_read_b64_tr_b16 v[88:89], v6 offset:0
    ds_read_b64_tr_b16 v[90:91], v6 offset:1024
    ds_read_b128 v[84:87], v4 offset:4096
    ds_read_b64_tr_b16 v[92:93], v8 offset:0
    ds_read_b64_tr_b16 v[94:95], v8 offset:1024
    ds_read_b128 v[96:99], v4 offset:1024
    ds_read_b64_tr_b16 v[104:105], v6 offset:4096
    ds_read_b64_tr_b16 v[106:107], v6 offset:5120
    ds_read_b128 v[100:103], v4 offset:5120
    ds_read_b64_tr_b16 v[108:109], v8 offset:4096
    ds_read_b64_tr_b16 v[110:111], v8 offset:5120
    s_mov_b32 s54, 3
.p2align 6
K3_loop:
    s_waitcnt lgkmcnt(6)
    v_mfma_f32_32x32x16_bf16 v[16:31], v[88:91], v[80:83], v[16:31]
    ds_read_b128 v[112:115], v4 offset:2048
    ds_read_b64_tr_b16 v[120:121], v6 offset:8192
    s_add_u32 m0, s58, 98304
    s_nop 0
    buffer_load_dwordx4 v2, s[12:15], s51 offen lds
    v_mfma_f32_32x32x16_bf16 v[32:47], v[92:95], v[80:83], v[32:47]
    ds_read_b64_tr_b16 v[122:123], v6 offset:9216
    ds_read_b128 v[116:119], v4 offset:6144
    v_mfma_f32_32x32x16_bf16 v[48:63], v[88:91], v[84:87], v[48:63]
    ds_read_b64_tr_b16 v[124:125], v8 offset:8192
    ds_read_b64_tr_b16 v[126:127], v8 offset:9216
    buffer_load_dwordx4 v3, s[12:15], s51 offen offset:1024 lds
    v_mfma_f32_32x32x16_bf16 v[64:79], v[92:95], v[84:87], v[64:79]
    s_waitcnt lgkmcnt(6)
    v_mfma_f32_32x32x16_bf16 v[16:31], v[104:107], v[96:99], v[16:31]
    ds_read_b128 v[128:131], v4 offset:3072
    ds_read_b64_tr_b16 v[136:137], v6 offset:12288
    s_add_u32 m0, s58, 100352
    s_nop 0
    buffer_load_dwordx4 v2, s[12:15], s52 offen lds
    v_mfma_f32_32x32x16_bf16 v[32:47], v[108:111], v[96:99], v[32:47]
    ds_read_b64_tr_b16 v[138:139], v6 offset:13312
    ds_read_b128 v[132:135], v4 offset:7168
    v_mfma_f32_32x32x16_bf16 v[48:63], v[104:107], v[100:103], v[48:63]
    ds_read_b64_tr_b16 v[140:141], v8 offset:12288
    ds_read_b64_tr_b16 v[142:143], v8 offset:13312
    buffer_load_dwordx4 v3, s[12:15], s52 offen offset:1024 lds
    s_add_u32 s51, s51, 65536
    s_add_u32 s52, s52, 65536
    v_mfma_f32_32x32x16_bf16 v[64:79], v[108:111], v[100:103], v[64:79]
    s_waitcnt vmcnt(16) lgkmcnt(0)
    s_barrier
    v_mfma_f32_32x32x16_bf16 v[16:31], v[120:123], v[112:115], v[16:31]
    ds_read_b128 v[80:83], v4 offset:32768
    ds_read_b64_tr_b16 v[88:89], v6 offset:32768
    s_add_u32 m0, s53, 0
    s_nop 0
    buffer_load_dwordx4 v1, s[8:11], s50 offen lds
    v_mfma_f32_32x32x16_bf16 v[32:47], v[124:127], v[112:115], v[32:47]
    ds_read_b64_tr_b16 v[90:91], v6 offset:33792
    ds_read_b128 v[84:87], v4 offset:36864
    v_mfma_f32_32x32x16_bf16 v[48:63], v[120:123], v[116:119], v[48:63]
    ds_read_b64_tr_b16 v[92:93], v8 offset:32768
    ds_read_b64_tr_b16 v[94:95], v8 offset:33792
    buffer_load_dwordx4 v1, s[8:11], s50 offen offset:1024 lds
    v_mfma_f32_32x32x16_bf16 v[64:79], v[124:127], v[116:119], v[64:79]
    s_waitcnt lgkmcnt(6)
    v_mfma_f32_32x32x16_bf16 v[16:31], v[136:139], v[128:131], v[16:31]
    ds_read_b128 v[96:99], v4 offset:33792
    ds_read_b64_tr_b16 v[104:105], v6 offset:36864
    buffer_load_dwordx4 v1, s[8:11], s50 offen offset:2048 lds
    v_mfma_f32_32x32x16_bf16 v[32:47], v[140:143], v[128:131], v[32:47]
    ds_read_b64_tr_b16 v[106:107], v6 offset:37888
    ds_read_b128 v[100:103], v4 offset:37888
    v_mfma_f32_32x32x16_bf16 v[48:63], v[136:139], v[132:135], v[48:63]
    ds_read_b64_tr_b16 v[108:109], v8 offset:36864
    ds_read_b64_tr_b16 v[110:111], v8 offset:37888
    buffer_load_dwordx4 v1, s[8:11], s50 offen offset:3072 lds
    s_add_u32 s50, s50, 4096
    v_mfma_f32_32x32x16_bf16 v[64:79], v[140:143], v[132:135], v[64:79]
    s_waitcnt lgkmcnt(6)
    v_mfma_f32_32x32x16_bf16 v[16:31], v[88:91], v[80:83], v[16:31]
    ds_read_b128 v[112:115], v4 offset:34816
    ds_read_b64_tr_b16 v[120:121], v6 offset:40960
    s_add_u32 m0, s58, 0
    s_nop 0
    buffer_load_dwordx4 v2, s[12:15], s51 offen lds
    v_mfma_f32_32x32x16_bf16 v[32:47], v[92:95], v[80:83], v[32:47]
    ds_read_b64_tr_b16 v[122:123], v6 offset:41984
    ds_read_b128 v[116:119], v4 offset:38912
    v_mfma_f32_32x32x16_bf16 v[48:63], v[88:91], v[84:87], v[48:63]
    ds_read_b64_tr_b16 v[124:125], v8 offset:40960
    ds_read_b64_tr_b16 v[126:127], v8 offset:41984
    buffer_load_dwordx4 v3, s[12:15], s51 offen offset:1024 lds
    v_mfma_f32_32x32x16_bf16 v[64:79], v[92:95], v[84:87], v[64:79]
    s_waitcnt lgkmcnt(6)
    v_mfma_f32_32x32x16_bf16 v[16:31], v[104:107], v[96:99], v[16:31]
    ds_read_b128 v[128:131], v4 offset:35840
    ds_read_b64_tr_b16 v[136:137], v6 offset:45056
    s_add_u32 m0, s58, 2048
    s_nop 0
    buffer_load_dwordx4 v2, s[12:15], s52 offen lds
    v_mfma_f32_32x32x16_bf16 v[32:47], v[108:111], v[96:99], v[32:47]
    ds_read_b64_tr_b16 v[138:139], v6 offset:46080
    ds_read_b128 v[132:135], v4 offset:39936
    v_mfma_f32_32x32x16_bf16 v[48:63], v[104:107], v[100:103], v[48:63]
    ds_read_b64_tr_b16 v[140:141], v8 offset:45056
    ds_read_b64_tr_b16 v[142:143], v8 offset:46080
    buffer_load_dwordx4 v3, s[12:15], s52 offen offset:1024 lds
    s_add_u32 s51, s51, 65536
    s_add_u32 s52, s52, 65536
    v_mfma_f32_32x32x16_bf16 v[64:79], v[108:111], v[100:103], v[64:79]
    s_waitcnt vmcnt(16) lgkmcnt(0)
    s_barrier
    v_mfma_f32_32x32x16_bf16 v[16:31], v[120:123], v[112:115], v[16:31]
    ds_read_b128 v[80:83], v5 offset:0
    ds_read_b64_tr_b16 v[88:89], v7 offset:0
    s_add_u32 m0, s53, 32768
    s_nop 0
    buffer_load_dwordx4 v1, s[8:11], s50 offen lds
    v_mfma_f32_32x32x16_bf16 v[32:47], v[124:127], v[112:115], v[32:47]
    ds_read_b64_tr_b16 v[90:91], v7 offset:1024
    ds_read_b128 v[84:87], v5 offset:4096
    v_mfma_f32_32x32x16_bf16 v[48:63], v[120:123], v[116:119], v[48:63]
    ds_read_b64_tr_b16 v[92:93], v9 offset:0
    ds_read_b64_tr_b16 v[94:95], v9 offset:1024
    buffer_load_dwordx4 v1, s[8:11], s50 offen offset:1024 lds
    v_mfma_f32_32x32x16_bf16 v[64:79], v[124:127], v[116:119], v[64:79]
    s_waitcnt lgkmcnt(6)
    v_mfma_f32_32x32x16_bf16 v[16:31], v[136:139], v[128:131], v[16:31]
    ds_read_b128 v[96:99], v5 offset:1024
    ds_read_b64_tr_b16 v[104:105], v7 offset:4096
    buffer_load_dwordx4 v1, s[8:11], s50 offen offset:2048 lds
    v_mfma_f32_32x32x16_bf16 v[32:47], v[140:143], v[128:131], v[32:47]
    ds_read_b64_tr_b16 v[106:107], v7 offset:5120
    ds_read_b128 v[100:103], v5 offset:5120
    v_mfma_f32_32x32x16_bf16 v[48:63], v[136:139], v[132:135], v[48:63]
    ds_read_b64_tr_b16 v[108:109], v9 offset:4096
    ds_read_b64_tr_b16 v[110:111], v9 offset:5120
    buffer_load_dwordx4 v1, s[8:11], s50 offen offset:3072 lds
    s_add_u32 s50, s50, 4096
    v_mfma_f32_32x32x16_bf16 v[64:79], v[140:143], v[132:135], v[64:79]
    s_waitcnt lgkmcnt(6)
    v_mfma_f32_32x32x16_bf16 v[16:31], v[88:91], v[80:83], v[16:31]
    ds_read_b128 v[112:115], v5 offset:2048
    ds_read_b64_tr_b16 v[120:121], v7 offset:8192
    s_add_u32 m0, s58, 32768
    s_nop 0
    buffer_load_dwordx4 v2, s[12:15], s51 offen lds
    v_mfma_f32_32x32x16_bf16 v[32:47], v[92:95], v[80:83], v[32:47]
    ds_read_b64_tr_b16 v[122:123], v7 offset:9216
    ds_read_b128 v[116:119], v5 offset:6144
    v_mfma_f32_32x32x16_bf16 v[48:63], v[88:91], v[84:87], v[48:63]
    ds_read_b64_tr_b16 v[124:125], v9 offset:8192
    ds_read_b64_tr_b16 v[126:127], v9 offset:9216
    buffer_load_dwordx4 v3, s[12:15], s51 offen offset:1024 lds
    v_mfma_f32_32x32x16_bf16 v[64:79], v[92:95], v[84:87], v[64:79]
    s_waitcnt lgkmcnt(6)
    v_mfma_f32_32x32x16_bf16 v[16:31], v[104:107], v[96:99], v[16:31]
    ds_read_b128 v[128:131], v5 offset:3072
    ds_read_b64_tr_b16 v[136:137], v7 offset:12288
    s_add_u32 m0, s58, 34816
    s_nop 0
    buffer_load_dwordx4 v2, s[12:15], s52 offen lds
    v_mfma_f32_32x32x16_bf16 v[32:47], v[108:111], v[96:99], v[32:47]
    ds_read_b64_tr_b16 v[138:139], v7 offset:13312
    ds_read_b128 v[132:135], v5 offset:7168
    v_mfma_f32_32x32x16_bf16 v[48:63], v[104:107], v[100:103], v[48:63]
    ds_read_b64_tr_b16 v[140:141], v9 offset:12288
    ds_read_b64_tr_b16 v[142:143], v9 offset:13312
    buffer_load_dwordx4 v3, s[12:15], s52 offen offset:1024 lds
    s_add_u32 s51, s51, 65536
    s_add_u32 s52, s52, 65536
    v_mfma_f32_32x32x16_bf16 v[64:79], v[108:111], v[100:103], v[64:79]
    s_waitcnt vmcnt(16) lgkmcnt(0)
    s_barrier
    v_mfma_f32_32x32x16_bf16 v[16:31], v[120:123], v[112:115], v[16:31]
    ds_read_b128 v[80:83], v5 offset:32768
    ds_read_b64_tr_b16 v[88:89], v7 offset:32768
    s_add_u32 m0, s53, 65536
    s_nop 0
    buffer_load_dwordx4 v1, s[8:11], s50 offen lds
    v_mfma_f32_32x32x16_bf16 v[32:47], v[124:127], v[112:115], v[32:47]
    ds_read_b64_tr_b16 v[90:91], v7 offset:33792
    ds_read_b128 v[84:87], v5 offset:36864
    v_mfma_f32_32x32x16_bf16 v[48:63], v[120:123], v[116:119], v[48:63]
    ds_read_b64_tr_b16 v[92:93], v9 offset:32768
    ds_read_b64_tr_b16 v[94:95], v9 offset:33792
    buffer_load_dwordx4 v1, s[8:11], s50 offen offset:1024 lds
    v_mfma_f32_32x32x16_bf16 v[64:79], v[124:127], v[116:119], v[64:79]
    s_waitcnt lgkmcnt(6)
    v_mfma_f32_32x32x16_bf16 v[16:31], v[136:139], v[128:131], v[16:31]
    ds_read_b128 v[96:99], v5 offset:33792
    ds_read_b64_tr_b16 v[104:105], v7 offset:36864
    buffer_load_dwordx4 v1, s[8:11], s50 offen offset:2048 lds
    v_mfma_f32_32x32x16_bf16 v[32:47], v[140:143], v[128:131], v[32:47]
    ds_read_b64_tr_b16 v[106:107], v7 offset:37888
    ds_read_b128 v[100:103], v5 offset:37888
    v_mfma_f32_32x32x16_bf16 v[48:63], v[136:139], v[132:135], v[48:63]
    ds_read_b64_tr_b16 v[108:109], v9 offset:36864
    ds_read_b64_tr_b16 v[110:111], v9 offset:37888
    buffer_load_dwordx4 v1, s[8:11], s50 offen offset:3072 lds
    s_add_u32 s50, s50, 4096
    v_mfma_f32_32x32x16_bf16 v[64:79], v[140:143], v[132:135], v[64:79]
    s_waitcnt lgkmcnt(6)
    v_mfma_f32_32x32x16_bf16 v[16:31], v[88:91], v[80:83], v[16:31]
    ds_read_b128 v[112:115], v5 offset:34816
    ds_read_b64_tr_b16 v[120:121], v7 offset:40960
    s_add_u32 m0, s58, 65536
    s_nop 0
    buffer_load_dwordx4 v2, s[12:15], s51 offen lds
    v_mfma_f32_32x32x16_bf16 v[32:47], v[92:95], v[80:83], v[32:47]
    ds_read_b64_tr_b16 v[122:123], v7 offset:41984
    ds_read_b128 v[116:119], v5 offset:38912
    v_mfma_f32_32x32x16_bf16 v[48:63], v[88:91], v[84:87], v[48:63]
    ds_read_b64_tr_b16 v[124:125], v9 offset:40960
    ds_read_b64_tr_b16 v[126:127], v9 offset:41984
    buffer_load_dwordx4 v3, s[12:15], s51 offen offset:1024 lds
    v_mfma_f32_32x32x16_bf16 v[64:79], v[92:95], v[84:87], v[64:79]
    s_waitcnt lgkmcnt(6)
    v_mfma_f32_32x32x16_bf16 v[16:31], v[104:107], v[96:99], v[16:31]
    ds_read_b128 v[128:131], v5 offset:35840
    ds_read_b64_tr_b16 v[136:137], v7 offset:45056
    s_add_u32 m0, s58, 67584
    s_nop 0
    buffer_load_dwordx4 v2, s[12:15], s52 offen lds
    v_mfma_f32_32x32x16_bf16 v[32:47], v[108:111], v[96:99], v[32:47]
    ds_read_b64_tr_b16 v[138:139], v7 offset:46080
    ds_read_b128 v[132:135], v5 offset:39936
    v_mfma_f32_32x32x16_bf16 v[48:63], v[104:107], v[100:103], v[48:63]
    ds_read_b64_tr_b16 v[140:141], v9 offset:45056
    ds_read_b64_tr_b16 v[142:143], v9 offset:46080
    buffer_load_dwordx4 v3, s[12:15], s52 offen offset:1024 lds
    s_add_u32 s51, s51, 65536
    s_add_u32 s52, s52, 65536
    v_mfma_f32_32x32x16_bf16 v[64:79], v[108:111], v[100:103], v[64:79]
    s_waitcnt vmcnt(16) lgkmcnt(0)
    s_barrier
    v_mfma_f32_32x32x16_bf16 v[16:31], v[120:123], v[112:115], v[16:31]
    ds_read_b128 v[80:83], v4 offset:0
    ds_read_b64_tr_b16 v[88:89], v6 offset:0
    s_add_u32 m0, s53, 98304
    s_nop 0
    buffer_load_dwordx4 v1, s[8:11], s50 offen lds
    v_mfma_f32_32x32x16_bf16 v[32:47], v[124:127], v[112:115], v[32:47]
    ds_read_b64_tr_b16 v[90:91], v6 offset:1024
    ds_read_b128 v[84:87], v4 offset:4096
    v_mfma_f32_32x32x16_bf16 v[48:63], v[120:123], v[116:119], v[48:63]
    ds_read_b64_tr_b16 v[92:93], v8 offset:0
    ds_read_b64_tr_b16 v[94:95], v8 offset:1024
    buffer_load_dwordx4 v1, s[8:11], s50 offen offset:1024 lds
    v_mfma_f32_32x32x16_bf16 v[64:79], v[124:127], v[116:119], v[64:79]
    s_waitcnt lgkmcnt(6)
    v_mfma_f32_32x32x16_bf16 v[16:31], v[136:139], v[128:131], v[16:31]
    ds_read_b128 v[96:99], v4 offset:1024
    ds_read_b64_tr_b16 v[104:105], v6 offset:4096
    buffer_load_dwordx4 v1, s[8:11], s50 offen offset:2048 lds
    v_mfma_f32_32x32x16_bf16 v[32:47], v[140:143], v[128:131], v[32:47]
    ds_read_b64_tr_b16 v[106:107], v6 offset:5120
    ds_read_b128 v[100:103], v4 offset:5120
    v_mfma_f32_32x32x16_bf16 v[48:63], v[136:139], v[132:135], v[48:63]
    ds_read_b64_tr_b16 v[108:109], v8 offset:4096
    ds_read_b64_tr_b16 v[110:111], v8 offset:5120
    buffer_load_dwordx4 v1, s[8:11], s50 offen offset:3072 lds
    s_add_u32 s50, s50, 4096
    v_mfma_f32_32x32x16_bf16 v[64:79], v[140:143], v[132:135], v[64:79]
    s_sub_u32 s54, s54, 1
    s_cmp_lg_u32 s54, 0
    s_cbranch_scc1 K3_loop
    s_lshl_b32 s55, s48, 2
    s_add_u32 s55, s55, s46
    s_mul_i32 s55, s55, 294912
    s_lshl_b32 s56, s47, 13
    s_add_u32 s50, s55, s56
    s_add_u32 s50, s50, 56885248
    s_waitcnt lgkmcnt(6)
    v_mfma_f32_32x32x16_bf16 v[16:31], v[88:91], v[80:83], v[16:31]
    ds_read_b128 v[112:115], v4 offset:2048
    ds_read_b64_tr_b16 v[120:121], v6 offset:8192
    s_add_u32 m0, s58, 98304
    s_nop 0
    buffer_load_dwordx4 v2, s[12:15], s51 offen lds
    v_mfma_f32_32x32x16_bf16 v[32:47], v[92:95], v[80:83], v[32:47]
    ds_read_b64_tr_b16 v[122:123], v6 offset:9216
    ds_read_b128 v[116:119], v4 offset:6144
    v_mfma_f32_32x32x16_bf16 v[48:63], v[88:91], v[84:87], v[48:63]
    ds_read_b64_tr_b16 v[124:125], v8 offset:8192
    ds_read_b64_tr_b16 v[126:127], v8 offset:9216
    buffer_load_dwordx4 v3, s[12:15], s51 offen offset:1024 lds
    v_mfma_f32_32x32x16_bf16 v[64:79], v[92:95], v[84:87], v[64:79]
    s_waitcnt lgkmcnt(6)
    v_mfma_f32_32x32x16_bf16 v[16:31], v[104:107], v[96:99], v[16:31]
    ds_read_b128 v[128:131], v4 offset:3072
    ds_read_b64_tr_b16 v[136:137], v6 offset:12288
    s_add_u32 m0, s58, 100352
    s_nop 0
    buffer_load_dwordx4 v2, s[12:15], s52 offen lds
    v_mfma_f32_32x32x16_bf16 v[32:47], v[108:111], v[96:99], v[32:47]
    ds_read_b64_tr_b16 v[138:139], v6 offset:13312
    ds_read_b128 v[132:135], v4 offset:7168
    v_mfma_f32_32x32x16_bf16 v[48:63], v[104:107], v[100:103], v[48:63]
    ds_read_b64_tr_b16 v[140:141], v8 offset:12288
    ds_read_b64_tr_b16 v[142:143], v8 offset:13312
    buffer_load_dwordx4 v3, s[12:15], s52 offen offset:1024 lds
    s_add_u32 s51, s51, 65536
    s_add_u32 s52, s52, 65536
    v_mfma_f32_32x32x16_bf16 v[64:79], v[108:111], v[100:103], v[64:79]
    s_waitcnt vmcnt(16) lgkmcnt(0)
    s_barrier
    v_mfma_f32_32x32x16_bf16 v[16:31], v[120:123], v[112:115], v[16:31]
    ds_read_b128 v[80:83], v4 offset:32768
    ds_read_b64_tr_b16 v[88:89], v6 offset:32768
    s_add_u32 m0, s53, 0
    s_nop 0
    buffer_load_dwordx4 v1, s[8:11], s50 offen lds
    v_mfma_f32_32x32x16_bf16 v[32:47], v[124:127], v[112:115], v[32:47]
    ds_read_b64_tr_b16 v[90:91], v6 offset:33792
    ds_read_b128 v[84:87], v4 offset:36864
    v_mfma_f32_32x32x16_bf16 v[48:63], v[120:123], v[116:119], v[48:63]
    ds_read_b64_tr_b16 v[92:93], v8 offset:32768
    ds_read_b64_tr_b16 v[94:95], v8 offset:33792
    buffer_load_dwordx4 v1, s[8:11], s50 offen offset:1024 lds
    v_mfma_f32_32x32x16_bf16 v[64:79], v[124:127], v[116:119], v[64:79]
    s_waitcnt lgkmcnt(6)
    v_mfma_f32_32x32x16_bf16 v[16:31], v[136:139], v[128:131], v[16:31]
    ds_read_b128 v[96:99], v4 offset:33792
    ds_read_b64_tr_b16 v[104:105], v6 offset:36864
    buffer_load_dwordx4 v1, s[8:11], s50 offen offset:2048 lds
    v_mfma_f32_32x32x16_bf16 v[32:47], v[140:143], v[128:131], v[32:47]
    ds_read_b64_tr_b16 v[106:107], v6 offset:37888
    ds_read_b128 v[100:103], v4 offset:37888
    v_mfma_f32_32x32x16_bf16 v[48:63], v[136:139], v[132:135], v[48:63]
    ds_read_b64_tr_b16 v[108:109], v8 offset:36864
    ds_read_b64_tr_b16 v[110:111], v8 offset:37888
    buffer_load_dwordx4 v1, s[8:11], s50 offen offset:3072 lds
    s_add_u32 s50, s50, 4096
    v_mfma_f32_32x32x16_bf16 v[64:79], v[140:143], v[132:135], v[64:79]
    s_mov_b32 s12, s16
    s_mov_b32 s13, s17
    s_mov_b32 s14, s18
    s_lshl_b32 s51, s47, 17
    s_lshl_b32 s55, s46, 14
    s_add_u32 s51, s51, s55
    s_lshl_b32 s55, s49, 8
    s_add_u32 s51, s51, s55
    s_add_u32 s52, s51, 128
    s_waitcnt lgkmcnt(6)
    v_mfma_f32_32x32x16_bf16 v[16:31], v[88:91], v[80:83], v[16:31]
    ds_read_b128 v[112:115], v4 offset:34816
    ds_read_b64_tr_b16 v[120:121], v6 offset:40960
    s_add_u32 m0, s58, 0
    s_nop 0
    buffer_load_dwordx4 v2, s[12:15], s51 offen lds
    v_mfma_f32_32x32x16_bf16 v[32:47], v[92:95], v[80:83], v[32:47]
    ds_read_b64_tr_b16 v[122:123], v6 offset:41984
    ds_read_b128 v[116:119], v4 offset:38912
    v_mfma_f32_32x32x16_bf16 v[48:63], v[88:91], v[84:87], v[48:63]
    ds_read_b64_tr_b16 v[124:125], v8 offset:40960
    ds_read_b64_tr_b16 v[126:127], v8 offset:41984
    buffer_load_dwordx4 v3, s[12:15], s51 offen offset:1024 lds
    v_mfma_f32_32x32x16_bf16 v[64:79], v[92:95], v[84:87], v[64:79]
    s_waitcnt lgkmcnt(6)
    v_mfma_f32_32x32x16_bf16 v[16:31], v[104:107], v[96:99], v[16:31]
    ds_read_b128 v[128:131], v4 offset:35840
    ds_read_b64_tr_b16 v[136:137], v6 offset:45056
    s_add_u32 m0, s58, 2048
    s_nop 0
    buffer_load_dwordx4 v2, s[12:15], s52 offen lds
    v_mfma_f32_32x32x16_bf16 v[32:47], v[108:111], v[96:99], v[32:47]
    ds_read_b64_tr_b16 v[138:139], v6 offset:46080
    ds_read_b128 v[132:135], v4 offset:39936
    v_mfma_f32_32x32x16_bf16 v[48:63], v[104:107], v[100:103], v[48:63]
    ds_read_b64_tr_b16 v[140:141], v8 offset:45056
    ds_read_b64_tr_b16 v[142:143], v8 offset:46080
    buffer_load_dwordx4 v3, s[12:15], s52 offen offset:1024 lds
    s_add_u32 s51, s51, 65536
    s_add_u32 s52, s52, 65536
    v_mfma_f32_32x32x16_bf16 v[64:79], v[108:111], v[100:103], v[64:79]
    s_waitcnt vmcnt(16) lgkmcnt(0)
    s_barrier
    v_mfma_f32_32x32x16_bf16 v[16:31], v[120:123], v[112:115], v[16:31]
    ds_read_b128 v[80:83], v5 offset:0
    ds_read_b64_tr_b16 v[88:89], v7 offset:0
    s_add_u32 m0, s53, 32768
    s_nop 0
    buffer_load_dwordx4 v1, s[8:11], s50 offen lds
    v_mfma_f32_32x32x16_bf16 v[32:47], v[124:127], v[112:115], v[32:47]
    ds_read_b64_tr_b16 v[90:91], v7 offset:1024
    ds_read_b128 v[84:87], v5 offset:4096
    v_mfma_f32_32x32x16_bf16 v[48:63], v[120:123], v[116:119], v[48:63]
    ds_read_b64_tr_b16 v[92:93], v9 offset:0
    ds_read_b64_tr_b16 v[94:95], v9 offset:1024
    buffer_load_dwordx4 v1, s[8:11], s50 offen offset:1024 lds
    v_mfma_f32_32x32x16_bf16 v[64:79], v[124:127], v[116:119], v[64:79]
    s_waitcnt lgkmcnt(6)
    v_mfma_f32_32x32x16_bf16 v[16:31], v[136:139], v[128:131], v[16:31]
    ds_read_b128 v[96:99], v5 offset:1024
    ds_read_b64_tr_b16 v[104:105], v7 offset:4096
    buffer_load_dwordx4 v1, s[8:11], s50 offen offset:2048 lds
    v_mfma_f32_32x32x16_bf16 v[32:47], v[140:143], v[128:131], v[32:47]
    ds_read_b64_tr_b16 v[106:107], v7 offset:5120
    ds_read_b128 v[100:103], v5 offset:5120
    v_mfma_f32_32x32x16_bf16 v[48:63], v[136:139], v[132:135], v[48:63]
    ds_read_b64_tr_b16 v[108:109], v9 offset:4096
    ds_read_b64_tr_b16 v[110:111], v9 offset:5120
    buffer_load_dwordx4 v1, s[8:11], s50 offen offset:3072 lds
    s_add_u32 s50, s50, 4096
    v_mfma_f32_32x32x16_bf16 v[64:79], v[140:143], v[132:135], v[64:79]
    s_waitcnt lgkmcnt(6)
    v_mfma_f32_32x32x16_bf16 v[16:31], v[88:91], v[80:83], v[16:31]
    ds_read_b128 v[112:115], v5 offset:2048
    ds_read_b64_tr_b16 v[120:121], v7 offset:8192
    s_add_u32 m0, s58, 32768
    s_nop 0
    buffer_load_dwordx4 v2, s[12:15], s51 offen lds
    v_mfma_f32_32x32x16_bf16 v[32:47], v[92:95], v[80:83], v[32:47]
    ds_read_b64_tr_b16 v[122:123], v7 offset:9216
    ds_read_b128 v[116:119], v5 offset:6144
    v_mfma_f32_32x32x16_bf16 v[48:63], v[88:91], v[84:87], v[48:63]
    ds_read_b64_tr_b16 v[124:125], v9 offset:8192
    ds_read_b64_tr_b16 v[126:127], v9 offset:9216
    buffer_load_dwordx4 v3, s[12:15], s51 offen offset:1024 lds
    v_mfma_f32_32x32x16_bf16 v[64:79], v[92:95], v[84:87], v[64:79]
    s_waitcnt lgkmcnt(6)
    v_mfma_f32_32x32x16_bf16 v[16:31], v[104:107], v[96:99], v[16:31]
    ds_read_b128 v[128:131], v5 offset:3072
    ds_read_b64_tr_b16 v[136:137], v7 offset:12288
    s_add_u32 m0, s58, 34816
    s_nop 0
    buffer_load_dwordx4 v2, s[12:15], s52 offen lds
    v_mfma_f32_32x32x16_bf16 v[32:47], v[108:111], v[96:99], v[32:47]
    ds_read_b64_tr_b16 v[138:139], v7 offset:13312
    ds_read_b128 v[132:135], v5 offset:7168
    v_mfma_f32_32x32x16_bf16 v[48:63], v[104:107], v[100:103], v[48:63]
    ds_read_b64_tr_b16 v[140:141], v9 offset:12288
    ds_read_b64_tr_b16 v[142:143], v9 offset:13312
    buffer_load_dwordx4 v3, s[12:15], s52 offen offset:1024 lds
    s_add_u32 s51, s51, 65536
    s_add_u32 s52, s52, 65536
    v_mfma_f32_32x32x16_bf16 v[64:79], v[108:111], v[100:103], v[64:79]
    s_waitcnt vmcnt(16) lgkmcnt(0)
    s_barrier
    v_mfma_f32_32x32x16_bf16 v[16:31], v[120:123], v[112:115], v[16:31]
    ds_read_b128 v[80:83], v5 offset:32768
    ds_read_b64_tr_b16 v[88:89], v7 offset:32768
    v_mfma_f32_32x32x16_bf16 v[32:47], v[124:127], v[112:115], v[32:47]
    ds_read_b64_tr_b16 v[90:91], v7 offset:33792
    ds_read_b128 v[84:87], v5 offset:36864
    v_mfma_f32_32x32x16_bf16 v[48:63], v[120:123], v[116:119], v[48:63]
    ds_read_b64_tr_b16 v[92:93], v9 offset:32768
    ds_read_b64_tr_b16 v[94:95], v9 offset:33792
    v_mfma_f32_32x32x16_bf16 v[64:79], v[124:127], v[116:119], v[64:79]
    s_waitcnt lgkmcnt(6)
    v_mfma_f32_32x32x16_bf16 v[16:31], v[136:139], v[128:131], v[16:31]
    ds_read_b128 v[96:99], v5 offset:33792
    ds_read_b64_tr_b16 v[104:105], v7 offset:36864
    v_mfma_f32_32x32x16_bf16 v[32:47], v[140:143], v[128:131], v[32:47]
    ds_read_b64_tr_b16 v[106:107], v7 offset:37888
    ds_read_b128 v[100:103], v5 offset:37888
    v_mfma_f32_32x32x16_bf16 v[48:63], v[136:139], v[132:135], v[48:63]
    ds_read_b64_tr_b16 v[108:109], v9 offset:36864
    ds_read_b64_tr_b16 v[110:111], v9 offset:37888
    v_mfma_f32_32x32x16_bf16 v[64:79], v[140:143], v[132:135], v[64:79]
    s_waitcnt lgkmcnt(6)
    v_mfma_f32_32x32x16_bf16 v[16:31], v[88:91], v[80:83], v[16:31]
    ds_read_b128 v[112:115], v5 offset:34816
    ds_read_b64_tr_b16 v[120:121], v7 offset:40960
    v_mfma_f32_32x32x16_bf16 v[32:47], v[92:95], v[80:83], v[32:47]
    ds_read_b64_tr_b16 v[122:123], v7 offset:41984
    ds_read_b128 v[116:119], v5 offset:38912
    v_mfma_f32_32x32x16_bf16 v[48:63], v[88:91], v[84:87], v[48:63]
    ds_read_b64_tr_b16 v[124:125], v9 offset:40960
    ds_read_b64_tr_b16 v[126:127], v9 offset:41984
    v_mfma_f32_32x32x16_bf16 v[64:79], v[92:95], v[84:87], v[64:79]
    s_waitcnt lgkmcnt(6)
    v_mfma_f32_32x32x16_bf16 v[16:31], v[104:107], v[96:99], v[16:31]
    ds_read_b128 v[128:131], v5 offset:35840
    ds_read_b64_tr_b16 v[136:137], v7 offset:45056
    v_mfma_f32_32x32x16_bf16 v[32:47], v[108:111], v[96:99], v[32:47]
    ds_read_b64_tr_b16 v[138:139], v7 offset:46080
    ds_read_b128 v[132:135], v5 offset:39936
    v_mfma_f32_32x32x16_bf16 v[48:63], v[104:107], v[100:103], v[48:63]
    ds_read_b64_tr_b16 v[140:141], v9 offset:45056
    ds_read_b64_tr_b16 v[142:143], v9 offset:46080
    v_mfma_f32_32x32x16_bf16 v[64:79], v[108:111], v[100:103], v[64:79]
    s_waitcnt vmcnt(8) lgkmcnt(0)
    s_barrier
    v_mfma_f32_32x32x16_bf16 v[16:31], v[120:123], v[112:115], v[16:31]
    ds_read_b128 v[80:83], v4 offset:0
    ds_read_b64_tr_b16 v[88:89], v6 offset:0
    v_mfma_f32_32x32x16_bf16 v[32:47], v[124:127], v[112:115], v[32:47]
    ds_read_b64_tr_b16 v[90:91], v6 offset:1024
    ds_read_b128 v[84:87], v4 offset:4096
    v_mfma_f32_32x32x16_bf16 v[48:63], v[120:123], v[116:119], v[48:63]
    ds_read_b64_tr_b16 v[92:93], v8 offset:0
    ds_read_b64_tr_b16 v[94:95], v8 offset:1024
    v_mfma_f32_32x32x16_bf16 v[64:79], v[124:127], v[116:119], v[64:79]
    s_waitcnt lgkmcnt(6)
    v_mfma_f32_32x32x16_bf16 v[16:31], v[136:139], v[128:131], v[16:31]
    ds_read_b128 v[96:99], v4 offset:1024
    ds_read_b64_tr_b16 v[104:105], v6 offset:4096
    v_mfma_f32_32x32x16_bf16 v[32:47], v[140:143], v[128:131], v[32:47]
    ds_read_b64_tr_b16 v[106:107], v6 offset:5120
    ds_read_b128 v[100:103], v4 offset:5120
    v_mfma_f32_32x32x16_bf16 v[48:63], v[136:139], v[132:135], v[48:63]
    ds_read_b64_tr_b16 v[108:109], v8 offset:4096
    ds_read_b64_tr_b16 v[110:111], v8 offset:5120
    v_mfma_f32_32x32x16_bf16 v[64:79], v[140:143], v[132:135], v[64:79]
    s_waitcnt lgkmcnt(6)
    v_mfma_f32_32x32x16_bf16 v[16:31], v[88:91], v[80:83], v[16:31]
    ds_read_b128 v[112:115], v4 offset:2048
    ds_read_b64_tr_b16 v[120:121], v6 offset:8192
    v_mfma_f32_32x32x16_bf16 v[32:47], v[92:95], v[80:83], v[32:47]
    ds_read_b64_tr_b16 v[122:123], v6 offset:9216
    ds_read_b128 v[116:119], v4 offset:6144
    v_mfma_f32_32x32x16_bf16 v[48:63], v[88:91], v[84:87], v[48:63]
    ds_read_b64_tr_b16 v[124:125], v8 offset:8192
    ds_read_b64_tr_b16 v[126:127], v8 offset:9216
    v_mfma_f32_32x32x16_bf16 v[64:79], v[92:95], v[84:87], v[64:79]
    s_waitcnt lgkmcnt(6)
    v_mfma_f32_32x32x16_bf16 v[16:31], v[104:107], v[96:99], v[16:31]
    ds_read_b128 v[128:131], v4 offset:3072
    ds_read_b64_tr_b16 v[136:137], v6 offset:12288
    v_mfma_f32_32x32x16_bf16 v[32:47], v[108:111], v[96:99], v[32:47]
    ds_read_b64_tr_b16 v[138:139], v6 offset:13312
    ds_read_b128 v[132:135], v4 offset:7168
    v_mfma_f32_32x32x16_bf16 v[48:63], v[104:107], v[100:103], v[48:63]
    ds_read_b64_tr_b16 v[140:141], v8 offset:12288
    ds_read_b64_tr_b16 v[142:143], v8 offset:13312
    v_mfma_f32_32x32x16_bf16 v[64:79], v[108:111], v[100:103], v[64:79]
    s_waitcnt vmcnt(0) lgkmcnt(0)
    s_barrier
    v_mfma_f32_32x32x16_bf16 v[16:31], v[120:123], v[112:115], v[16:31]
    ds_read_b128 v[80:83], v4 offset:32768
    ds_read_b64_tr_b16 v[88:89], v6 offset:32768
    v_mfma_f32_32x32x16_bf16 v[32:47], v[124:127], v[112:115], v[32:47]
    ds_read_b64_tr_b16 v[90:91], v6 offset:33792
    ds_read_b128 v[84:87], v4 offset:36864
    v_mfma_f32_32x32x16_bf16 v[48:63], v[120:123], v[116:119], v[48:63]
    ds_read_b64_tr_b16 v[92:93], v8 offset:32768
    ds_read_b64_tr_b16 v[94:95], v8 offset:33792
    v_mfma_f32_32x32x16_bf16 v[64:79], v[124:127], v[116:119], v[64:79]
    s_waitcnt lgkmcnt(6)
    v_mfma_f32_32x32x16_bf16 v[16:31], v[136:139], v[128:131], v[16:31]
    ds_read_b128 v[96:99], v4 offset:33792
    ds_read_b64_tr_b16 v[104:105], v6 offset:36864
    v_mfma_f32_32x32x16_bf16 v[32:47], v[140:143], v[128:131], v[32:47]
    ds_read_b64_tr_b16 v[106:107], v6 offset:37888
    ds_read_b128 v[100:103], v4 offset:37888
    v_mfma_f32_32x32x16_bf16 v[48:63], v[136:139], v[132:135], v[48:63]
    ds_read_b64_tr_b16 v[108:109], v8 offset:36864
    ds_read_b64_tr_b16 v[110:111], v8 offset:37888
    v_mfma_f32_32x32x16_bf16 v[64:79], v[140:143], v[132:135], v[64:79]
    s_waitcnt lgkmcnt(6)
    v_mfma_f32_32x32x16_bf16 v[16:31], v[88:91], v[80:83], v[16:31]
    ds_read_b128 v[112:115], v4 offset:34816
    ds_read_b64_tr_b16 v[120:121], v6 offset:40960
    v_mfma_f32_32x32x16_bf16 v[32:47], v[92:95], v[80:83], v[32:47]
    ds_read_b64_tr_b16 v[122:123], v6 offset:41984
    ds_read_b128 v[116:119], v4 offset:38912
    v_mfma_f32_32x32x16_bf16 v[48:63], v[88:91], v[84:87], v[48:63]
    ds_read_b64_tr_b16 v[124:125], v8 offset:40960
    ds_read_b64_tr_b16 v[126:127], v8 offset:41984
    v_mfma_f32_32x32x16_bf16 v[64:79], v[92:95], v[84:87], v[64:79]
    s_waitcnt lgkmcnt(6)
    v_mfma_f32_32x32x16_bf16 v[16:31], v[104:107], v[96:99], v[16:31]
    ds_read_b128 v[128:131], v4 offset:35840
    ds_read_b64_tr_b16 v[136:137], v6 offset:45056
    v_mfma_f32_32x32x16_bf16 v[32:47], v[108:111], v[96:99], v[32:47]
    ds_read_b64_tr_b16 v[138:139], v6 offset:46080
    ds_read_b128 v[132:135], v4 offset:39936
    v_mfma_f32_32x32x16_bf16 v[48:63], v[104:107], v[100:103], v[48:63]
    ds_read_b64_tr_b16 v[140:141], v8 offset:45056
    ds_read_b64_tr_b16 v[142:143], v8 offset:46080
    v_mfma_f32_32x32x16_bf16 v[64:79], v[108:111], v[100:103], v[64:79]
    s_waitcnt lgkmcnt(0)
    v_mfma_f32_32x32x16_bf16 v[16:31], v[120:123], v[112:115], v[16:31]
    v_mfma_f32_32x32x16_bf16 v[32:47], v[124:127], v[112:115], v[32:47]
    v_mfma_f32_32x32x16_bf16 v[48:63], v[120:123], v[116:119], v[48:63]
    v_mfma_f32_32x32x16_bf16 v[64:79], v[124:127], v[116:119], v[64:79]
    v_mfma_f32_32x32x16_bf16 v[16:31], v[136:139], v[128:131], v[16:31]
    v_mfma_f32_32x32x16_bf16 v[32:47], v[140:143], v[128:131], v[32:47]
    v_mfma_f32_32x32x16_bf16 v[48:63], v[136:139], v[132:135], v[48:63]
    v_mfma_f32_32x32x16_bf16 v[64:79], v[140:143], v[132:135], v[64:79]
    s_lshl_b32 s55, s57, 2
    s_add_u32 s55, s55, s46
    s_lshl_b32 s55, s55, 16
    s_add_u32 s55, s55, 83886080
    s_lshl_b32 s56, s47, 12
    s_add_u32 s50, s55, s56
    s_nop 7
    s_nop 7
    s_cmp_lt_u32 s47, 2
    s_cbranch_scc0 K3_x23
    s_cmp_eq_u32 s47, 0
    s_cbranch_scc0 K3_x1
    s_add_u32 s51, s50, 16384
    buffer_store_dwordx4 v[32:35], v1, s[8:11], s51 offen sc1
    buffer_store_dwordx4 v[36:39], v1, s[8:11], s51 offen offset:1024 sc1
    buffer_store_dwordx4 v[40:43], v1, s[8:11], s51 offen offset:2048 sc1
    buffer_store_dwordx4 v[44:47], v1, s[8:11], s51 offen offset:3072 sc1
    s_add_u32 s51, s50, 32768
    buffer_store_dwordx4 v[48:51], v1, s[8:11], s51 offen sc1
    buffer_store_dwordx4 v[52:55], v1, s[8:11], s51 offen offset:1024 sc1
    buffer_store_dwordx4 v[56:59], v1, s[8:11], s51 offen offset:2048 sc1
    buffer_store_dwordx4 v[60:63], v1, s[8:11], s51 offen offset:3072 sc1
    s_add_u32 s51, s50, 49152
    buffer_store_dwordx4 v[64:67], v1, s[8:11], s51 offen sc1
    buffer_store_dwordx4 v[68:71], v1, s[8:11], s51 offen offset:1024 sc1
    buffer_store_dwordx4 v[72:75], v1, s[8:11], s51 offen offset:2048 sc1
    buffer_store_dwordx4 v[76:79], v1, s[8:11], s51 offen offset:3072 sc1
    v_mov_b32 v80, v16
    v_mov_b32 v81, v17
    v_mov_b32 v82, v18
    v_mov_b32 v83, v19
    v_mov_b32 v84, v20
    v_mov_b32 v85, v21
    v_mov_b32 v86, v22
    v_mov_b32 v87, v23
    v_mov_b32 v88, v24
    v_mov_b32 v89, v25
    v_mov_b32 v90, v26
    v_mov_b32 v91, v27
    v_mov_b32 v92, v28
    v_mov_b32 v93, v29
    v_mov_b32 v94, v30
    v_mov_b32 v95, v31
    s_branch K3_xj
K3_x1:
    s_add_u32 s51, s50, 0
    buffer_store_dwordx4 v[16:19], v1, s[8:11], s51 offen sc1
    buffer_store_dwordx4 v[20:23], v1, s[8:11], s51 offen offset:1024 sc1
    buffer_store_dwordx4 v[24:27], v1, s[8:11], s51 offen offset:2048 sc1
    buffer_store_dwordx4 v[28:31], v1, s[8:11], s51 offen offset:3072 sc1
    s_add_u32 s51, s50, 32768
    buffer_store_dwordx4 v[48:51], v1, s[8:11], s51 offen sc1
    buffer_store_dwordx4 v[52:55], v1, s[8:11], s51 offen offset:1024 sc1
    buffer_store_dwordx4 v[56:59], v1, s[8:11], s51 offen offset:2048 sc1
    buffer_store_dwordx4 v[60:63], v1, s[8:11], s51 offen offset:3072 sc1
    s_add_u32 s51, s50, 49152
    buffer_store_dwordx4 v[64:67], v1, s[8:11], s51 offen sc1
    buffer_store_dwordx4 v[68:71], v1, s[8:11], s51 offen offset:1024 sc1
    buffer_store_dwordx4 v[72:75], v1, s[8:11], s51 offen offset:2048 sc1
    buffer_store_dwordx4 v[76:79], v1, s[8:11], s51 offen offset:3072 sc1
    v_mov_b32 v80, v32
    v_mov_b32 v81, v33
    v_mov_b32 v82, v34
    v_mov_b32 v83, v35
    v_mov_b32 v84, v36
    v_mov_b32 v85, v37
    v_mov_b32 v86, v38
    v_mov_b32 v87, v39
    v_mov_b32 v88, v40
    v_mov_b32 v89, v41
    v_mov_b32 v90, v42
    v_mov_b32 v91, v43
    v_mov_b32 v92, v44
    v_mov_b32 v93, v45
    v_mov_b32 v94, v46
    v_mov_b32 v95, v47
    s_branch K3_xj
K3_x23:
    s_cmp_eq_u32 s47, 2
    s_cbranch_scc0 K3_x3
    s_add_u32 s51, s50, 0
    buffer_store_dwordx4 v[16:19], v1, s[8:11], s51 offen sc1
    buffer_store_dwordx4 v[20:23], v1, s[8:11], s51 offen offset:1024 sc1
    buffer_store_dwordx4 v[24:27], v1, s[8:11], s51 offen offset:2048 sc1
    buffer_store_dwordx4 v[28:31], v1, s[8:11], s51 offen offset:3072 sc1
    s_add_u32 s51, s50, 16384
    buffer_store_dwordx4 v[32:35], v1, s[8:11], s51 offen sc1
    buffer_store_dwordx4 v[36:39], v1, s[8:11], s51 offen offset:1024 sc1
    buffer_store_dwordx4 v[40:43], v1, s[8:11], s51 offen offset:2048 sc1
    buffer_store_dwordx4 v[44:47], v1, s[8:11], s51 offen offset:3072 sc1
    s_add_u32 s51, s50, 49152
    buffer_store_dwordx4 v[64:67], v1, s[8:11], s51 offen sc1
    buffer_store_dwordx4 v[68:71], v1, s[8:11], s51 offen offset:1024 sc1
    buffer_store_dwordx4 v[72:75], v1, s[8:11], s51 offen offset:2048 sc1
    buffer_store_dwordx4 v[76:79], v1, s[8:11], s51 offen offset:3072 sc1
    v_mov_b32 v80, v48
    v_mov_b32 v81, v49
    v_mov_b32 v82, v50
    v_mov_b32 v83, v51
    v_mov_b32 v84, v52
    v_mov_b32 v85, v53
    v_mov_b32 v86, v54
    v_mov_b32 v87, v55
    v_mov_b32 v88, v56
    v_mov_b32 v89, v57
    v_mov_b32 v90, v58
    v_mov_b32 v91, v59
    v_mov_b32 v92, v60
    v_mov_b32 v93, v61
    v_mov_b32 v94, v62
    v_mov_b32 v95, v63
    s_branch K3_xj
K3_x3:
    s_add_u32 s51, s50, 0
    buffer_store_dwordx4 v[16:19], v1, s[8:11], s51 offen sc1
    buffer_store_dwordx4 v[20:23], v1, s[8:11], s51 offen offset:1024 sc1
    buffer_store_dwordx4 v[24:27], v1, s[8:11], s51 offen offset:2048 sc1
    buffer_store_dwordx4 v[28:31], v1, s[8:11], s51 offen offset:3072 sc1
    s_add_u32 s51, s50, 16384
    buffer_store_dwordx4 v[32:35], v1, s[8:11], s51 offen sc1
    buffer_store_dwordx4 v[36:39], v1, s[8:11], s51 offen offset:1024 sc1
    buffer_store_dwordx4 v[40:43], v1, s[8:11], s51 offen offset:2048 sc1
    buffer_store_dwordx4 v[44:47], v1, s[8:11], s51 offen offset:3072 sc1
    s_add_u32 s51, s50, 32768
    buffer_store_dwordx4 v[48:51], v1, s[8:11], s51 offen sc1
    buffer_store_dwordx4 v[52:55], v1, s[8:11], s51 offen offset:1024 sc1
    buffer_store_dwordx4 v[56:59], v1, s[8:11], s51 offen offset:2048 sc1
    buffer_store_dwordx4 v[60:63], v1, s[8:11], s51 offen offset:3072 sc1
    v_mov_b32 v80, v64
    v_mov_b32 v81, v65
    v_mov_b32 v82, v66
    v_mov_b32 v83, v67
    v_mov_b32 v84, v68
    v_mov_b32 v85, v69
    v_mov_b32 v86, v70
    v_mov_b32 v87, v71
    v_mov_b32 v88, v72
    v_mov_b32 v89, v73
    v_mov_b32 v90, v74
    v_mov_b32 v91, v75
    v_mov_b32 v92, v76
    v_mov_b32 v93, v77
    v_mov_b32 v94, v78
    v_mov_b32 v95, v79
K3_xj:
    v_and_b32 v10, 3, v0
    v_lshlrev_b32 v10, 7, v10
    s_lshl_b32 s56, s57, 2
    s_add_u32 s56, s56, s46
    s_lshl_b32 s56, s56, 9
    s_add_u32 s56, s56, 100663296
    s_lshl_b32 s51, s47, 7
    s_add_u32 s51, s51, s56
    v_mov_b32 v11, 1
    v_mov_b32 v12, 0
    s_mov_b64 s[60:61], exec
    s_waitcnt vmcnt(0)
    s_mov_b64 exec, 1
    buffer_store_dword v11, v12, s[8:11], s51 offen sc1
    s_mov_b64 exec, s[60:61]
    s_mov_b32 s54, 100000
K3_poll:
    s_sub_u32 s54, s54, 1
    s_cbranch_scc1 K3_pollx
    buffer_load_dword v12, v10, s[8:11], s56 offen sc1
    s_waitcnt vmcnt(0)
    v_cmp_eq_u32 vcc, 1, v12
    s_nop 1
    s_cmp_eq_u64 vcc, -1
    s_cbranch_scc0 K3_poll
K3_pollx:
    s_lshl_b32 s53, s47, 14
    s_add_u32 s55, s55, s53
    s_add_u32 s53, s47, 1
    s_and_b32 s53, s53, 3
    s_lshl_b32 s53, s53, 12
    s_add_u32 s53, s53, s55
    buffer_load_dwordx4 v[16:19], v1, s[8:11], s53 offen sc1
    buffer_load_dwordx4 v[20:23], v1, s[8:11], s53 offen offset:1024 sc1
    buffer_load_dwordx4 v[24:27], v1, s[8:11], s53 offen offset:2048 sc1
    buffer_load_dwordx4 v[28:31], v1, s[8:11], s53 offen offset:3072 sc1
    s_add_u32 s53, s47, 2
    s_and_b32 s53, s53, 3
    s_lshl_b32 s53, s53, 12
    s_add_u32 s53, s53, s55
    buffer_load_dwordx4 v[32:35], v1, s[8:11], s53 offen sc1
    buffer_load_dwordx4 v[36:39], v1, s[8:11], s53 offen offset:1024 sc1
    buffer_load_dwordx4 v[40:43], v1, s[8:11], s53 offen offset:2048 sc1
    buffer_load_dwordx4 v[44:47], v1, s[8:11], s53 offen offset:3072 sc1
    s_add_u32 s53, s47, 3
    s_and_b32 s53, s53, 3
    s_lshl_b32 s53, s53, 12
    s_add_u32 s53, s53, s55
    buffer_load_dwordx4 v[48:51], v1, s[8:11], s53 offen sc1
    buffer_load_dwordx4 v[52:55], v1, s[8:11], s53 offen offset:1024 sc1
    buffer_load_dwordx4 v[56:59], v1, s[8:11], s53 offen offset:2048 sc1
    buffer_load_dwordx4 v[60:63], v1, s[8:11], s53 offen offset:3072 sc1
    v_and_b32 v8, 31, v0
    v_lshlrev_b32 v8, 10, v8
    v_lshrrev_b32 v9, 5, v0
    v_lshl_add_u32 v8, v9, 4, v8
    s_lshl_b32 s55, s48, 17
    s_lshr_b32 s56, s46, 1
    s_lshl_b32 s56, s56, 16
    s_add_u32 s55, s55, s56
    s_lshr_b32 s56, s47, 1
    s_lshl_b32 s56, s56, 15
    s_add_u32 s55, s55, s56
    s_lshl_b32 s56, s49, 8
    s_add_u32 s55, s55, s56
    s_and_b32 s56, s46, 1
    s_lshl_b32 s56, s56, 7
    s_add_u32 s55, s55, s56
    s_and_b32 s56, s47, 1
    s_lshl_b32 s56, s56, 6
    s_add_u32 s55, s55, s56
    s_waitcnt vmcnt(8)
    v_add_f32 v80, v80, v16
    v_add_f32 v81, v81, v17
    v_add_f32 v82, v82, v18
    v_add_f32 v83, v83, v19
    v_add_f32 v84, v84, v20
    v_add_f32 v85, v85, v21
    v_add_f32 v86, v86, v22
    v_add_f32 v87, v87, v23
    v_add_f32 v88, v88, v24
    v_add_f32 v89, v89, v25
    v_add_f32 v90, v90, v26
    v_add_f32 v91, v91, v27
    v_add_f32 v92, v92, v28
    v_add_f32 v93, v93, v29
    v_add_f32 v94, v94, v30
    v_add_f32 v95, v95, v31
    s_waitcnt vmcnt(4)
    v_add_f32 v80, v80, v32
    v_add_f32 v81, v81, v33
    v_add_f32 v82, v82, v34
    v_add_f32 v83, v83, v35
    v_add_f32 v84, v84, v36
    v_add_f32 v85, v85, v37
    v_add_f32 v86, v86, v38
    v_add_f32 v87, v87, v39
    v_add_f32 v88, v88, v40
    v_add_f32 v89, v89, v41
    v_add_f32 v90, v90, v42
    v_add_f32 v91, v91, v43
    v_add_f32 v92, v92, v44
    v_add_f32 v93, v93, v45
    v_add_f32 v94, v94, v46
    v_add_f32 v95, v95, v47
    s_waitcnt vmcnt(0)
    v_add_f32 v80, v80, v48
    v_add_f32 v81, v81, v49
    v_add_f32 v82, v82, v50
    v_add_f32 v83, v83, v51
    v_add_f32 v84, v84, v52
    v_add_f32 v85, v85, v53
    v_add_f32 v86, v86, v54
    v_add_f32 v87, v87, v55
    v_add_f32 v88, v88, v56
    v_add_f32 v89, v89, v57
    v_add_f32 v90, v90, v58
    v_add_f32 v91, v91, v59
    v_add_f32 v92, v92, v60
    v_add_f32 v93, v93, v61
    v_add_f32 v94, v94, v62
    v_add_f32 v95, v95, v63
    v_cvt_pk_bf16_f32 v80, v80, v81
    v_cvt_pk_bf16_f32 v81, v82, v83
    v_cvt_pk_bf16_f32 v82, v84, v85
    v_cvt_pk_bf16_f32 v83, v86, v87
    v_cvt_pk_bf16_f32 v84, v88, v89
    v_cvt_pk_bf16_f32 v85, v90, v91
    v_cvt_pk_bf16_f32 v86, v92, v93
    v_cvt_pk_bf16_f32 v87, v94, v95
    s_nop 1
    v_permlane32_swap_b32 v80, v82
    v_permlane32_swap_b32 v81, v83
    v_permlane32_swap_b32 v84, v86
    v_permlane32_swap_b32 v85, v87
    s_nop 1
    buffer_store_dwordx4 v[80:83], v8, s[20:23], s55 offen
    buffer_store_dwordx4 v[84:87], v8, s[20:23], s55 offen offset:32
    s_waitcnt vmcnt(0)
    s_waitcnt lgkmcnt(0)
K3_end:
    s_endpgm
K3_helper:
    v_and_b32 v1, 31, v0
    v_lshlrev_b32 v1, 7, v1
    v_and_b32 v2, 15, v0
    v_lshlrev_b32 v2, 7, v2
    s_lshl_b32 s55, s48, 2
    s_add_u32 s55, s55, s49
    s_mul_i32 s55, s55, 294912
    s_add_u32 s55, s55, 56623104
    s_lshl_b32 s56, s47, 16
    s_add_u32 s50, s55, s56
    s_lshl_b32 s56, s47, 13
    s_add_u32 s53, s55, s56
    s_add_u32 s53, s53, 262144
    s_and_b32 s55, s48, 7
    s_lshl_b32 s55, s55, 2
    s_add_u32 s55, s55, s49
    s_lshl_b32 s55, s55, 11
    s_lshl_b32 s51, s47, 20
    s_add_u32 s51, s51, s55
    s_lshl_b32 s58, s47, 17
    s_add_u32 s58, s58, s55
    s_add_u32 s55, s50, 0
    s_add_u32 s56, s51, 0
    buffer_load_dword v4, v1, s[8:11], s55 offen
    buffer_load_dword v5, v2, s[12:15], s56 offen
    s_add_u32 s55, s50, 4096
    s_add_u32 s56, s51, 65536
    buffer_load_dword v4, v1, s[8:11], s55 offen
    buffer_load_dword v5, v2, s[12:15], s56 offen
    s_add_u32 s55, s50, 8192
    s_add_u32 s56, s51, 131072
    buffer_load_dword v4, v1, s[8:11], s55 offen
    buffer_load_dword v5, v2, s[12:15], s56 offen
    s_add_u32 s55, s50, 12288
    s_add_u32 s56, s51, 196608
    buffer_load_dword v4, v1, s[8:11], s55 offen
    buffer_load_dword v5, v2, s[12:15], s56 offen
    s_add_u32 s55, s50, 16384
    s_add_u32 s56, s51, 262144
    buffer_load_dword v4, v1, s[8:11], s55 offen
    buffer_load_dword v5, v2, s[12:15], s56 offen
    s_barrier
    s_add_u32 s55, s50, 20480
    s_add_u32 s56, s51, 327680
    buffer_load_dword v4, v1, s[8:11], s55 offen
    buffer_load_dword v5, v2, s[12:15], s56 offen
    s_barrier
    s_add_u32 s55, s50, 24576
    s_add_u32 s56, s51, 393216
    buffer_load_dword v4, v1, s[8:11], s55 offen
    buffer_load_dword v5, v2, s[12:15], s56 offen
    s_barrier
    s_add_u32 s55, s50, 28672
    s_add_u32 s56, s51, 458752
    buffer_load_dword v4, v1, s[8:11], s55 offen
    buffer_load_dword v5, v2, s[12:15], s56 offen
    s_barrier
    s_add_u32 s55, s50, 32768
    s_add_u32 s56, s51, 524288
    buffer_load_dword v4, v1, s[8:11], s55 offen
    buffer_load_dword v5, v2, s[12:15], s56 offen
    s_barrier
    s_add_u32 s55, s50, 36864
    s_add_u32 s56, s51, 589824
    buffer_load_dword v4, v1, s[8:11], s55 offen
    buffer_load_dword v5, v2, s[12:15], s56 offen
    s_barrier
    s_add_u32 s55, s50, 40960
    s_add_u32 s56, s51, 655360
    buffer_load_dword v4, v1, s[8:11], s55 offen
    buffer_load_dword v5, v2, s[12:15], s56 offen
    s_barrier
    s_add_u32 s55, s50, 45056
    s_add_u32 s56, s51, 720896
    buffer_load_dword v4, v1, s[8:11], s55 offen
    buffer_load_dword v5, v2, s[12:15], s56 offen
    s_barrier
    s_add_u32 s55, s50, 49152
    s_add_u32 s56, s51, 786432
    buffer_load_dword v4, v1, s[8:11], s55 offen
    buffer_load_dword v5, v2, s[12:15], s56 offen
    s_barrier
    s_add_u32 s55, s50, 53248
    s_add_u32 s56, s51, 851968
    buffer_load_dword v4, v1, s[8:11], s55 offen
    buffer_load_dword v5, v2, s[12:15], s56 offen
    s_barrier
    s_add_u32 s55, s50, 57344
    s_add_u32 s56, s51, 917504
    buffer_load_dword v4, v1, s[8:11], s55 offen
    buffer_load_dword v5, v2, s[12:15], s56 offen
    s_barrier
    s_add_u32 s55, s50, 61440
    s_add_u32 s56, s51, 983040
    buffer_load_dword v4, v1, s[8:11], s55 offen
    buffer_load_dword v5, v2, s[12:15], s56 offen
    s_barrier
    s_add_u32 s55, s53, 0
    s_add_u32 s56, s58, 0
    buffer_load_dword v4, v1, s[8:11], s55 offen
    buffer_load_dword v5, v2, s[16:19], s56 offen
    s_barrier
    s_add_u32 s55, s53, 4096
    s_add_u32 s56, s58, 65536
    buffer_load_dword v4, v1, s[8:11], s55 offen
    buffer_load_dword v5, v2, s[16:19], s56 offen
    s_barrier
    s_barrier
    s_barrier
    s_barrier
    s_barrier
    s_waitcnt vmcnt(0)
    s_endpgm
.section .rodata,"a"
.p2align 6
.amdhsa_kernel k12_kernel
  .amdhsa_next_free_vgpr 512
  .amdhsa_next_free_sgpr 102
  .amdhsa_accum_offset 256
  .amdhsa_group_segment_fixed_size 0
  .amdhsa_kernarg_size 112
  .amdhsa_user_sgpr_count 2
  .amdhsa_user_sgpr_kernarg_segment_ptr 1
  .amdhsa_system_sgpr_workgroup_id_x 1
  .amdhsa_float_denorm_mode_32 3
.end_amdhsa_kernel

.section .rodata,"a"
.p2align 6
.amdhsa_kernel k3b_kernel
  .amdhsa_next_free_vgpr 160
  .amdhsa_next_free_sgpr 102
  .amdhsa_accum_offset 160
  .amdhsa_group_segment_fixed_size 0
  .amdhsa_kernarg_size 112
  .amdhsa_user_sgpr_count 2
  .amdhsa_user_sgpr_kernarg_segment_ptr 1
  .amdhsa_system_sgpr_workgroup_id_x 1
  .amdhsa_float_denorm_mode_32 3
.end_amdhsa_kernel
```
